```python
import torch

def _softmax(x, axis=-1):
    return torch.softmax(x, dim=axis)
def _gelu(x):
    return torch.nn.functional.gelu(x, approximate="tanh")
def _silu(x):
    return torch.nn.functional.silu(x)
def _sigmoid(x):
    return torch.sigmoid(x)
def _layernorm(x, axis=-1, eps=1e-5):
    m = x.mean(dim=axis, keepdim=True)
    v = x.var(dim=axis, keepdim=True, unbiased=False)
    return (x - m) / torch.sqrt(v + eps)
def _scatter_add(tgt, idx, src, axis=0):
    return tgt.clone().index_add_(axis, idx, src)
def _segment_sum(src, seg, n):
    out = torch.zeros((n,) + src.shape[1:], dtype=src.dtype)
    return out.index_add_(0, seg, src)
def _pad(x, pw):
    flat = tuple(v for pair in reversed(pw) for v in pair)
    return torch.nn.functional.pad(x, flat)

kernel_name = 'gated_mix__ssm_conv_s4__swiglu_ffn__prompt'

def setup_inputs():

    _w = (lambda a: (lambda t: t.to(torch.bfloat16) if t.is_floating_point() else t)(torch.as_tensor(a)))
    def _A_setup():
        B, L, D, N = 1, 2048, 1024, 128
        A_re = -(lambda _x: torch.exp(torch.as_tensor(_x)))((lambda *s: torch.randn(*s, dtype=torch.bfloat16) * 6.4)(D, N))
        A_im = torch.pi * (lambda *s: torch.randn(*s, dtype=torch.bfloat16) * 0.05)(D, N)
        B_re = (lambda *s: torch.randn(*s, dtype=torch.bfloat16) * 0.1)(D, N)
        B_im = (lambda *s: torch.randn(*s, dtype=torch.bfloat16) * 0.1)(D, N)
        C_re = (lambda *s: torch.randn(*s, dtype=torch.bfloat16) * 0.1)(D, N)
        C_im = (lambda *s: torch.randn(*s, dtype=torch.bfloat16) * 0.1)(D, N)
        log_dt = (lambda *s: torch.randn(*s, dtype=torch.bfloat16) * 0.05)(D) * 0.5 - 4.0
        Dskip = (lambda *s: torch.randn(*s, dtype=torch.bfloat16) * 0.05)(D)
        return {
            "u": _w((lambda *s: torch.randn(*s, dtype=torch.bfloat16) * 0.05)(B, L, D)),
            "A_re": _w(A_re),
            "A_im": _w(A_im),
            "B_re": _w(B_re),
            "B_im": _w(B_im),
            "C_re": _w(C_re),
            "C_im": _w(C_im),
            "log_dt": _w(log_dt),
            "Dskip": _w(Dskip),
        }
    _A_in = _A_setup()

    def _B_setup():
        B, S, D, F = 1, 2048, 1024, 3584
        return {
            "x": _w((lambda *s: torch.randn(*s, dtype=torch.bfloat16) * 0.05)(B, S, D)),
            "w_gate": _w((lambda *s: torch.randn(*s, dtype=torch.bfloat16) * 0.05)(D, F)),
            "w_up": _w((lambda *s: torch.randn(*s, dtype=torch.bfloat16) * 0.05)(D, F)),
            "w_down": _w((lambda *s: torch.randn(*s, dtype=torch.bfloat16) * 0.05)(F, D)),
        }
    _B_in = _B_setup()

    return {
        "A_u": _A_in["u"],
        "A_A_re": _A_in["A_re"],
        "A_A_im": _A_in["A_im"],
        "A_B_re": _A_in["B_re"],
        "A_B_im": _A_in["B_im"],
        "A_C_re": _A_in["C_re"],
        "A_C_im": _A_in["C_im"],
        "A_log_dt": _A_in["log_dt"],
        "A_Dskip": _A_in["Dskip"],
        "B_x": _B_in["x"],
        "B_w_gate": _B_in["w_gate"],
        "B_w_up": _B_in["w_up"],
        "B_w_down": _B_in["w_down"],
        "gate_w": _w((lambda *s: torch.randn(*s, dtype=torch.bfloat16) * 0.05)(1024) * 16.0),
    }

def reference(A_u, A_A_re, A_A_im, A_B_re, A_B_im, A_C_re, A_C_im, A_log_dt, A_Dskip, B_x, B_w_gate, B_w_up, B_w_down, gate_w):
    def _A_ref(u, A_re, A_im, B_re, B_im, C_re, C_im, log_dt, Dskip):
        Bsz, L, D = u.shape
        dt = torch.exp(log_dt)[:, None]
        A = A_re + 1j * A_im
        Bc = B_re + 1j * B_im
        Cc = C_re + 1j * C_im
        logdA = dt * A
        dB = dt * Bc
        l = (lambda x, dt: x.to(dt))(torch.arange(L), A_re.dtype)
        P = torch.exp(logdA[:, :, None] * l[None, None, :])
        K = torch.einsum("dn,dnl,dn->dl", Cc, P, dB).real
        L2 = 2 * L
        Kp = _pad(K, ((0, 0), (0, L)))
        up = (lambda x, *d: x.permute(*d))(u, 0, 2, 1)
        up = _pad(up, ((0, 0), (0, 0), (0, L)))
        Kf = (lambda x, axes=(-2,-1): torch.fft.rfft2(x.float(), dim=axes))(Kp[:, None, :], axes=(-2, -1))
        Uf = (lambda x, axes=(-2,-1): torch.fft.rfft2(x.float(), dim=axes))(up[:, :, None, :], axes=(-2, -1))
        Yf = Uf * Kf[None, :, :, :]
        y = (lambda x, s, axes=(-2,-1): torch.fft.irfft2(x, s=s, dim=axes).to(torch.bfloat16))(Yf, (1, L2), axes=(-2, -1))[:, :, 0, :L]
        y = (lambda x, *d: x.permute(*d))(y, 0, 2, 1) + u * Dskip[None, None, :]
        return y

    def _B_ref(x, w_gate, w_up, w_down):
        g = _silu(x @ w_gate)
        u = x @ w_up
        return (g * u) @ w_down

    x = A_u
    g = _sigmoid((x * gate_w).sum(-1, keepdims=True))
    a = _A_ref(x, A_A_re, A_A_im, A_B_re, A_B_im, A_C_re, A_C_im, A_log_dt, A_Dskip)
    b = _B_ref(x, B_w_gate, B_w_up, B_w_down)
    return g * a + (1 - g) * b
```

```asm
; @launch grid=(256,1,1) block=(256,1,1) lds=163840
.amdgcn_target "amdgcn-amd-amdhsa--gfx950"
.text
.globl gated_mix__ssm_conv_s4__swiglu_ffn__prompt_kernel
.p2align 8
.type gated_mix__ssm_conv_s4__swiglu_ffn__prompt_kernel,@function
gated_mix__ssm_conv_s4__swiglu_ffn__prompt_kernel:
    s_cmp_ge_u32 s2, 256
    s_cbranch_scc1 gated_mix__ssm_conv_s4__swiglu_ffn__prompt_kernel_done
    s_load_dwordx16 s[4:19], s[0:1], 0
    s_load_dwordx2 s[20:21], s[0:1], 64
    s_load_dwordx8 s[84:91], s[0:1], 80
    s_load_dwordx4 s[92:95], s[0:1], 112
    s_load_dwordx2 s[24:25], s[0:1], 128
    s_getpc_b64 s[98:99]
gated_mix__ssm_conv_s4__swiglu_ffn__prompt_kernel_pc:
    s_bfe_u32 s97, s2, 0x10003
    s_lshl_b32 s97, s97, 15
    v_lshl_add_u32 v173, v0, 7, s97
    v_min_u32 v173, gated_mix__ssm_conv_s4__swiglu_ffn__prompt_kernel_end - gated_mix__ssm_conv_s4__swiglu_ffn__prompt_kernel_pc - 4, v173
    v_mov_b32 v31, v0
    v_lshrrev_b32 v1, 6, v0
    v_and_b32 v0, 63, v0
    v_readfirstlane_b32 s32, v1
    s_and_b32 s56, s2, 7
    s_lshr_b32 s57, s2, 3
    s_lshl_b32 s33, s56, 5
    s_add_u32 s33, s33, s57
    s_lshl_b32 s34, s33, 2
    s_add_u32 s34, s34, s32
    s_and_b32 s35, s57, 3
    s_lshl_b32 s58, s56, 2
    s_add_u32 s35, s35, s58
    s_lshr_b32 s36, s57, 2
    s_mul_i32 s40, s32, 40960
    v_lshlrev_b32 v30, 14, v31
    s_lshl_b32 s96, s33, 3
    v_lshlrev_b32 v43, 2, v0
    s_lshl_b32 s100, s34, 8
    s_lshl_b32 s101, s34, 1
    v_mov_b32 v44, 0
    v_lshlrev_b32 v45, 4, v0
    s_lshl_b32 s59, s36, 8
    s_lshl_b32 s60, s35, 3
    s_add_u32 s59, s59, s60
    s_lshl_b32 s60, s32, 1
    s_add_u32 s59, s59, s60
    s_lshl_b32 s60, s59, 11
    s_lshl_b32 s61, s36, 8
    s_lshl_b32 s62, s32, 6
    s_add_u32 s61, s61, s62
    v_lshrrev_b32 v1, 3, v0
    v_add_u32 v1, s61, v1
    v_lshlrev_b32 v1, 11, v1
    v_lshrrev_b32 v2, 4, v0
    v_and_b32 v3, 7, v0
    v_xor_b32 v2, v2, v3
    v_xor_b32 v3, 4, v2
    v_lshl_add_u32 v9, v2, 4, v1
    v_lshl_add_u32 v10, v3, 4, v1
    v_add_u32 v10, 0x4000, v10
    v_add_u32 v11, 0x8000, v9
    v_add_u32 v12, 0x8000, v10
    v_add_u32 v13, 0x8000, v11
    v_add_u32 v14, 0x8000, v12
    v_add_u32 v15, 0x8000, v13
    v_add_u32 v16, 0x8000, v14
    v_and_b32 v1, 15, v0
    v_add_u32 v1, s61, v1
    v_lshlrev_b32 v1, 3, v1
    v_lshrrev_b32 v2, 4, v0
    v_lshlrev_b32 v2, 15, v2
    s_and_b32 s62, s35, 30
    s_lshl_b32 s62, s62, 17
    v_add3_u32 v31, v1, v2, s62
    s_nop 0
    s_and_b32 s96, s35, 15
    v_lshlrev_b32 v30, 2, v0
    v_lshrrev_b32 v1, 3, v0
    v_min_u32 v1, 3, v1
    s_mul_i32 s61, s57, 8
    s_lshr_b32 s62, s32, 1
    s_mul_i32 s62, s62, 4
    s_add_u32 s61, s61, s62
    v_add_u32 v1, s61, v1
    v_mul_u32_u24 v1, 7168, v1
    v_and_b32 v2, 7, v0
    v_min_u32 v2, 6, v2
    v_lshlrev_b32 v2, 7, v2
    s_mul_i32 s61, s56, 896
    v_add3_u32 v25, v1, v2, s61
    v_bfe_u32 v1, v0, 3, 1
    s_lshl_b32 s62, s57, 2
    s_and_b32 s63, s32, 2
    s_add_u32 s62, s62, s63
    s_add_u32 s62, s62, 0
    v_add_u32 v1, s62, v1
    v_mul_u32_u24 v1, 7168, v1
    v_add3_u32 v23, v1, v2, s61
    v_and_b32 v1, 7, v0
    v_lshlrev_b32 v1, 7, v1
    s_mul_i32 s62, s2, 28672
    s_lshl_b32 s63, s32, 10
    s_add_u32 s62, s62, s63
    v_add_u32 v24, s62, v1
    s_lshr_b32 s62, s56, 2
    s_mul_i32 s62, s62, 1792
    s_lshl_b32 s63, s57, 3
    s_add_u32 s62, s62, s63
    s_lshl_b32 s63, s32, 1
    s_add_u32 s62, s62, s63
    s_lshl_b32 s62, s62, 11
    s_and_b32 s63, s56, 1
    s_lshl_b32 s63, s63, 10
    s_add_u32 s62, s62, s63
    v_bfe_u32 v2, v0, 3, 1
    v_lshl_add_u32 v1, v2, 11, v1
    v_add_u32 v24, s62, v1
    v_mov_b32 v1, 0x7ff00000
    v_cmp_lt_u32 vcc, 15, v0
    s_nop 1
    v_cndmask_b32 v23, v23, v1, vcc
    v_cndmask_b32 v24, v24, v1, vcc
    v_cmp_lt_u32 vcc, 31, v0
    s_nop 1
    v_cndmask_b32 v25, v25, v1, vcc
    s_waitcnt lgkmcnt(0)
    s_mov_b32 s44, s6
    s_and_b32 s45, s7, 0xffff
    s_mov_b32 s46, 0x40000
    s_mov_b32 s47, 0x00020000
    buffer_load_dword v34, v43, s[44:47], s100 offen
    s_mov_b32 s44, s8
    s_and_b32 s45, s9, 0xffff
    s_mov_b32 s46, 0x40000
    s_mov_b32 s47, 0x00020000
    buffer_load_dword v35, v43, s[44:47], s100 offen
    s_mov_b32 s44, s10
    s_and_b32 s45, s11, 0xffff
    s_mov_b32 s46, 0x40000
    s_mov_b32 s47, 0x00020000
    buffer_load_dword v36, v43, s[44:47], s100 offen
    s_mov_b32 s44, s12
    s_and_b32 s45, s13, 0xffff
    s_mov_b32 s46, 0x40000
    s_mov_b32 s47, 0x00020000
    buffer_load_dword v37, v43, s[44:47], s100 offen
    s_mov_b32 s44, s14
    s_and_b32 s45, s15, 0xffff
    s_mov_b32 s46, 0x40000
    s_mov_b32 s47, 0x00020000
    buffer_load_dword v38, v43, s[44:47], s100 offen
    s_mov_b32 s44, s16
    s_and_b32 s45, s17, 0xffff
    s_mov_b32 s46, 0x40000
    s_mov_b32 s47, 0x00020000
    buffer_load_dword v39, v43, s[44:47], s100 offen
    s_mov_b32 s44, s18
    s_and_b32 s45, s19, 0xffff
    s_mov_b32 s46, 0x800
    s_mov_b32 s47, 0x00020000
    buffer_load_ushort v40, v44, s[44:47], s101 offen
    s_mov_b32 s44, s20
    s_and_b32 s45, s21, 0xffff
    s_mov_b32 s46, 0x800
    s_mov_b32 s47, 0x00020000
    buffer_load_ushort v41, v44, s[44:47], s101 offen
    global_load_dword v172, v173, s[98:99]
    s_mov_b32 s48, s4
    s_and_b32 s49, s5, 0xffff
    s_mov_b32 s50, 0x400000
    s_mov_b32 s51, 0x00020000
    s_mov_b32 s28, s24
    s_and_b32 s29, s25, 0xffff
    s_mov_b32 s30, 0x10000000
    s_mov_b32 s31, 0x00020000
    s_mov_b32 s12, s90
    s_and_b32 s13, s91, 0xffff
    s_mov_b32 s14, 0x800
    s_mov_b32 s15, 0x00020000
    s_mov_b32 s8, s94
    s_and_b32 s9, s95, 0xffff
    s_mov_b32 s10, 0x100
    s_mov_b32 s11, 0x00020000
    s_cmp_ge_u32 s2, 24
    s_cbranch_scc1 gated_mix__ssm_conv_s4__swiglu_ffn__prompt_kernel_noclr
    s_cmp_lg_u32 s32, 0
    s_cbranch_scc1 gated_mix__ssm_conv_s4__swiglu_ffn__prompt_kernel_noclr
    s_mul_i32 s61, s2, 4352
    s_add_u32 s61, s61, 22020096
    v_and_b32 v26, 31, v0
    v_lshlrev_b32 v26, 2, v26
    buffer_store_dword v44, v26, s[28:31], s61 offen sc1
gated_mix__ssm_conv_s4__swiglu_ffn__prompt_kernel_noclr:
    s_and_b32 s61, s32, 1
    s_cmp_eq_u32 s61, 0
    s_cselect_b32 s52, s84, s86
    s_cselect_b32 s53, s85, s87
    s_and_b32 s53, s53, 0xffff
    s_mov_b32 s54, 0x700000
    s_mov_b32 s55, 0x00020000
    s_mov_b32 s44, s88
    s_and_b32 s45, s89, 0xffff
    s_mov_b32 s46, 0x700000
    s_mov_b32 s47, 0x00020000
    s_mov_b32 s37, 0
    s_mov_b32 s38, 0
    s_mov_b32 s43, 0
    s_lshr_b32 s61, s35, 4
    s_mul_i32 s37, s61, 3670016
    s_lshl_b32 s38, s61, 10
    s_add_u32 s19, s37, 1835008
    s_mov_b32 s16, 33554432
    s_mov_b32 s17, 33570816
    s_cmp_eq_u32 s32, 0
    s_cselect_b32 s18, s2, 0x7ff00000
    s_add_u32 s39, s40, 15360
    s_mov_b32 s41, 1
    s_mov_b32 s42, s60
    buffer_load_dword v1, v25, s[52:55], s37 offen
    s_lshr_b32 s61, s32, 1
    s_mul_i32 s61, s61, 229376
    s_mul_i32 s62, s35, 224
    s_add_u32 s61, s61, s62
    v_add_u32 v26, 0, v0
    v_mul_u32_u24 v27, 4682, v26
    v_lshrrev_b32 v27, 16, v27
    v_mul_u32_u24 v28, 14, v27
    v_sub_u32 v26, v26, v28
    v_bfe_u32 v28, v27, 3, 1
    v_lshlrev_b32 v28, 2, v28
    v_xor_b32 v27, v27, v28
    v_mul_u32_u24 v27, 7168, v27
    v_lshlrev_b32 v26, 4, v26
    v_add3_u32 v2, v27, v26, s61
    v_add_u32 v26, 64, v0
    v_mul_u32_u24 v27, 4682, v26
    v_lshrrev_b32 v27, 16, v27
    v_mul_u32_u24 v28, 14, v27
    v_sub_u32 v26, v26, v28
    v_bfe_u32 v28, v27, 3, 1
    v_lshlrev_b32 v28, 2, v28
    v_xor_b32 v27, v27, v28
    v_mul_u32_u24 v27, 7168, v27
    v_lshlrev_b32 v26, 4, v26
    v_add3_u32 v3, v27, v26, s61
    v_add_u32 v26, 128, v0
    v_mul_u32_u24 v27, 4682, v26
    v_lshrrev_b32 v27, 16, v27
    v_mul_u32_u24 v28, 14, v27
    v_sub_u32 v26, v26, v28
    v_bfe_u32 v28, v27, 3, 1
    v_lshlrev_b32 v28, 2, v28
    v_xor_b32 v27, v27, v28
    v_mul_u32_u24 v27, 7168, v27
    v_lshlrev_b32 v26, 4, v26
    v_add3_u32 v4, v27, v26, s61
    v_add_u32 v26, 192, v0
    v_mul_u32_u24 v27, 4682, v26
    v_lshrrev_b32 v27, 16, v27
    v_mul_u32_u24 v28, 14, v27
    v_sub_u32 v26, v26, v28
    v_bfe_u32 v28, v27, 3, 1
    v_lshlrev_b32 v28, 2, v28
    v_xor_b32 v27, v27, v28
    v_mul_u32_u24 v27, 7168, v27
    v_lshlrev_b32 v26, 4, v26
    v_add3_u32 v5, v27, v26, s61
    v_add_u32 v26, 256, v0
    v_mul_u32_u24 v27, 4682, v26
    v_lshrrev_b32 v27, 16, v27
    v_mul_u32_u24 v28, 14, v27
    v_sub_u32 v26, v26, v28
    v_bfe_u32 v28, v27, 3, 1
    v_lshlrev_b32 v28, 2, v28
    v_xor_b32 v27, v27, v28
    v_mul_u32_u24 v27, 7168, v27
    v_lshlrev_b32 v26, 4, v26
    v_add3_u32 v6, v27, v26, s61
    v_add_u32 v26, 320, v0
    v_mul_u32_u24 v27, 4682, v26
    v_lshrrev_b32 v27, 16, v27
    v_mul_u32_u24 v28, 14, v27
    v_sub_u32 v26, v26, v28
    v_bfe_u32 v28, v27, 3, 1
    v_lshlrev_b32 v28, 2, v28
    v_xor_b32 v27, v27, v28
    v_mul_u32_u24 v27, 7168, v27
    v_lshlrev_b32 v26, 4, v26
    v_add3_u32 v7, v27, v26, s61
    v_add_u32 v26, 384, v0
    v_mul_u32_u24 v27, 4682, v26
    v_lshrrev_b32 v27, 16, v27
    v_mul_u32_u24 v28, 14, v27
    v_sub_u32 v26, v26, v28
    v_bfe_u32 v28, v27, 3, 1
    v_lshlrev_b32 v28, 2, v28
    v_xor_b32 v27, v27, v28
    v_mul_u32_u24 v27, 7168, v27
    v_lshlrev_b32 v26, 4, v26
    v_add3_u32 v8, v27, v26, s61
    v_lshrrev_b32 v26, 4, v0
    v_bfe_u32 v27, v0, 2, 2
    v_lshl_add_u32 v27, v26, 3, v27
    v_and_b32 v26, 1, v26
    v_lshlrev_b32 v26, 2, v26
    v_and_b32 v28, 3, v0
    v_lshlrev_b32 v28, 3, v28
    v_add_u32 v28, 15360, v28
    v_add_u32 v29, v27, v26
    v_mul_u32_u24 v29, 224, v29
    v_add_u32 v17, v29, v28
    v_xor_b32 v26, 4, v26
    v_add_u32 v29, v27, v26
    v_mul_u32_u24 v29, 224, v29
    v_add_u32 v18, v29, v28
    v_add_u32 v19, 81920, v17
    v_add_u32 v20, 81920, v18
    v_and_b32 v26, 15, v0
    v_lshlrev_b32 v27, 7, v26
    v_add_u32 v27, s40, v27
    v_lshrrev_b32 v26, 1, v26
    v_lshrrev_b32 v28, 4, v0
    v_xor_b32 v26, v26, v28
    v_lshl_add_u32 v21, v26, 4, v27
    v_xor_b32 v22, 64, v21
    v_lshlrev_b32 v46, 3, v0
    v_add_u32 v46, s40, v46
    s_mov_b32 s60, 0x3fb8aa3b
    s_mov_b32 s61, 0x3fb8aa3b
    s_mov_b32 s62, 0x3e22f983
    s_mov_b32 s63, 0x3e22f983
    v_and_b32 v136, 31, v0
    v_lshrrev_b32 v137, 3, v136
    v_and_b32 v138, 7, v136
    v_lshrrev_b32 v139, 5, v0
    v_lshlrev_b32 v139, 4, v139
    v_add_u32 v139, s40, v139
    v_cmp_lt_u32 vcc, 4, v138
    v_lshlrev_b32 v140, 1, v137
    s_nop 0
    v_addc_co_u32 v140, vcc, 19, v140, vcc
    v_mul_u32_u24 v140, 528, v140
    v_add_u32 v27, v140, v139
    v_mov_b32 v140, 0x76543210
    v_mov_b32 v141, 0
    v_mov_b32 v142, 0x43222100
    v_mov_b32 v143, 0x22111000
    v_cmp_eq_u32 vcc, 1, v137
    s_nop 1
    v_cndmask_b32 v140, v140, v142, vcc
    v_cndmask_b32 v141, v141, 8, vcc
    v_cmp_eq_u32 vcc, 2, v137
    s_nop 1
    v_cndmask_b32 v140, v140, v143, vcc
    v_cndmask_b32 v141, v141, 13, vcc
    v_cmp_eq_u32 vcc, 3, v137
    s_nop 1
    v_cndmask_b32 v140, v140, v143, vcc
    v_cndmask_b32 v141, v141, 16, vcc
    v_lshlrev_b32 v138, 2, v138
    v_bfe_u32 v140, v140, v138, 4
    v_add_u32 v140, v140, v141
    v_mul_u32_u24 v140, 528, v140
    v_add_u32 v26, v140, v139
    v_mul_u32_u24 v140, 528, v136
    v_add_u32 v28, v140, v139
    v_mov_b32 v136, 0x3f803f80
    v_mov_b32 v137, 0
    ds_write_b64 v46, v[136:137] offset:14256
    s_waitcnt vmcnt(2)
    v_lshlrev_b32 v40, 16, v40
    v_mul_f32 v40, s60, v40
    v_exp_f32 v40, v40
    v_lshlrev_b32 v41, 16, v41
    v_cvt_pk_bf16_f32 v40, v40, v40
    v_and_b32 v50, 0xffff0000, v40
    v_mov_b32 v51, v50
    v_readfirstlane_b32 s26, v41
    v_lshlrev_b32 v52, 16, v34
    v_and_b32 v53, 0xffff0000, v34
    v_lshlrev_b32 v54, 16, v35
    v_and_b32 v55, 0xffff0000, v35
    v_lshlrev_b32 v56, 16, v36
    v_and_b32 v57, 0xffff0000, v36
    v_lshlrev_b32 v58, 16, v37
    v_and_b32 v59, 0xffff0000, v37
    v_lshlrev_b32 v60, 16, v38
    v_and_b32 v61, 0xffff0000, v38
    v_lshlrev_b32 v62, 16, v39
    v_and_b32 v63, 0xffff0000, v39
    v_pk_mul_f32 v[52:53], v[52:53], v[50:51]
    v_pk_mul_f32 v[54:55], v[54:55], v[50:51]
    v_pk_mul_f32 v[56:57], v[56:57], v[50:51]
    v_pk_mul_f32 v[58:59], v[58:59], v[50:51]
    v_pk_mul_f32 v[52:53], v[52:53], s[60:61]
    v_pk_mul_f32 v[54:55], v[54:55], s[62:63]
    v_pk_mul_f32 v[76:77], v[60:61], v[56:57]
    v_pk_mul_f32 v[78:79], v[60:61], v[58:59]
    v_pk_fma_f32 v[76:77], v[62:63], v[58:59], v[76:77] neg_lo:[1,0,0] neg_hi:[1,0,0]
    v_pk_fma_f32 v[78:79], v[62:63], v[56:57], v[78:79]
    v_mul_f32 v136, 0x41000000, v52
    v_mul_f32 v137, 0x41000000, v54
    v_fract_f32 v137, v137
    v_mul_f32 v140, 0x41000000, v53
    v_mul_f32 v141, 0x41000000, v55
    v_fract_f32 v141, v141
    v_mul_f32 v144, 1.0, v52
    v_mul_f32 v145, 1.0, v54
    v_fract_f32 v145, v145
    v_mul_f32 v148, 1.0, v53
    v_mul_f32 v149, 1.0, v55
    v_fract_f32 v149, v149
    v_mul_f32 v152, 0x43800000, v52
    v_mul_f32 v153, 0x43800000, v54
    v_fract_f32 v153, v153
    v_mul_f32 v156, 0x43800000, v53
    v_mul_f32 v157, 0x43800000, v55
    v_fract_f32 v157, v157
    v_exp_f32 v136, v136
    v_cos_f32 v138, v137
    v_sin_f32 v139, v137
    v_exp_f32 v140, v140
    v_cos_f32 v142, v141
    v_sin_f32 v143, v141
    v_exp_f32 v144, v144
    v_cos_f32 v146, v145
    v_sin_f32 v147, v145
    v_exp_f32 v148, v148
    v_cos_f32 v150, v149
    v_sin_f32 v151, v149
    v_exp_f32 v152, v152
    v_cos_f32 v154, v153
    v_sin_f32 v155, v153
    v_exp_f32 v156, v156
    v_cos_f32 v158, v157
    v_sin_f32 v159, v157
    v_mul_f32 v68, v136, v138
    v_mul_f32 v70, v136, v139
    v_mul_f32 v69, v140, v142
    v_mul_f32 v71, v140, v143
    v_mul_f32 v64, v144, v146
    v_mul_f32 v66, v144, v147
    v_mul_f32 v65, v148, v150
    v_mul_f32 v67, v148, v151
    v_mul_f32 v72, v152, v154
    v_mul_f32 v74, v152, v155
    v_mul_f32 v73, v156, v158
    v_mul_f32 v75, v156, v159
    v_cvt_pk_bf16_f32 v34, v68, v69
    v_cvt_pk_bf16_f32 v35, v70, v71
    ds_write_b64 v46, v[34:35] offset:14784
    buffer_load_dwordx4 v[208:211], v45, s[12:15], 0 offen
    v_cvt_pk_bf16_f32 v36, v76, v77
    v_cvt_pk_bf16_f32 v37, -v78, -v79
    ds_write_b64 v46, v[36:37] offset:0
    v_pk_mul_f32 v[136:137], v[76:77], v[64:65]
    v_pk_mul_f32 v[138:139], v[76:77], v[66:67]
    v_pk_fma_f32 v[136:137], v[78:79], v[66:67], v[136:137] neg_lo:[1,0,0] neg_hi:[1,0,0]
    v_pk_fma_f32 v[138:139], v[78:79], v[64:65], v[138:139]
    v_cvt_pk_bf16_f32 v38, v136, v137
    v_cvt_pk_bf16_f32 v39, -v138, -v139
    ds_write_b64 v46, v[38:39] offset:528
    buffer_load_dwordx4 v[212:215], v45, s[12:15], 0 offen offset:1024
    v_pk_mul_f32 v[140:141], v[68:69], v[68:69]
    v_pk_mul_f32 v[142:143], v[68:69], v[70:71]
    v_pk_fma_f32 v[140:141], v[70:71], v[70:71], v[140:141] neg_lo:[1,0,0] neg_hi:[1,0,0]
    v_pk_fma_f32 v[142:143], v[70:71], v[68:69], v[142:143]
    v_cvt_pk_bf16_f32 v34, v140, v141
    v_cvt_pk_bf16_f32 v35, v142, v143
    ds_write_b64 v46, v[34:35] offset:15312
    v_pk_mul_f32 v[80:81], v[136:137], v[64:65]
    v_pk_mul_f32 v[82:83], v[136:137], v[66:67]
    v_pk_fma_f32 v[80:81], v[138:139], v[66:67], v[80:81] neg_lo:[1,0,0] neg_hi:[1,0,0]
    v_pk_fma_f32 v[82:83], v[138:139], v[64:65], v[82:83]
    v_cvt_pk_bf16_f32 v36, v80, v81
    v_cvt_pk_bf16_f32 v37, -v82, -v83
    ds_write_b64 v46, v[36:37] offset:1056
    buffer_load_dwordx4 v[192:195], v45, s[48:51], s42 offen offset:0
    v_pk_mul_f32 v[144:145], v[140:141], v[68:69]
    v_pk_mul_f32 v[146:147], v[140:141], v[70:71]
    v_pk_fma_f32 v[144:145], v[142:143], v[70:71], v[144:145] neg_lo:[1,0,0] neg_hi:[1,0,0]
    v_pk_fma_f32 v[146:147], v[142:143], v[68:69], v[146:147]
    v_cvt_pk_bf16_f32 v38, v144, v145
    v_cvt_pk_bf16_f32 v39, v146, v147
    ds_write_b64 v46, v[38:39] offset:15840
    v_pk_mul_f32 v[136:137], v[80:81], v[64:65]
    v_pk_mul_f32 v[138:139], v[80:81], v[66:67]
    v_pk_fma_f32 v[136:137], v[82:83], v[66:67], v[136:137] neg_lo:[1,0,0] neg_hi:[1,0,0]
    v_pk_fma_f32 v[138:139], v[82:83], v[64:65], v[138:139]
    v_cvt_pk_bf16_f32 v34, v136, v137
    v_cvt_pk_bf16_f32 v35, -v138, -v139
    ds_write_b64 v46, v[34:35] offset:1584
    buffer_load_dwordx4 v[196:199], v45, s[48:51], s42 offen offset:1024
    v_pk_mul_f32 v[140:141], v[144:145], v[68:69]
    v_pk_mul_f32 v[142:143], v[144:145], v[70:71]
    v_pk_fma_f32 v[140:141], v[146:147], v[70:71], v[140:141] neg_lo:[1,0,0] neg_hi:[1,0,0]
    v_pk_fma_f32 v[142:143], v[146:147], v[68:69], v[142:143]
    v_cvt_pk_bf16_f32 v36, v140, v141
    v_cvt_pk_bf16_f32 v37, v142, v143
    ds_write_b64 v46, v[36:37] offset:16368
    v_pk_mul_f32 v[84:85], v[136:137], v[64:65]
    v_pk_mul_f32 v[86:87], v[136:137], v[66:67]
    v_pk_fma_f32 v[84:85], v[138:139], v[66:67], v[84:85] neg_lo:[1,0,0] neg_hi:[1,0,0]
    v_pk_fma_f32 v[86:87], v[138:139], v[64:65], v[86:87]
    v_cvt_pk_bf16_f32 v38, v84, v85
    v_cvt_pk_bf16_f32 v39, -v86, -v87
    ds_write_b64 v46, v[38:39] offset:2112
    buffer_load_dwordx4 v[200:203], v45, s[48:51], s42 offen offset:2048
    v_pk_mul_f32 v[144:145], v[140:141], v[68:69]
    v_pk_mul_f32 v[146:147], v[140:141], v[70:71]
    v_pk_fma_f32 v[144:145], v[142:143], v[70:71], v[144:145] neg_lo:[1,0,0] neg_hi:[1,0,0]
    v_pk_fma_f32 v[146:147], v[142:143], v[68:69], v[146:147]
    v_cvt_pk_bf16_f32 v34, v144, v145
    v_cvt_pk_bf16_f32 v35, v146, v147
    ds_write_b64 v46, v[34:35] offset:16896
    v_pk_mul_f32 v[136:137], v[84:85], v[64:65]
    v_pk_mul_f32 v[138:139], v[84:85], v[66:67]
    v_pk_fma_f32 v[136:137], v[86:87], v[66:67], v[136:137] neg_lo:[1,0,0] neg_hi:[1,0,0]
    v_pk_fma_f32 v[138:139], v[86:87], v[64:65], v[138:139]
    v_cvt_pk_bf16_f32 v36, v136, v137
    v_cvt_pk_bf16_f32 v37, -v138, -v139
    ds_write_b64 v46, v[36:37] offset:2640
    buffer_load_dwordx4 v[204:207], v45, s[48:51], s42 offen offset:3072
    v_pk_mul_f32 v[140:141], v[144:145], v[68:69]
    v_pk_mul_f32 v[142:143], v[144:145], v[70:71]
    v_pk_fma_f32 v[140:141], v[146:147], v[70:71], v[140:141] neg_lo:[1,0,0] neg_hi:[1,0,0]
    v_pk_fma_f32 v[142:143], v[146:147], v[68:69], v[142:143]
    v_cvt_pk_bf16_f32 v38, v140, v141
    v_cvt_pk_bf16_f32 v39, v142, v143
    ds_write_b64 v46, v[38:39] offset:17424
    v_pk_mul_f32 v[88:89], v[136:137], v[64:65]
    v_pk_mul_f32 v[90:91], v[136:137], v[66:67]
    v_pk_fma_f32 v[88:89], v[138:139], v[66:67], v[88:89] neg_lo:[1,0,0] neg_hi:[1,0,0]
    v_pk_fma_f32 v[90:91], v[138:139], v[64:65], v[90:91]
    v_cvt_pk_bf16_f32 v34, v88, v89
    v_cvt_pk_bf16_f32 v35, -v90, -v91
    ds_write_b64 v46, v[34:35] offset:3168
    s_add_u32 m0, s40, 32768
    s_nop 0
    buffer_load_dwordx4 v9, s[48:51], s38 offen lds
    v_pk_mul_f32 v[144:145], v[140:141], v[68:69]
    v_pk_mul_f32 v[146:147], v[140:141], v[70:71]
    v_pk_fma_f32 v[144:145], v[142:143], v[70:71], v[144:145] neg_lo:[1,0,0] neg_hi:[1,0,0]
    v_pk_fma_f32 v[146:147], v[142:143], v[68:69], v[146:147]
    v_cvt_pk_bf16_f32 v36, v144, v145
    v_cvt_pk_bf16_f32 v37, v146, v147
    ds_write_b64 v46, v[36:37] offset:17952
    v_pk_mul_f32 v[136:137], v[88:89], v[64:65]
    v_pk_mul_f32 v[138:139], v[88:89], v[66:67]
    v_pk_fma_f32 v[136:137], v[90:91], v[66:67], v[136:137] neg_lo:[1,0,0] neg_hi:[1,0,0]
    v_pk_fma_f32 v[138:139], v[90:91], v[64:65], v[138:139]
    v_cvt_pk_bf16_f32 v38, v136, v137
    v_cvt_pk_bf16_f32 v39, -v138, -v139
    ds_write_b64 v46, v[38:39] offset:3696
    s_add_u32 m0, s40, 33792
    s_nop 0
    buffer_load_dwordx4 v10, s[48:51], s38 offen lds
    v_pk_mul_f32 v[140:141], v[144:145], v[68:69]
    v_pk_mul_f32 v[142:143], v[144:145], v[70:71]
    v_pk_fma_f32 v[140:141], v[146:147], v[70:71], v[140:141] neg_lo:[1,0,0] neg_hi:[1,0,0]
    v_pk_fma_f32 v[142:143], v[146:147], v[68:69], v[142:143]
    v_cvt_pk_bf16_f32 v34, v140, v141
    v_cvt_pk_bf16_f32 v35, v142, v143
    ds_write_b64 v46, v[34:35] offset:18480
    v_pk_mul_f32 v[92:93], v[136:137], v[64:65]
    v_pk_mul_f32 v[94:95], v[136:137], v[66:67]
    v_pk_fma_f32 v[92:93], v[138:139], v[66:67], v[92:93] neg_lo:[1,0,0] neg_hi:[1,0,0]
    v_pk_fma_f32 v[94:95], v[138:139], v[64:65], v[94:95]
    v_pk_mul_f32 v[144:145], v[140:141], v[68:69]
    v_pk_mul_f32 v[146:147], v[140:141], v[70:71]
    v_pk_fma_f32 v[144:145], v[142:143], v[70:71], v[144:145] neg_lo:[1,0,0] neg_hi:[1,0,0]
    v_pk_fma_f32 v[146:147], v[142:143], v[68:69], v[146:147]
    v_cvt_pk_bf16_f32 v36, v144, v145
    v_cvt_pk_bf16_f32 v37, v146, v147
    ds_write_b64 v46, v[36:37] offset:19008
    s_add_u32 m0, s40, 34816
    s_nop 0
    buffer_load_dwordx4 v11, s[48:51], s38 offen lds
    v_pk_mul_f32 v[148:149], v[76:77], v[72:73]
    v_pk_mul_f32 v[150:151], v[76:77], v[74:75]
    v_pk_fma_f32 v[148:149], v[78:79], v[74:75], v[148:149] neg_lo:[1,0,0] neg_hi:[1,0,0]
    v_pk_fma_f32 v[150:151], v[78:79], v[72:73], v[150:151]
    v_cvt_pk_bf16_f32 v38, v148, v149
    v_cvt_pk_bf16_f32 v39, -v150, -v151
    ds_write_b64 v46, v[38:39] offset:4224
    v_pk_mul_f32 v[140:141], v[144:145], v[68:69]
    v_pk_mul_f32 v[142:143], v[144:145], v[70:71]
    v_pk_fma_f32 v[140:141], v[146:147], v[70:71], v[140:141] neg_lo:[1,0,0] neg_hi:[1,0,0]
    v_pk_fma_f32 v[142:143], v[146:147], v[68:69], v[142:143]
    v_cvt_pk_bf16_f32 v34, v140, v141
    v_cvt_pk_bf16_f32 v35, v142, v143
    ds_write_b64 v46, v[34:35] offset:19536
    s_add_u32 m0, s40, 35840
    s_nop 0
    buffer_load_dwordx4 v12, s[48:51], s38 offen lds
    v_pk_mul_f32 v[136:137], v[80:81], v[72:73]
    v_pk_mul_f32 v[138:139], v[80:81], v[74:75]
    v_pk_fma_f32 v[136:137], v[82:83], v[74:75], v[136:137] neg_lo:[1,0,0] neg_hi:[1,0,0]
    v_pk_fma_f32 v[138:139], v[82:83], v[72:73], v[138:139]
    v_cvt_pk_bf16_f32 v36, v136, v137
    v_cvt_pk_bf16_f32 v37, -v138, -v139
    ds_write_b64 v46, v[36:37] offset:4752
    v_pk_mul_f32 v[144:145], v[140:141], v[68:69]
    v_pk_mul_f32 v[146:147], v[140:141], v[70:71]
    v_pk_fma_f32 v[144:145], v[142:143], v[70:71], v[144:145] neg_lo:[1,0,0] neg_hi:[1,0,0]
    v_pk_fma_f32 v[146:147], v[142:143], v[68:69], v[146:147]
    v_cvt_pk_bf16_f32 v38, v144, v145
    v_cvt_pk_bf16_f32 v39, v146, v147
    ds_write_b64 v46, v[38:39] offset:20064
    s_add_u32 m0, s40, 36864
    s_nop 0
    buffer_load_dwordx4 v13, s[48:51], s38 offen lds
    v_pk_mul_f32 v[152:153], v[84:85], v[72:73]
    v_pk_mul_f32 v[154:155], v[84:85], v[74:75]
    v_pk_fma_f32 v[152:153], v[86:87], v[74:75], v[152:153] neg_lo:[1,0,0] neg_hi:[1,0,0]
    v_pk_fma_f32 v[154:155], v[86:87], v[72:73], v[154:155]
    v_cvt_pk_bf16_f32 v34, v152, v153
    v_cvt_pk_bf16_f32 v35, -v154, -v155
    ds_write_b64 v46, v[34:35] offset:5280
    v_pk_mul_f32 v[140:141], v[144:145], v[68:69]
    v_pk_mul_f32 v[142:143], v[144:145], v[70:71]
    v_pk_fma_f32 v[140:141], v[146:147], v[70:71], v[140:141] neg_lo:[1,0,0] neg_hi:[1,0,0]
    v_pk_fma_f32 v[142:143], v[146:147], v[68:69], v[142:143]
    v_cvt_pk_bf16_f32 v36, v140, v141
    v_cvt_pk_bf16_f32 v37, v142, v143
    ds_write_b64 v46, v[36:37] offset:20592
    s_add_u32 m0, s40, 37888
    s_nop 0
    buffer_load_dwordx4 v14, s[48:51], s38 offen lds
    v_pk_mul_f32 v[136:137], v[88:89], v[72:73]
    v_pk_mul_f32 v[138:139], v[88:89], v[74:75]
    v_pk_fma_f32 v[136:137], v[90:91], v[74:75], v[136:137] neg_lo:[1,0,0] neg_hi:[1,0,0]
    v_pk_fma_f32 v[138:139], v[90:91], v[72:73], v[138:139]
    v_cvt_pk_bf16_f32 v38, v136, v137
    v_cvt_pk_bf16_f32 v39, -v138, -v139
    ds_write_b64 v46, v[38:39] offset:5808
    v_pk_mul_f32 v[144:145], v[140:141], v[68:69]
    v_pk_mul_f32 v[146:147], v[140:141], v[70:71]
    v_pk_fma_f32 v[144:145], v[142:143], v[70:71], v[144:145] neg_lo:[1,0,0] neg_hi:[1,0,0]
    v_pk_fma_f32 v[146:147], v[142:143], v[68:69], v[146:147]
    v_cvt_pk_bf16_f32 v34, v144, v145
    v_cvt_pk_bf16_f32 v35, v146, v147
    ds_write_b64 v46, v[34:35] offset:21120
    s_add_u32 m0, s40, 38912
    s_nop 0
    buffer_load_dwordx4 v15, s[48:51], s38 offen lds
    v_pk_mul_f32 v[156:157], v[92:93], v[72:73]
    v_pk_mul_f32 v[158:159], v[92:93], v[74:75]
    v_pk_fma_f32 v[156:157], v[94:95], v[74:75], v[156:157] neg_lo:[1,0,0] neg_hi:[1,0,0]
    v_pk_fma_f32 v[158:159], v[94:95], v[72:73], v[158:159]
    v_cvt_pk_bf16_f32 v36, v156, v157
    v_cvt_pk_bf16_f32 v37, -v158, -v159
    ds_write_b64 v46, v[36:37] offset:6336
    v_pk_mul_f32 v[140:141], v[144:145], v[68:69]
    v_pk_mul_f32 v[142:143], v[144:145], v[70:71]
    v_pk_fma_f32 v[140:141], v[146:147], v[70:71], v[140:141] neg_lo:[1,0,0] neg_hi:[1,0,0]
    v_pk_fma_f32 v[142:143], v[146:147], v[68:69], v[142:143]
    v_cvt_pk_bf16_f32 v38, v140, v141
    v_cvt_pk_bf16_f32 v39, v142, v143
    ds_write_b64 v46, v[38:39] offset:21648
    s_add_u32 m0, s40, 39936
    s_nop 0
    buffer_load_dwordx4 v16, s[48:51], s38 offen lds
    v_pk_mul_f32 v[76:77], v[148:149], v[72:73]
    v_pk_mul_f32 v[78:79], v[148:149], v[74:75]
    v_pk_fma_f32 v[76:77], v[150:151], v[74:75], v[76:77] neg_lo:[1,0,0] neg_hi:[1,0,0]
    v_pk_fma_f32 v[78:79], v[150:151], v[72:73], v[78:79]
    v_cvt_pk_bf16_f32 v34, v76, v77
    v_cvt_pk_bf16_f32 v35, -v78, -v79
    ds_write_b64 v46, v[34:35] offset:6864
    v_pk_mul_f32 v[144:145], v[140:141], v[68:69]
    v_pk_mul_f32 v[146:147], v[140:141], v[70:71]
    v_pk_fma_f32 v[144:145], v[142:143], v[70:71], v[144:145] neg_lo:[1,0,0] neg_hi:[1,0,0]
    v_pk_fma_f32 v[146:147], v[142:143], v[68:69], v[146:147]
    v_cvt_pk_bf16_f32 v36, v144, v145
    v_cvt_pk_bf16_f32 v37, v146, v147
    ds_write_b64 v46, v[36:37] offset:22176
    buffer_load_dword v1, v23, s[52:55], s19 offen
    s_add_u32 s19, s19, 917504
    v_pk_mul_f32 v[84:85], v[152:153], v[72:73]
    v_pk_mul_f32 v[86:87], v[152:153], v[74:75]
    v_pk_fma_f32 v[84:85], v[154:155], v[74:75], v[84:85] neg_lo:[1,0,0] neg_hi:[1,0,0]
    v_pk_fma_f32 v[86:87], v[154:155], v[72:73], v[86:87]
    v_cvt_pk_bf16_f32 v38, v84, v85
    v_cvt_pk_bf16_f32 v39, -v86, -v87
    ds_write_b64 v46, v[38:39] offset:7392
    v_pk_mul_f32 v[140:141], v[144:145], v[68:69]
    v_pk_mul_f32 v[142:143], v[144:145], v[70:71]
    v_pk_fma_f32 v[140:141], v[146:147], v[70:71], v[140:141] neg_lo:[1,0,0] neg_hi:[1,0,0]
    v_pk_fma_f32 v[142:143], v[146:147], v[68:69], v[142:143]
    v_cvt_pk_bf16_f32 v34, v140, v141
    v_cvt_pk_bf16_f32 v35, v142, v143
    ds_write_b64 v46, v[34:35] offset:22704
    v_pk_mul_f32 v[92:93], v[156:157], v[72:73]
    v_pk_mul_f32 v[94:95], v[156:157], v[74:75]
    v_pk_fma_f32 v[92:93], v[158:159], v[74:75], v[92:93] neg_lo:[1,0,0] neg_hi:[1,0,0]
    v_pk_fma_f32 v[94:95], v[158:159], v[72:73], v[94:95]
    v_cvt_pk_bf16_f32 v36, v92, v93
    v_cvt_pk_bf16_f32 v37, -v94, -v95
    ds_write_b64 v46, v[36:37] offset:7920
    v_pk_mul_f32 v[144:145], v[140:141], v[68:69]
    v_pk_mul_f32 v[146:147], v[140:141], v[70:71]
    v_pk_fma_f32 v[144:145], v[142:143], v[70:71], v[144:145] neg_lo:[1,0,0] neg_hi:[1,0,0]
    v_pk_fma_f32 v[146:147], v[142:143], v[68:69], v[146:147]
    v_cvt_pk_bf16_f32 v38, v144, v145
    v_cvt_pk_bf16_f32 v39, v146, v147
    ds_write_b64 v46, v[38:39] offset:23232
    v_pk_mul_f32 v[148:149], v[76:77], v[72:73]
    v_pk_mul_f32 v[150:151], v[76:77], v[74:75]
    v_pk_fma_f32 v[148:149], v[78:79], v[74:75], v[148:149] neg_lo:[1,0,0] neg_hi:[1,0,0]
    v_pk_fma_f32 v[150:151], v[78:79], v[72:73], v[150:151]
    v_cvt_pk_bf16_f32 v34, v148, v149
    v_cvt_pk_bf16_f32 v35, -v150, -v151
    ds_write_b64 v46, v[34:35] offset:8448
    v_pk_mul_f32 v[140:141], v[144:145], v[68:69]
    v_pk_mul_f32 v[142:143], v[144:145], v[70:71]
    v_pk_fma_f32 v[140:141], v[146:147], v[70:71], v[140:141] neg_lo:[1,0,0] neg_hi:[1,0,0]
    v_pk_fma_f32 v[142:143], v[146:147], v[68:69], v[142:143]
    v_cvt_pk_bf16_f32 v36, v140, v141
    v_cvt_pk_bf16_f32 v37, v142, v143
    ds_write_b64 v46, v[36:37] offset:23760
    v_pk_mul_f32 v[152:153], v[84:85], v[72:73]
    v_pk_mul_f32 v[154:155], v[84:85], v[74:75]
    v_pk_fma_f32 v[152:153], v[86:87], v[74:75], v[152:153] neg_lo:[1,0,0] neg_hi:[1,0,0]
    v_pk_fma_f32 v[154:155], v[86:87], v[72:73], v[154:155]
    v_cvt_pk_bf16_f32 v38, v152, v153
    v_cvt_pk_bf16_f32 v39, -v154, -v155
    ds_write_b64 v46, v[38:39] offset:8976
    v_pk_mul_f32 v[144:145], v[140:141], v[68:69]
    v_pk_mul_f32 v[146:147], v[140:141], v[70:71]
    v_pk_fma_f32 v[144:145], v[142:143], v[70:71], v[144:145] neg_lo:[1,0,0] neg_hi:[1,0,0]
    v_pk_fma_f32 v[146:147], v[142:143], v[68:69], v[146:147]
    v_cvt_pk_bf16_f32 v34, v144, v145
    v_cvt_pk_bf16_f32 v35, v146, v147
    ds_write_b64 v46, v[34:35] offset:24288
    v_pk_mul_f32 v[156:157], v[92:93], v[72:73]
    v_pk_mul_f32 v[158:159], v[92:93], v[74:75]
    v_pk_fma_f32 v[156:157], v[94:95], v[74:75], v[156:157] neg_lo:[1,0,0] neg_hi:[1,0,0]
    v_pk_fma_f32 v[158:159], v[94:95], v[72:73], v[158:159]
    v_cvt_pk_bf16_f32 v36, v156, v157
    v_cvt_pk_bf16_f32 v37, -v158, -v159
    ds_write_b64 v46, v[36:37] offset:9504
    v_pk_mul_f32 v[140:141], v[144:145], v[68:69]
    v_pk_mul_f32 v[142:143], v[144:145], v[70:71]
    v_pk_fma_f32 v[140:141], v[146:147], v[70:71], v[140:141] neg_lo:[1,0,0] neg_hi:[1,0,0]
    v_pk_fma_f32 v[142:143], v[146:147], v[68:69], v[142:143]
    v_cvt_pk_bf16_f32 v38, v140, v141
    v_cvt_pk_bf16_f32 v39, v142, v143
    ds_write_b64 v46, v[38:39] offset:24816
    v_pk_mul_f32 v[76:77], v[148:149], v[72:73]
    v_pk_mul_f32 v[78:79], v[148:149], v[74:75]
    v_pk_fma_f32 v[76:77], v[150:151], v[74:75], v[76:77] neg_lo:[1,0,0] neg_hi:[1,0,0]
    v_pk_fma_f32 v[78:79], v[150:151], v[72:73], v[78:79]
    v_cvt_pk_bf16_f32 v34, v76, v77
    v_cvt_pk_bf16_f32 v35, -v78, -v79
    ds_write_b64 v46, v[34:35] offset:10032
    v_pk_mul_f32 v[144:145], v[140:141], v[68:69]
    v_pk_mul_f32 v[146:147], v[140:141], v[70:71]
    v_pk_fma_f32 v[144:145], v[142:143], v[70:71], v[144:145] neg_lo:[1,0,0] neg_hi:[1,0,0]
    v_pk_fma_f32 v[146:147], v[142:143], v[68:69], v[146:147]
    v_cvt_pk_bf16_f32 v36, v144, v145
    v_cvt_pk_bf16_f32 v37, v146, v147
    ds_write_b64 v46, v[36:37] offset:25344
    v_pk_mul_f32 v[92:93], v[156:157], v[72:73]
    v_pk_mul_f32 v[94:95], v[156:157], v[74:75]
    v_pk_fma_f32 v[92:93], v[158:159], v[74:75], v[92:93] neg_lo:[1,0,0] neg_hi:[1,0,0]
    v_pk_fma_f32 v[94:95], v[158:159], v[72:73], v[94:95]
    v_cvt_pk_bf16_f32 v38, v92, v93
    v_cvt_pk_bf16_f32 v39, -v94, -v95
    ds_write_b64 v46, v[38:39] offset:10560
    v_pk_mul_f32 v[140:141], v[144:145], v[68:69]
    v_pk_mul_f32 v[142:143], v[144:145], v[70:71]
    v_pk_fma_f32 v[140:141], v[146:147], v[70:71], v[140:141] neg_lo:[1,0,0] neg_hi:[1,0,0]
    v_pk_fma_f32 v[142:143], v[146:147], v[68:69], v[142:143]
    v_cvt_pk_bf16_f32 v34, v140, v141
    v_cvt_pk_bf16_f32 v35, v142, v143
    ds_write_b64 v46, v[34:35] offset:25872
    v_pk_mul_f32 v[148:149], v[76:77], v[72:73]
    v_pk_mul_f32 v[150:151], v[76:77], v[74:75]
    v_pk_fma_f32 v[148:149], v[78:79], v[74:75], v[148:149] neg_lo:[1,0,0] neg_hi:[1,0,0]
    v_pk_fma_f32 v[150:151], v[78:79], v[72:73], v[150:151]
    v_cvt_pk_bf16_f32 v36, v148, v149
    v_cvt_pk_bf16_f32 v37, -v150, -v151
    ds_write_b64 v46, v[36:37] offset:11088
    v_pk_mul_f32 v[144:145], v[140:141], v[68:69]
    v_pk_mul_f32 v[146:147], v[140:141], v[70:71]
    v_pk_fma_f32 v[144:145], v[142:143], v[70:71], v[144:145] neg_lo:[1,0,0] neg_hi:[1,0,0]
    v_pk_fma_f32 v[146:147], v[142:143], v[68:69], v[146:147]
    v_cvt_pk_bf16_f32 v38, v144, v145
    v_cvt_pk_bf16_f32 v39, v146, v147
    ds_write_b64 v46, v[38:39] offset:26400
    v_pk_mul_f32 v[156:157], v[92:93], v[72:73]
    v_pk_mul_f32 v[158:159], v[92:93], v[74:75]
    v_pk_fma_f32 v[156:157], v[94:95], v[74:75], v[156:157] neg_lo:[1,0,0] neg_hi:[1,0,0]
    v_pk_fma_f32 v[158:159], v[94:95], v[72:73], v[158:159]
    v_cvt_pk_bf16_f32 v34, v156, v157
    v_cvt_pk_bf16_f32 v35, -v158, -v159
    ds_write_b64 v46, v[34:35] offset:11616
    v_pk_mul_f32 v[140:141], v[144:145], v[68:69]
    v_pk_mul_f32 v[142:143], v[144:145], v[70:71]
    v_pk_fma_f32 v[140:141], v[146:147], v[70:71], v[140:141] neg_lo:[1,0,0] neg_hi:[1,0,0]
    v_pk_fma_f32 v[142:143], v[146:147], v[68:69], v[142:143]
    v_cvt_pk_bf16_f32 v36, v140, v141
    v_cvt_pk_bf16_f32 v37, v142, v143
    ds_write_b64 v46, v[36:37] offset:26928
    v_pk_mul_f32 v[76:77], v[148:149], v[72:73]
    v_pk_mul_f32 v[78:79], v[148:149], v[74:75]
    v_pk_fma_f32 v[76:77], v[150:151], v[74:75], v[76:77] neg_lo:[1,0,0] neg_hi:[1,0,0]
    v_pk_fma_f32 v[78:79], v[150:151], v[72:73], v[78:79]
    v_cvt_pk_bf16_f32 v38, v76, v77
    v_cvt_pk_bf16_f32 v39, -v78, -v79
    ds_write_b64 v46, v[38:39] offset:12144
    v_pk_mul_f32 v[144:145], v[140:141], v[68:69]
    v_pk_mul_f32 v[146:147], v[140:141], v[70:71]
    v_pk_fma_f32 v[144:145], v[142:143], v[70:71], v[144:145] neg_lo:[1,0,0] neg_hi:[1,0,0]
    v_pk_fma_f32 v[146:147], v[142:143], v[68:69], v[146:147]
    v_cvt_pk_bf16_f32 v34, v144, v145
    v_cvt_pk_bf16_f32 v35, v146, v147
    ds_write_b64 v46, v[34:35] offset:27456
    v_pk_mul_f32 v[92:93], v[156:157], v[72:73]
    v_pk_mul_f32 v[94:95], v[156:157], v[74:75]
    v_pk_fma_f32 v[92:93], v[158:159], v[74:75], v[92:93] neg_lo:[1,0,0] neg_hi:[1,0,0]
    v_pk_fma_f32 v[94:95], v[158:159], v[72:73], v[94:95]
    v_cvt_pk_bf16_f32 v36, v92, v93
    v_cvt_pk_bf16_f32 v37, -v94, -v95
    ds_write_b64 v46, v[36:37] offset:12672
    v_pk_mul_f32 v[140:141], v[144:145], v[68:69]
    v_pk_mul_f32 v[142:143], v[144:145], v[70:71]
    v_pk_fma_f32 v[140:141], v[146:147], v[70:71], v[140:141] neg_lo:[1,0,0] neg_hi:[1,0,0]
    v_pk_fma_f32 v[142:143], v[146:147], v[68:69], v[142:143]
    v_cvt_pk_bf16_f32 v38, v140, v141
    v_cvt_pk_bf16_f32 v39, v142, v143
    ds_write_b64 v46, v[38:39] offset:27984
    v_pk_mul_f32 v[148:149], v[76:77], v[72:73]
    v_pk_mul_f32 v[150:151], v[76:77], v[74:75]
    v_pk_fma_f32 v[148:149], v[78:79], v[74:75], v[148:149] neg_lo:[1,0,0] neg_hi:[1,0,0]
    v_pk_fma_f32 v[150:151], v[78:79], v[72:73], v[150:151]
    v_cvt_pk_bf16_f32 v34, v148, v149
    v_cvt_pk_bf16_f32 v35, -v150, -v151
    ds_write_b64 v46, v[34:35] offset:13200
    v_pk_mul_f32 v[144:145], v[140:141], v[68:69]
    v_pk_mul_f32 v[146:147], v[140:141], v[70:71]
    v_pk_fma_f32 v[144:145], v[142:143], v[70:71], v[144:145] neg_lo:[1,0,0] neg_hi:[1,0,0]
    v_pk_fma_f32 v[146:147], v[142:143], v[68:69], v[146:147]
    v_cvt_pk_bf16_f32 v36, v144, v145
    v_cvt_pk_bf16_f32 v37, v146, v147
    ds_write_b64 v46, v[36:37] offset:28512
    v_pk_mul_f32 v[156:157], v[92:93], v[72:73]
    v_pk_mul_f32 v[158:159], v[92:93], v[74:75]
    v_pk_fma_f32 v[156:157], v[94:95], v[74:75], v[156:157] neg_lo:[1,0,0] neg_hi:[1,0,0]
    v_pk_fma_f32 v[158:159], v[94:95], v[72:73], v[158:159]
    v_cvt_pk_bf16_f32 v38, v156, v157
    v_cvt_pk_bf16_f32 v39, -v158, -v159
    ds_write_b64 v46, v[38:39] offset:13728
    v_pk_mul_f32 v[140:141], v[144:145], v[68:69]
    v_pk_mul_f32 v[142:143], v[144:145], v[70:71]
    v_pk_fma_f32 v[140:141], v[146:147], v[70:71], v[140:141] neg_lo:[1,0,0] neg_hi:[1,0,0]
    v_pk_fma_f32 v[142:143], v[146:147], v[68:69], v[142:143]
    v_cvt_pk_bf16_f32 v34, v140, v141
    v_cvt_pk_bf16_f32 v35, v142, v143
    ds_write_b64 v46, v[34:35] offset:29040
    v_pk_mul_f32 v[144:145], v[140:141], v[68:69]
    v_pk_mul_f32 v[146:147], v[140:141], v[70:71]
    v_pk_fma_f32 v[144:145], v[142:143], v[70:71], v[144:145] neg_lo:[1,0,0] neg_hi:[1,0,0]
    v_pk_fma_f32 v[146:147], v[142:143], v[68:69], v[146:147]
    v_cvt_pk_bf16_f32 v36, v144, v145
    v_cvt_pk_bf16_f32 v37, v146, v147
    ds_write_b64 v46, v[36:37] offset:29568
    v_pk_mul_f32 v[140:141], v[144:145], v[68:69]
    v_pk_mul_f32 v[142:143], v[144:145], v[70:71]
    v_pk_fma_f32 v[140:141], v[146:147], v[70:71], v[140:141] neg_lo:[1,0,0] neg_hi:[1,0,0]
    v_pk_fma_f32 v[142:143], v[146:147], v[68:69], v[142:143]
    v_cvt_pk_bf16_f32 v38, v140, v141
    v_cvt_pk_bf16_f32 v39, v142, v143
    ds_write_b64 v46, v[38:39] offset:30096
    v_pk_mul_f32 v[144:145], v[140:141], v[68:69]
    v_pk_mul_f32 v[146:147], v[140:141], v[70:71]
    v_pk_fma_f32 v[144:145], v[142:143], v[70:71], v[144:145] neg_lo:[1,0,0] neg_hi:[1,0,0]
    v_pk_fma_f32 v[146:147], v[142:143], v[68:69], v[146:147]
    v_cvt_pk_bf16_f32 v34, v144, v145
    v_cvt_pk_bf16_f32 v35, v146, v147
    ds_write_b64 v46, v[34:35] offset:30624
    s_add_u32 s38, s38, 128
    s_and_b32 s38, s38, 2047
    s_waitcnt lgkmcnt(0)
    ds_read_b128 a[0:3], v26 offset:0
    ds_read_b128 a[4:7], v27 offset:0
    ds_read_b128 a[8:11], v28 offset:14256
    ds_read_b128 a[12:15], v26 offset:32
    ds_read_b128 a[16:19], v27 offset:32
    ds_read_b128 a[20:23], v28 offset:14288
    ds_read_b128 a[24:27], v26 offset:64
    ds_read_b128 a[28:31], v27 offset:64
    ds_read_b128 a[32:35], v28 offset:14320
    s_waitcnt vmcnt(9)
    s_waitcnt lgkmcnt(6)
    v_mfma_f32_32x32x16_bf16 v[224:239], a[0:3], a[8:11], 0
    s_mov_b32 s100, 0x05040100
    s_mov_b32 s101, 0x07060302
    v_lshlrev_b32 v176, 16, v208
    v_and_b32 v177, 0xffff0000, v208
    v_lshlrev_b32 v178, 16, v209
    v_and_b32 v179, 0xffff0000, v209
    v_mfma_f32_32x32x16_bf16 v[240:255], a[4:7], a[8:11], 0
    ds_read_b128 a[36:39], v26 offset:96
    ds_read_b128 a[40:43], v27 offset:96
    ds_read_b128 a[44:47], v28 offset:14352
    v_lshlrev_b32 v180, 16, v210
    v_and_b32 v181, 0xffff0000, v210
    v_lshlrev_b32 v182, 16, v211
    s_waitcnt lgkmcnt(6)
    v_mfma_f32_32x32x16_bf16 v[224:239], a[12:15], a[20:23], v[224:239]
    v_and_b32 v183, 0xffff0000, v211
    v_lshlrev_b32 v184, 16, v212
    v_and_b32 v185, 0xffff0000, v212
    v_lshlrev_b32 v186, 16, v213
    v_and_b32 v187, 0xffff0000, v213
    v_mfma_f32_32x32x16_bf16 v[240:255], a[16:19], a[20:23], v[240:255]
    ds_read_b128 a[0:3], v26 offset:128
    ds_read_b128 a[4:7], v27 offset:128
    ds_read_b128 a[8:11], v28 offset:14384
    v_lshlrev_b32 v188, 16, v214
    v_and_b32 v189, 0xffff0000, v214
    v_lshlrev_b32 v190, 16, v215
    s_waitcnt lgkmcnt(6)
    v_mfma_f32_32x32x16_bf16 v[224:239], a[24:27], a[32:35], v[224:239]
    v_and_b32 v191, 0xffff0000, v215
    v_mov_b32 v216, 0
    v_mov_b32 v217, 0
    v_lshlrev_b32 v218, 16, v192
    v_lshlrev_b32 v220, 16, v200
    v_mfma_f32_32x32x16_bf16 v[240:255], a[28:31], a[32:35], v[240:255]
    ds_read_b128 a[12:15], v26 offset:160
    ds_read_b128 a[16:19], v27 offset:160
    ds_read_b128 a[20:23], v28 offset:14416
    v_and_b32 v219, 0xffff0000, v192
    v_and_b32 v221, 0xffff0000, v200
    v_mul_f32 v218, v218, v176
    s_waitcnt lgkmcnt(6)
    v_mfma_f32_32x32x16_bf16 v[224:239], a[36:39], a[44:47], v[224:239]
    v_mul_f32 v220, v220, v176
    v_mul_f32 v219, v219, v177
    v_mul_f32 v221, v221, v177
    v_cvt_pk_bf16_f32 v218, v218, v219
    v_cvt_pk_bf16_f32 v220, v220, v221
    v_mfma_f32_32x32x16_bf16 v[240:255], a[40:43], a[44:47], v[240:255]
    ds_read_b128 a[24:27], v26 offset:192
    ds_read_b128 a[28:31], v27 offset:192
    ds_read_b128 a[32:35], v28 offset:14448
    v_lshlrev_b32 v219, 16, v218
    v_lshlrev_b32 v221, 16, v220
    v_and_b32 v218, 0xffff0000, v218
    s_waitcnt lgkmcnt(6)
    v_mfma_f32_32x32x16_bf16 v[224:239], a[0:3], a[8:11], v[224:239]
    v_and_b32 v220, 0xffff0000, v220
    v_add_f32 v216, v216, v219
    v_add_f32 v217, v217, v221
    v_add_f32 v216, v216, v218
    v_add_f32 v217, v217, v220
    v_mfma_f32_32x32x16_bf16 v[240:255], a[4:7], a[8:11], v[240:255]
    ds_read_b128 a[36:39], v26 offset:224
    ds_read_b128 a[40:43], v27 offset:224
    ds_read_b128 a[44:47], v28 offset:14480
    v_lshlrev_b32 v218, 16, v193
    v_lshlrev_b32 v220, 16, v201
    v_and_b32 v219, 0xffff0000, v193
    s_waitcnt lgkmcnt(6)
    v_mfma_f32_32x32x16_bf16 v[224:239], a[12:15], a[20:23], v[224:239]
    v_and_b32 v221, 0xffff0000, v201
    v_mul_f32 v218, v218, v178
    v_mul_f32 v220, v220, v178
    v_mul_f32 v219, v219, v179
    v_mul_f32 v221, v221, v179
    v_mfma_f32_32x32x16_bf16 v[240:255], a[16:19], a[20:23], v[240:255]
    ds_read_b128 a[0:3], v26 offset:256
    ds_read_b128 a[4:7], v27 offset:256
    ds_read_b128 a[8:11], v28 offset:14512
    v_cvt_pk_bf16_f32 v218, v218, v219
    v_cvt_pk_bf16_f32 v220, v220, v221
    v_lshlrev_b32 v219, 16, v218
    s_waitcnt lgkmcnt(6)
    v_mfma_f32_32x32x16_bf16 v[224:239], a[24:27], a[32:35], v[224:239]
    v_lshlrev_b32 v221, 16, v220
    v_and_b32 v218, 0xffff0000, v218
    v_and_b32 v220, 0xffff0000, v220
    v_add_f32 v216, v216, v219
    v_add_f32 v217, v217, v221
    v_mfma_f32_32x32x16_bf16 v[240:255], a[28:31], a[32:35], v[240:255]
    ds_read_b128 a[12:15], v26 offset:288
    ds_read_b128 a[16:19], v27 offset:288
    ds_read_b128 a[20:23], v28 offset:14544
    v_add_f32 v216, v216, v218
    v_add_f32 v217, v217, v220
    v_lshlrev_b32 v218, 16, v194
    s_waitcnt lgkmcnt(6)
    v_mfma_f32_32x32x16_bf16 v[224:239], a[36:39], a[44:47], v[224:239]
    v_lshlrev_b32 v220, 16, v202
    v_and_b32 v219, 0xffff0000, v194
    v_and_b32 v221, 0xffff0000, v202
    v_mul_f32 v218, v218, v180
    v_mul_f32 v220, v220, v180
    v_mfma_f32_32x32x16_bf16 v[240:255], a[40:43], a[44:47], v[240:255]
    ds_read_b128 a[24:27], v26 offset:320
    ds_read_b128 a[28:31], v27 offset:320
    ds_read_b128 a[32:35], v28 offset:14576
    v_mul_f32 v219, v219, v181
    v_mul_f32 v221, v221, v181
    v_cvt_pk_bf16_f32 v218, v218, v219
    s_waitcnt lgkmcnt(6)
    v_mfma_f32_32x32x16_bf16 v[224:239], a[0:3], a[8:11], v[224:239]
    v_cvt_pk_bf16_f32 v220, v220, v221
    v_lshlrev_b32 v219, 16, v218
    v_lshlrev_b32 v221, 16, v220
    v_and_b32 v218, 0xffff0000, v218
    v_and_b32 v220, 0xffff0000, v220
    v_mfma_f32_32x32x16_bf16 v[240:255], a[4:7], a[8:11], v[240:255]
    ds_read_b128 a[36:39], v26 offset:352
    ds_read_b128 a[40:43], v27 offset:352
    ds_read_b128 a[44:47], v28 offset:14608
    v_add_f32 v216, v216, v219
    v_add_f32 v217, v217, v221
    v_add_f32 v216, v216, v218
    s_waitcnt lgkmcnt(6)
    v_mfma_f32_32x32x16_bf16 v[224:239], a[12:15], a[20:23], v[224:239]
    v_add_f32 v217, v217, v220
    v_lshlrev_b32 v218, 16, v195
    v_lshlrev_b32 v220, 16, v203
    v_and_b32 v219, 0xffff0000, v195
    v_and_b32 v221, 0xffff0000, v203
    v_mfma_f32_32x32x16_bf16 v[240:255], a[16:19], a[20:23], v[240:255]
    ds_read_b128 a[0:3], v26 offset:384
    ds_read_b128 a[4:7], v27 offset:384
    ds_read_b128 a[8:11], v28 offset:14640
    v_mul_f32 v218, v218, v182
    v_mul_f32 v220, v220, v182
    v_mul_f32 v219, v219, v183
    s_waitcnt lgkmcnt(6)
    v_mfma_f32_32x32x16_bf16 v[224:239], a[24:27], a[32:35], v[224:239]
    v_mul_f32 v221, v221, v183
    v_cvt_pk_bf16_f32 v218, v218, v219
    v_cvt_pk_bf16_f32 v220, v220, v221
    v_lshlrev_b32 v219, 16, v218
    v_lshlrev_b32 v221, 16, v220
    v_mfma_f32_32x32x16_bf16 v[240:255], a[28:31], a[32:35], v[240:255]
    ds_read_b128 a[12:15], v26 offset:416
    ds_read_b128 a[16:19], v27 offset:416
    ds_read_b128 a[20:23], v28 offset:14672
    v_and_b32 v218, 0xffff0000, v218
    v_and_b32 v220, 0xffff0000, v220
    v_add_f32 v216, v216, v219
    s_waitcnt lgkmcnt(6)
    v_mfma_f32_32x32x16_bf16 v[224:239], a[36:39], a[44:47], v[224:239]
    v_add_f32 v217, v217, v221
    v_add_f32 v216, v216, v218
    v_add_f32 v217, v217, v220
    v_lshlrev_b32 v218, 16, v196
    v_lshlrev_b32 v220, 16, v204
    v_mfma_f32_32x32x16_bf16 v[240:255], a[40:43], a[44:47], v[240:255]
    ds_read_b128 a[24:27], v26 offset:448
    ds_read_b128 a[28:31], v27 offset:448
    ds_read_b128 a[32:35], v28 offset:14704
    v_and_b32 v219, 0xffff0000, v196
    v_and_b32 v221, 0xffff0000, v204
    v_mul_f32 v218, v218, v184
    s_waitcnt lgkmcnt(6)
    v_mfma_f32_32x32x16_bf16 v[224:239], a[0:3], a[8:11], v[224:239]
    v_mul_f32 v220, v220, v184
    v_mul_f32 v219, v219, v185
    v_mul_f32 v221, v221, v185
    v_cvt_pk_bf16_f32 v218, v218, v219
    v_cvt_pk_bf16_f32 v220, v220, v221
    v_mfma_f32_32x32x16_bf16 v[240:255], a[4:7], a[8:11], v[240:255]
    ds_read_b128 a[36:39], v26 offset:480
    ds_read_b128 a[40:43], v27 offset:480
    ds_read_b128 a[44:47], v28 offset:14736
    v_lshlrev_b32 v219, 16, v218
    v_lshlrev_b32 v221, 16, v220
    v_and_b32 v218, 0xffff0000, v218
    s_waitcnt lgkmcnt(6)
    v_mfma_f32_32x32x16_bf16 v[224:239], a[12:15], a[20:23], v[224:239]
    v_and_b32 v220, 0xffff0000, v220
    v_add_f32 v216, v216, v219
    v_add_f32 v217, v217, v221
    v_add_f32 v216, v216, v218
    v_add_f32 v217, v217, v220
    v_mfma_f32_32x32x16_bf16 v[240:255], a[16:19], a[20:23], v[240:255]
    v_lshlrev_b32 v218, 16, v197
    v_lshlrev_b32 v220, 16, v205
    v_and_b32 v219, 0xffff0000, v197
    s_waitcnt lgkmcnt(3)
    v_mfma_f32_32x32x16_bf16 v[224:239], a[24:27], a[32:35], v[224:239]
    v_and_b32 v221, 0xffff0000, v205
    v_mul_f32 v218, v218, v186
    v_mul_f32 v220, v220, v186
    v_mul_f32 v219, v219, v187
    v_mul_f32 v221, v221, v187
    v_mfma_f32_32x32x16_bf16 v[240:255], a[28:31], a[32:35], v[240:255]
    v_cvt_pk_bf16_f32 v218, v218, v219
    v_cvt_pk_bf16_f32 v220, v220, v221
    v_lshlrev_b32 v219, 16, v218
    s_waitcnt lgkmcnt(0)
    v_mfma_f32_32x32x16_bf16 v[224:239], a[36:39], a[44:47], v[224:239]
    v_mfma_f32_32x32x16_bf16 v[240:255], a[40:43], a[44:47], v[240:255]
    s_add_u32 m0, s39, 0
    v_lshlrev_b32 v221, 16, v220
    buffer_load_dwordx4 v2, s[52:55], s37 offen lds
    s_add_u32 m0, s39, 1024
    v_and_b32 v218, 0xffff0000, v218
    buffer_load_dwordx4 v3, s[52:55], s37 offen lds
    s_add_u32 m0, s39, 2048
    v_and_b32 v220, 0xffff0000, v220
    buffer_load_dwordx4 v4, s[52:55], s37 offen lds
    s_add_u32 m0, s39, 3072
    v_add_f32 v216, v216, v219
    buffer_load_dwordx4 v5, s[52:55], s37 offen lds
    s_add_u32 m0, s39, 4096
    v_add_f32 v217, v217, v221
    buffer_load_dwordx4 v6, s[52:55], s37 offen lds
    s_add_u32 m0, s39, 5120
    v_add_f32 v216, v216, v218
    buffer_load_dwordx4 v7, s[52:55], s37 offen lds
    s_add_u32 m0, s39, 6144
    v_add_f32 v217, v217, v220
    buffer_load_dwordx4 v8, s[52:55], s37 offen lds
    s_add_u32 s37, s37, 458752
    s_add_u32 s39, s39, 7168
    s_sub_u32 s56, s39, s40
    s_cmp_ge_u32 s56, 29696
    s_cselect_b32 s56, 21504, 0
    s_sub_u32 s39, s39, s56
    s_cmp_ge_u32 s37, 7340032
    s_cselect_b32 s37, 0, s37
    s_add_u32 m0, s39, 0
    v_lshlrev_b32 v218, 16, v198
    buffer_load_dwordx4 v2, s[52:55], s37 offen lds
    v_lshlrev_b32 v220, 16, v206
    s_add_u32 m0, s39, 1024
    v_and_b32 v219, 0xffff0000, v198
    buffer_load_dwordx4 v3, s[52:55], s37 offen lds
    v_and_b32 v221, 0xffff0000, v206
    s_add_u32 m0, s39, 2048
    v_mul_f32 v218, v218, v188
    buffer_load_dwordx4 v4, s[52:55], s37 offen lds
    v_mul_f32 v220, v220, v188
    s_add_u32 m0, s39, 3072
    v_mul_f32 v219, v219, v189
    buffer_load_dwordx4 v5, s[52:55], s37 offen lds
    v_mul_f32 v221, v221, v189
    s_add_u32 m0, s39, 4096
    v_cvt_pk_bf16_f32 v218, v218, v219
    buffer_load_dwordx4 v6, s[52:55], s37 offen lds
    v_cvt_pk_bf16_f32 v220, v220, v221
    s_add_u32 m0, s39, 5120
    v_lshlrev_b32 v219, 16, v218
    buffer_load_dwordx4 v7, s[52:55], s37 offen lds
    v_lshlrev_b32 v221, 16, v220
    s_add_u32 m0, s39, 6144
    v_and_b32 v218, 0xffff0000, v218
    buffer_load_dwordx4 v8, s[52:55], s37 offen lds
    v_and_b32 v220, 0xffff0000, v220
    s_add_u32 s37, s37, 458752
    s_add_u32 s39, s39, 7168
    s_sub_u32 s56, s39, s40
    s_cmp_ge_u32 s56, 29696
    s_cselect_b32 s56, 21504, 0
    s_sub_u32 s39, s39, s56
    s_cmp_ge_u32 s37, 7340032
    s_cselect_b32 s37, 0, s37
    s_add_u32 m0, s40, 0
    v_add_f32 v216, v216, v219
    buffer_load_dwordx4 v9, s[48:51], s38 offen lds
    v_add_f32 v217, v217, v221
    s_add_u32 m0, s40, 1024
    v_add_f32 v216, v216, v218
    buffer_load_dwordx4 v10, s[48:51], s38 offen lds
    v_add_f32 v217, v217, v220
    s_add_u32 m0, s40, 2048
    v_lshlrev_b32 v218, 16, v199
    buffer_load_dwordx4 v11, s[48:51], s38 offen lds
    v_lshlrev_b32 v220, 16, v207
    s_add_u32 m0, s40, 3072
    v_and_b32 v219, 0xffff0000, v199
    buffer_load_dwordx4 v12, s[48:51], s38 offen lds
    v_and_b32 v221, 0xffff0000, v207
    s_add_u32 m0, s40, 4096
    v_mul_f32 v218, v218, v190
    buffer_load_dwordx4 v13, s[48:51], s38 offen lds
    v_mul_f32 v220, v220, v190
    s_add_u32 m0, s40, 5120
    v_mul_f32 v219, v219, v191
    buffer_load_dwordx4 v14, s[48:51], s38 offen lds
    v_mul_f32 v221, v221, v191
    s_add_u32 m0, s40, 6144
    v_cvt_pk_bf16_f32 v218, v218, v219
    buffer_load_dwordx4 v15, s[48:51], s38 offen lds
    v_cvt_pk_bf16_f32 v220, v220, v221
    s_add_u32 m0, s40, 7168
    v_lshlrev_b32 v219, 16, v218
    buffer_load_dwordx4 v16, s[48:51], s38 offen lds
    v_lshlrev_b32 v221, 16, v220
    s_add_u32 s38, s38, 128
    s_and_b32 s38, s38, 2047
    s_waitcnt vmcnt(15)
    v_lshlrev_b32 v29, 8, v0
    v_mov_b32 v28, 1
    s_add_u32 s13, s35, 1
    s_bitcmp0_b32 s13, 1
    s_cselect_b32 s13, s96, 0x4000
    s_add_u32 s14, s16, 131072
    s_add_u32 s15, s17, 131072
    s_branch gated_mix__ssm_conv_s4__swiglu_ffn__prompt_kernel_noini
    s_cmp_ge_u32 s2, 24
    s_cbranch_scc1 gated_mix__ssm_conv_s4__swiglu_ffn__prompt_kernel_noini
    s_cmp_lg_u32 s32, 0
    s_cbranch_scc1 gated_mix__ssm_conv_s4__swiglu_ffn__prompt_kernel_noini
    v_mov_b32 v26, 1
    v_mov_b32 v27, 0
    s_mov_b64 exec, 1
    buffer_atomic_add v26, v27, s[8:11], 0 offen sc1
    s_mov_b64 exec, -1
gated_mix__ssm_conv_s4__swiglu_ffn__prompt_kernel_noini:
    s_barrier
    ds_read_b128 a[112:115], v21 offset:32768
    ds_read_b128 a[116:119], v21 offset:34816
    ds_read_b128 a[120:123], v21 offset:36864
    ds_read_b128 a[124:127], v21 offset:38912
    ds_read_b64_tr_b16 a[0:1], v17 offset:0
    ds_read_b64_tr_b16 a[2:3], v18 offset:0
    ds_read_b64_tr_b16 a[4:5], v17 offset:40960
    ds_read_b64_tr_b16 a[6:7], v18 offset:40960
    ds_read_b64_tr_b16 a[8:9], v17 offset:32
    ds_read_b64_tr_b16 a[10:11], v18 offset:32
    ds_read_b64_tr_b16 a[12:13], v17 offset:40992
    ds_read_b64_tr_b16 a[14:15], v18 offset:40992
    ds_read_b64_tr_b16 a[16:17], v17 offset:64
    ds_read_b64_tr_b16 a[18:19], v18 offset:64
    ds_read_b64_tr_b16 a[20:21], v17 offset:41024
    ds_read_b64_tr_b16 a[22:23], v18 offset:41024
    ds_read_b64_tr_b16 a[24:25], v17 offset:96
    ds_read_b64_tr_b16 a[26:27], v18 offset:96
    ds_read_b64_tr_b16 a[28:29], v17 offset:41056
    ds_read_b64_tr_b16 a[30:31], v18 offset:41056
    ds_read_b64_tr_b16 a[32:33], v17 offset:128
    ds_read_b64_tr_b16 a[34:35], v18 offset:128
    ds_read_b64_tr_b16 a[36:37], v17 offset:41088
    ds_read_b64_tr_b16 a[38:39], v18 offset:41088
    ds_read_b64_tr_b16 a[40:41], v17 offset:160
    ds_read_b64_tr_b16 a[42:43], v18 offset:160
    ds_read_b64_tr_b16 a[44:45], v17 offset:41120
    ds_read_b64_tr_b16 a[46:47], v18 offset:41120
    ds_read_b64_tr_b16 a[48:49], v17 offset:192
    ds_read_b64_tr_b16 a[50:51], v18 offset:192
    ds_read_b64_tr_b16 a[52:53], v17 offset:41152
    ds_read_b64_tr_b16 a[54:55], v18 offset:41152
    ds_read_b128 a[128:131], v22 offset:32768
    ds_read_b128 a[132:135], v22 offset:34816
    ds_read_b128 a[136:139], v22 offset:36864
    ds_read_b128 a[140:143], v22 offset:38912
    v_and_b32 v218, 0xffff0000, v218
    v_and_b32 v220, 0xffff0000, v220
    v_add_f32 v216, v216, v219
    v_add_f32 v217, v217, v221
    v_add_f32 v216, v216, v218
    v_add_f32 v217, v217, v220
    s_nop 0
    v_add_f32_dpp v216, v216, v216 row_shr:1 row_mask:0xf bank_mask:0xf
    v_add_f32_dpp v217, v217, v217 row_shr:1 row_mask:0xf bank_mask:0xf
    s_nop 0
    v_add_f32_dpp v216, v216, v216 row_shr:2 row_mask:0xf bank_mask:0xf
    v_add_f32_dpp v217, v217, v217 row_shr:2 row_mask:0xf bank_mask:0xf
    s_nop 0
    v_add_f32_dpp v216, v216, v216 row_shr:4 row_mask:0xf bank_mask:0xf
    v_add_f32_dpp v217, v217, v217 row_shr:4 row_mask:0xf bank_mask:0xf
    s_waitcnt lgkmcnt(0)
    v_mfma_f32_16x16x32_bf16 v[32:35], a[0:3], a[112:115], 0
    ds_read_b64_tr_b16 a[56:57], v19 offset:0
    v_add_f32_dpp v216, v216, v216 row_shr:8 row_mask:0xf bank_mask:0xf
    v_add_f32_dpp v217, v217, v217 row_shr:8 row_mask:0xf bank_mask:0xf
    v_mfma_f32_16x16x32_bf16 v[36:39], a[0:3], a[116:119], 0
    ds_read_b64_tr_b16 a[58:59], v20 offset:0
    s_add_u32 m0, s40, 32768
    v_add_f32_dpp v216, v216, v216 row_bcast:15 row_mask:0xa bank_mask:0xf
    v_add_f32_dpp v217, v217, v217 row_bcast:15 row_mask:0xa bank_mask:0xf
    v_mfma_f32_16x16x32_bf16 v[40:43], a[0:3], a[120:123], 0
    buffer_load_dwordx4 v9, s[48:51], s38 offen lds
    v_mfma_f32_16x16x32_bf16 v[44:47], a[0:3], a[124:127], 0
    ds_read_b64_tr_b16 a[60:61], v19 offset:40960
    v_add_f32_dpp v216, v216, v216 row_bcast:31 row_mask:0xc bank_mask:0xf
    v_add_f32_dpp v217, v217, v217 row_bcast:31 row_mask:0xc bank_mask:0xf
    v_mfma_f32_16x16x32_bf16 v[48:51], a[4:7], a[112:115], 0
    ds_read_b64_tr_b16 a[62:63], v20 offset:40960
    s_add_u32 m0, s39, 0
    v_readlane_b32 s62, v216, 63
    v_readlane_b32 s63, v217, 63
    v_mfma_f32_16x16x32_bf16 v[52:55], a[4:7], a[116:119], 0
    buffer_load_dwordx4 v2, s[52:55], s37 offen lds
    v_mfma_f32_16x16x32_bf16 v[56:59], a[4:7], a[120:123], 0
    ds_read_b64_tr_b16 a[64:65], v19 offset:32
    v_and_b32 v218, 1, v0
    v_cmp_eq_u32 vcc, 1, v218
    v_mfma_f32_16x16x32_bf16 v[60:63], a[4:7], a[124:127], 0
    ds_read_b64_tr_b16 a[66:67], v20 offset:32
    s_add_u32 m0, s40, 33792
    v_mov_b32 v216, s62
    v_mov_b32 v217, s63
    v_mfma_f32_16x16x32_bf16 v[64:67], a[8:11], a[112:115], 0
    buffer_load_dwordx4 v10, s[48:51], s38 offen lds
    v_mfma_f32_16x16x32_bf16 v[68:71], a[8:11], a[116:119], 0
    ds_read_b64_tr_b16 a[68:69], v19 offset:40992
    v_cndmask_b32 v216, v216, v217, vcc
    v_cvt_pk_bf16_f32 v216, v216, v216
    v_mfma_f32_16x16x32_bf16 v[72:75], a[8:11], a[120:123], 0
    ds_read_b64_tr_b16 a[70:71], v20 offset:40992
    s_add_u32 m0, s39, 1024
    v_and_b32 v216, 0xffff0000, v216
    v_mul_f32 v216, s60, v216
    v_mfma_f32_16x16x32_bf16 v[76:79], a[8:11], a[124:127], 0
    buffer_load_dwordx4 v3, s[52:55], s37 offen lds
    v_mfma_f32_16x16x32_bf16 v[80:83], a[12:15], a[112:115], 0
    ds_read_b64_tr_b16 a[72:73], v19 offset:64
    v_exp_f32 v216, -v216
    s_nop 0
    v_add_f32 v216, 1.0, v216
    v_mfma_f32_16x16x32_bf16 v[84:87], a[12:15], a[116:119], 0
    ds_read_b64_tr_b16 a[74:75], v20 offset:64
    s_add_u32 m0, s40, 34816
    v_rcp_f32 v216, v216
    s_nop 0
    v_cvt_pk_bf16_f32 v216, v216, v216
    v_mfma_f32_16x16x32_bf16 v[88:91], a[12:15], a[120:123], 0
    buffer_load_dwordx4 v11, s[48:51], s38 offen lds
    v_mfma_f32_16x16x32_bf16 v[92:95], a[12:15], a[124:127], 0
    ds_read_b64_tr_b16 a[76:77], v19 offset:41024
    v_and_b32 v216, 0xffff0000, v216
    v_lshlrev_b32 v218, 2, v218
    v_mfma_f32_16x16x32_bf16 v[96:99], a[16:19], a[112:115], 0
    ds_read_b64_tr_b16 a[78:79], v20 offset:41024
    s_add_u32 m0, s39, 2048
    s_lshl_b32 s62, s59, 2
    s_add_u32 s62, s62, 20971520
    buffer_store_dword v216, v218, s[28:31], s62 offen sc1
    v_mfma_f32_16x16x32_bf16 v[100:103], a[16:19], a[116:119], 0
    buffer_load_dwordx4 v4, s[52:55], s37 offen lds
    v_mfma_f32_16x16x32_bf16 v[104:107], a[16:19], a[120:123], 0
    ds_read_b64_tr_b16 a[80:81], v19 offset:96
    v_mov_b32 v219, 0
    v_writelane_b32 v219, s26, 0
    v_mfma_f32_16x16x32_bf16 v[108:111], a[16:19], a[124:127], 0
    ds_read_b64_tr_b16 a[82:83], v20 offset:96
    s_add_u32 m0, s40, 35840
    v_add_f32 v224, v224, v219
    v_cndmask_b32 v240, v240, v241, vcc
    v_mfma_f32_16x16x32_bf16 v[112:115], a[20:23], a[112:115], 0
    buffer_load_dwordx4 v12, s[48:51], s38 offen lds
    v_mfma_f32_16x16x32_bf16 v[116:119], a[20:23], a[116:119], 0
    ds_read_b64_tr_b16 a[84:85], v19 offset:41056
    v_cndmask_b32 v244, v244, v245, vcc
    v_cndmask_b32 v248, v248, v249, vcc
    v_mfma_f32_16x16x32_bf16 v[120:123], a[20:23], a[120:123], 0
    ds_read_b64_tr_b16 a[86:87], v20 offset:41056
    s_add_u32 m0, s39, 3072
    v_cndmask_b32 v252, v252, v253, vcc
    v_cvt_pk_bf16_f32 v224, v224, v225
    v_mfma_f32_16x16x32_bf16 v[124:127], a[20:23], a[124:127], 0
    buffer_load_dwordx4 v5, s[52:55], s37 offen lds
    v_mfma_f32_16x16x32_bf16 v[128:131], a[24:27], a[112:115], 0
    ds_read_b64_tr_b16 a[88:89], v19 offset:128
    v_cvt_pk_bf16_f32 v225, v226, v227
    v_cvt_pk_bf16_f32 v228, v228, v229
    v_mfma_f32_16x16x32_bf16 v[132:135], a[24:27], a[116:119], 0
    ds_read_b64_tr_b16 a[90:91], v20 offset:128
    s_add_u32 m0, s40, 36864
    v_cvt_pk_bf16_f32 v229, v230, v231
    v_cvt_pk_bf16_f32 v232, v232, v233
    v_mfma_f32_16x16x32_bf16 v[136:139], a[24:27], a[120:123], 0
    buffer_load_dwordx4 v13, s[48:51], s38 offen lds
    v_mfma_f32_16x16x32_bf16 v[140:143], a[24:27], a[124:127], 0
    ds_read_b64_tr_b16 a[92:93], v19 offset:41088
    v_cvt_pk_bf16_f32 v233, v234, v235
    v_cvt_pk_bf16_f32 v236, v236, v237
    v_mfma_f32_16x16x32_bf16 v[144:147], a[28:31], a[112:115], 0
    ds_read_b64_tr_b16 a[94:95], v20 offset:41088
    s_add_u32 m0, s39, 4096
    v_cvt_pk_bf16_f32 v237, v238, v239
    v_cvt_pk_bf16_f32 v240, v240, v241
    v_mfma_f32_16x16x32_bf16 v[148:151], a[28:31], a[116:119], 0
    buffer_load_dwordx4 v6, s[52:55], s37 offen lds
    v_mfma_f32_16x16x32_bf16 v[152:155], a[28:31], a[120:123], 0
    ds_read_b64_tr_b16 a[96:97], v19 offset:160
    v_cvt_pk_bf16_f32 v241, v242, v243
    v_cvt_pk_bf16_f32 v244, v244, v245
    v_mfma_f32_16x16x32_bf16 v[156:159], a[28:31], a[124:127], 0
    ds_read_b64_tr_b16 a[98:99], v20 offset:160
    s_add_u32 m0, s40, 37888
    v_cvt_pk_bf16_f32 v245, v246, v247
    v_cvt_pk_bf16_f32 v248, v248, v249
    v_mfma_f32_16x16x32_bf16 v[160:163], a[32:35], a[112:115], 0
    buffer_load_dwordx4 v14, s[48:51], s38 offen lds
    v_mfma_f32_16x16x32_bf16 v[164:167], a[32:35], a[116:119], 0
    ds_read_b64_tr_b16 a[100:101], v19 offset:41120
    v_cvt_pk_bf16_f32 v249, v250, v251
    v_cvt_pk_bf16_f32 v252, v252, v253
    v_mfma_f32_16x16x32_bf16 v[168:171], a[32:35], a[120:123], 0
    ds_read_b64_tr_b16 a[102:103], v20 offset:41120
    s_add_u32 m0, s39, 5120
    v_cvt_pk_bf16_f32 v253, v254, v255
    v_accvgpr_write_b32 a176, v224
    v_mfma_f32_16x16x32_bf16 v[172:175], a[32:35], a[124:127], 0
    buffer_load_dwordx4 v7, s[52:55], s37 offen lds
    v_mfma_f32_16x16x32_bf16 v[176:179], a[36:39], a[112:115], 0
    ds_read_b64_tr_b16 a[104:105], v19 offset:192
    v_accvgpr_write_b32 a177, v225
    v_accvgpr_write_b32 a178, v228
    v_mfma_f32_16x16x32_bf16 v[180:183], a[36:39], a[116:119], 0
    ds_read_b64_tr_b16 a[106:107], v20 offset:192
    s_add_u32 m0, s40, 38912
    v_accvgpr_write_b32 a179, v229
    v_accvgpr_write_b32 a180, v232
    v_mfma_f32_16x16x32_bf16 v[184:187], a[36:39], a[120:123], 0
    buffer_load_dwordx4 v15, s[48:51], s38 offen lds
    v_mfma_f32_16x16x32_bf16 v[188:191], a[36:39], a[124:127], 0
    ds_read_b64_tr_b16 a[108:109], v19 offset:41152
    v_accvgpr_write_b32 a181, v233
    v_accvgpr_write_b32 a182, v236
    v_mfma_f32_16x16x32_bf16 v[192:195], a[40:43], a[112:115], 0
    ds_read_b64_tr_b16 a[110:111], v20 offset:41152
    s_add_u32 m0, s39, 6144
    v_accvgpr_write_b32 a183, v237
    v_accvgpr_write_b32 a184, v240
    v_accvgpr_write_b32 a185, v241
    v_mfma_f32_16x16x32_bf16 v[196:199], a[40:43], a[116:119], 0
    buffer_load_dwordx4 v8, s[52:55], s37 offen lds
    v_mfma_f32_16x16x32_bf16 v[200:203], a[40:43], a[120:123], 0
    s_add_u32 s37, s37, 458752
    s_add_u32 s39, s39, 7168
    s_sub_u32 s56, s39, s40
    v_accvgpr_write_b32 a186, v244
    v_accvgpr_write_b32 a187, v245
    v_accvgpr_write_b32 a188, v248
    v_mfma_f32_16x16x32_bf16 v[204:207], a[40:43], a[124:127], 0
    s_add_u32 m0, s40, 39936
    s_cmp_ge_u32 s56, 29696
    s_cselect_b32 s56, 21504, 0
    s_sub_u32 s39, s39, s56
    s_cmp_ge_u32 s37, 7340032
    s_cselect_b32 s37, 0, s37
    v_accvgpr_write_b32 a189, v249
    v_accvgpr_write_b32 a190, v252
    v_accvgpr_write_b32 a191, v253
    v_mfma_f32_16x16x32_bf16 v[208:211], a[44:47], a[112:115], 0
    buffer_load_dwordx4 v16, s[48:51], s38 offen lds
    v_mfma_f32_16x16x32_bf16 v[212:215], a[44:47], a[116:119], 0
    v_mfma_f32_16x16x32_bf16 v[216:219], a[44:47], a[120:123], 0
    s_add_u32 s41, s41, 1
    s_cmp_eq_u32 s41, 3
    s_cselect_b32 s41, 0, s41
    s_cselect_b32 s57, -2, 1
    s_mul_i32 s57, s57, 7168
    v_mfma_f32_16x16x32_bf16 v[220:223], a[44:47], a[124:127], 0
    v_add_u32 v17, s57, v17
    v_add_u32 v18, s57, v18
    v_mfma_f32_16x16x32_bf16 v[224:227], a[48:51], a[112:115], 0
    s_mov_b32 s97, s19
    v_add_u32 v19, s57, v19
    v_add_u32 v20, s57, v20
    v_mfma_f32_16x16x32_bf16 v[228:231], a[48:51], a[116:119], 0
    s_add_u32 s38, s38, 128
    s_and_b32 s38, s38, 2047
    buffer_load_dword v1, v23, s[52:55], s97 offen
    v_mfma_f32_16x16x32_bf16 v[232:235], a[48:51], a[120:123], 0
    s_add_u32 s19, s19, 917504
    s_cmp_ge_u32 s19, 7340032
    s_cselect_b32 s19, 0, s19
    v_mfma_f32_16x16x32_bf16 v[236:239], a[48:51], a[124:127], 0
    v_mfma_f32_16x16x32_bf16 v[240:243], a[52:55], a[112:115], 0
    s_waitcnt vmcnt(17) lgkmcnt(0)
    s_barrier
    v_mfma_f32_16x16x32_bf16 v[244:247], a[52:55], a[116:119], 0
    s_cmp_lt_u32 s13, 2
    s_cbranch_scc1 gated_mix__ssm_conv_s4__swiglu_ffn__prompt_kernel_u1_o
gated_mix__ssm_conv_s4__swiglu_ffn__prompt_kernel_u1_b:
    s_sub_u32 s96, s96, 2
    v_mfma_f32_16x16x32_bf16 v[248:251], a[52:55], a[120:123], 0
    s_add_u32 s97, s96, 6
    s_cmp_lt_u32 s97, 2
    s_cbranch_scc1 gated_mix__ssm_conv_s4__swiglu_ffn__prompt_kernel_u1_f
gated_mix__ssm_conv_s4__swiglu_ffn__prompt_kernel_u1_g:
    v_mfma_f32_16x16x32_bf16 v[252:255], a[52:55], a[124:127], 0
    s_sub_u32 s13, s13, 2
    v_mfma_f32_16x16x32_bf16 v[32:35], a[56:59], a[128:131], v[32:35]
    ds_read_b64_tr_b16 a[0:1], v17 offset:0
    v_mfma_f32_16x16x32_bf16 v[36:39], a[56:59], a[132:135], v[36:39]
    ds_read_b64_tr_b16 a[2:3], v18 offset:0
    v_mfma_f32_16x16x32_bf16 v[40:43], a[56:59], a[136:139], v[40:43]
    ds_read_b64_tr_b16 a[4:5], v17 offset:40960
    s_add_u32 m0, s39, 0
    v_mfma_f32_16x16x32_bf16 v[44:47], a[56:59], a[140:143], v[44:47]
    buffer_load_dwordx4 v2, s[52:55], s37 offen lds
    v_mfma_f32_16x16x32_bf16 v[48:51], a[60:63], a[128:131], v[48:51]
    ds_read_b64_tr_b16 a[6:7], v18 offset:40960
    v_mfma_f32_16x16x32_bf16 v[52:55], a[60:63], a[132:135], v[52:55]
    ds_read_b64_tr_b16 a[8:9], v17 offset:32
    v_mfma_f32_16x16x32_bf16 v[56:59], a[60:63], a[136:139], v[56:59]
    ds_read_b64_tr_b16 a[10:11], v18 offset:32
    v_mfma_f32_16x16x32_bf16 v[60:63], a[60:63], a[140:143], v[60:63]
    ds_read_b64_tr_b16 a[12:13], v17 offset:40992
    v_mfma_f32_16x16x32_bf16 v[64:67], a[64:67], a[128:131], v[64:67]
    ds_read_b64_tr_b16 a[14:15], v18 offset:40992
    v_mfma_f32_16x16x32_bf16 v[68:71], a[64:67], a[132:135], v[68:71]
    ds_read_b64_tr_b16 a[16:17], v17 offset:64
    s_add_u32 m0, s39, 1024
    v_mfma_f32_16x16x32_bf16 v[72:75], a[64:67], a[136:139], v[72:75]
    buffer_load_dwordx4 v3, s[52:55], s37 offen lds
    v_mfma_f32_16x16x32_bf16 v[76:79], a[64:67], a[140:143], v[76:79]
    ds_read_b64_tr_b16 a[18:19], v18 offset:64
    v_mfma_f32_16x16x32_bf16 v[80:83], a[68:71], a[128:131], v[80:83]
    ds_read_b64_tr_b16 a[20:21], v17 offset:41024
    v_mfma_f32_16x16x32_bf16 v[84:87], a[68:71], a[132:135], v[84:87]
    ds_read_b64_tr_b16 a[22:23], v18 offset:41024
    v_mfma_f32_16x16x32_bf16 v[88:91], a[68:71], a[136:139], v[88:91]
    ds_read_b64_tr_b16 a[24:25], v17 offset:96
    v_mfma_f32_16x16x32_bf16 v[92:95], a[68:71], a[140:143], v[92:95]
    ds_read_b64_tr_b16 a[26:27], v18 offset:96
    v_mfma_f32_16x16x32_bf16 v[96:99], a[72:75], a[128:131], v[96:99]
    ds_read_b64_tr_b16 a[28:29], v17 offset:41056
    s_add_u32 m0, s39, 2048
    v_mfma_f32_16x16x32_bf16 v[100:103], a[72:75], a[132:135], v[100:103]
    buffer_load_dwordx4 v4, s[52:55], s37 offen lds
    v_mfma_f32_16x16x32_bf16 v[104:107], a[72:75], a[136:139], v[104:107]
    ds_read_b64_tr_b16 a[30:31], v18 offset:41056
    v_mfma_f32_16x16x32_bf16 v[108:111], a[72:75], a[140:143], v[108:111]
    ds_read_b64_tr_b16 a[32:33], v17 offset:128
    v_mfma_f32_16x16x32_bf16 v[112:115], a[76:79], a[128:131], v[112:115]
    ds_read_b64_tr_b16 a[34:35], v18 offset:128
    v_mfma_f32_16x16x32_bf16 v[116:119], a[76:79], a[132:135], v[116:119]
    ds_read_b64_tr_b16 a[36:37], v17 offset:41088
    v_mfma_f32_16x16x32_bf16 v[120:123], a[76:79], a[136:139], v[120:123]
    ds_read_b64_tr_b16 a[38:39], v18 offset:41088
    v_mfma_f32_16x16x32_bf16 v[124:127], a[76:79], a[140:143], v[124:127]
    ds_read_b64_tr_b16 a[40:41], v17 offset:160
    s_add_u32 m0, s39, 3072
    v_mfma_f32_16x16x32_bf16 v[128:131], a[80:83], a[128:131], v[128:131]
    buffer_load_dwordx4 v5, s[52:55], s37 offen lds
    v_mfma_f32_16x16x32_bf16 v[132:135], a[80:83], a[132:135], v[132:135]
    ds_read_b64_tr_b16 a[42:43], v18 offset:160
    v_mfma_f32_16x16x32_bf16 v[136:139], a[80:83], a[136:139], v[136:139]
    ds_read_b64_tr_b16 a[44:45], v17 offset:41120
    v_mfma_f32_16x16x32_bf16 v[140:143], a[80:83], a[140:143], v[140:143]
    ds_read_b64_tr_b16 a[46:47], v18 offset:41120
    v_mfma_f32_16x16x32_bf16 v[144:147], a[84:87], a[128:131], v[144:147]
    ds_read_b64_tr_b16 a[48:49], v17 offset:192
    v_mfma_f32_16x16x32_bf16 v[148:151], a[84:87], a[132:135], v[148:151]
    ds_read_b64_tr_b16 a[50:51], v18 offset:192
    v_mfma_f32_16x16x32_bf16 v[152:155], a[84:87], a[136:139], v[152:155]
    ds_read_b64_tr_b16 a[52:53], v17 offset:41152
    s_add_u32 m0, s39, 4096
    v_mfma_f32_16x16x32_bf16 v[156:159], a[84:87], a[140:143], v[156:159]
    buffer_load_dwordx4 v6, s[52:55], s37 offen lds
    v_mfma_f32_16x16x32_bf16 v[160:163], a[88:91], a[128:131], v[160:163]
    ds_read_b64_tr_b16 a[54:55], v18 offset:41152
    v_mfma_f32_16x16x32_bf16 v[164:167], a[88:91], a[132:135], v[164:167]
    ds_read_b128 a[144:147], v21 offset:0
    v_mfma_f32_16x16x32_bf16 v[168:171], a[88:91], a[136:139], v[168:171]
    ds_read_b128 a[148:151], v21 offset:2048
    v_mfma_f32_16x16x32_bf16 v[172:175], a[88:91], a[140:143], v[172:175]
    ds_read_b128 a[152:155], v21 offset:4096
    v_mfma_f32_16x16x32_bf16 v[176:179], a[92:95], a[128:131], v[176:179]
    ds_read_b128 a[156:159], v21 offset:6144
    v_mfma_f32_16x16x32_bf16 v[180:183], a[92:95], a[132:135], v[180:183]
    ds_read_b128 a[160:163], v22 offset:0
    s_add_u32 m0, s39, 5120
    v_mfma_f32_16x16x32_bf16 v[184:187], a[92:95], a[136:139], v[184:187]
    buffer_load_dwordx4 v7, s[52:55], s37 offen lds
    v_mfma_f32_16x16x32_bf16 v[188:191], a[92:95], a[140:143], v[188:191]
    ds_read_b128 a[164:167], v22 offset:2048
    v_mfma_f32_16x16x32_bf16 v[192:195], a[96:99], a[128:131], v[192:195]
    ds_read_b128 a[168:171], v22 offset:4096
    v_mfma_f32_16x16x32_bf16 v[196:199], a[96:99], a[132:135], v[196:199]
    ds_read_b128 a[172:175], v22 offset:6144
    v_mfma_f32_16x16x32_bf16 v[200:203], a[96:99], a[136:139], v[200:203]
    v_mfma_f32_16x16x32_bf16 v[204:207], a[96:99], a[140:143], v[204:207]
    v_mfma_f32_16x16x32_bf16 v[208:211], a[100:103], a[128:131], v[208:211]
    s_add_u32 m0, s39, 6144
    v_mfma_f32_16x16x32_bf16 v[212:215], a[100:103], a[132:135], v[212:215]
    buffer_load_dwordx4 v8, s[52:55], s37 offen lds
    v_mfma_f32_16x16x32_bf16 v[216:219], a[100:103], a[136:139], v[216:219]
    s_add_u32 s37, s37, 458752
    s_add_u32 s39, s39, 7168
    s_sub_u32 s56, s39, s40
    v_mfma_f32_16x16x32_bf16 v[220:223], a[100:103], a[140:143], v[220:223]
    s_cmp_ge_u32 s56, 29696
    s_cselect_b32 s56, 21504, 0
    s_sub_u32 s39, s39, s56
    s_cmp_ge_u32 s37, 7340032
    s_cselect_b32 s37, 0, s37
    v_mfma_f32_16x16x32_bf16 v[224:227], a[104:107], a[128:131], v[224:227]
    v_mfma_f32_16x16x32_bf16 v[228:231], a[104:107], a[132:135], v[228:231]
    v_mfma_f32_16x16x32_bf16 v[232:235], a[104:107], a[136:139], v[232:235]
    v_mfma_f32_16x16x32_bf16 v[236:239], a[104:107], a[140:143], v[236:239]
    v_mfma_f32_16x16x32_bf16 v[240:243], a[108:111], a[128:131], v[240:243]
    v_mfma_f32_16x16x32_bf16 v[244:247], a[108:111], a[132:135], v[244:247]
    v_mfma_f32_16x16x32_bf16 v[248:251], a[108:111], a[136:139], v[248:251]
    v_mfma_f32_16x16x32_bf16 v[252:255], a[108:111], a[140:143], v[252:255]
    s_waitcnt lgkmcnt(0)
    v_mfma_f32_16x16x32_bf16 v[32:35], a[0:3], a[144:147], v[32:35]
    ds_read_b64_tr_b16 a[56:57], v19 offset:0
    v_mfma_f32_16x16x32_bf16 v[36:39], a[0:3], a[148:151], v[36:39]
    ds_read_b64_tr_b16 a[58:59], v20 offset:0
    s_add_u32 m0, s40, 0
    v_mfma_f32_16x16x32_bf16 v[40:43], a[0:3], a[152:155], v[40:43]
    buffer_load_dwordx4 v9, s[48:51], s38 offen lds
    v_mfma_f32_16x16x32_bf16 v[44:47], a[0:3], a[156:159], v[44:47]
    ds_read_b64_tr_b16 a[60:61], v19 offset:40960
    v_mfma_f32_16x16x32_bf16 v[48:51], a[4:7], a[144:147], v[48:51]
    ds_read_b64_tr_b16 a[62:63], v20 offset:40960
    v_mfma_f32_16x16x32_bf16 v[52:55], a[4:7], a[148:151], v[52:55]
    ds_read_b64_tr_b16 a[64:65], v19 offset:32
    v_mfma_f32_16x16x32_bf16 v[56:59], a[4:7], a[152:155], v[56:59]
    ds_read_b64_tr_b16 a[66:67], v20 offset:32
    v_mfma_f32_16x16x32_bf16 v[60:63], a[4:7], a[156:159], v[60:63]
    ds_read_b64_tr_b16 a[68:69], v19 offset:40992
    s_add_u32 m0, s40, 1024
    v_mfma_f32_16x16x32_bf16 v[64:67], a[8:11], a[144:147], v[64:67]
    buffer_load_dwordx4 v10, s[48:51], s38 offen lds
    v_mfma_f32_16x16x32_bf16 v[68:71], a[8:11], a[148:151], v[68:71]
    ds_read_b64_tr_b16 a[70:71], v20 offset:40992
    v_mfma_f32_16x16x32_bf16 v[72:75], a[8:11], a[152:155], v[72:75]
    ds_read_b64_tr_b16 a[72:73], v19 offset:64
    v_mfma_f32_16x16x32_bf16 v[76:79], a[8:11], a[156:159], v[76:79]
    ds_read_b64_tr_b16 a[74:75], v20 offset:64
    v_mfma_f32_16x16x32_bf16 v[80:83], a[12:15], a[144:147], v[80:83]
    ds_read_b64_tr_b16 a[76:77], v19 offset:41024
    v_mfma_f32_16x16x32_bf16 v[84:87], a[12:15], a[148:151], v[84:87]
    ds_read_b64_tr_b16 a[78:79], v20 offset:41024
    s_add_u32 m0, s40, 2048
    v_mfma_f32_16x16x32_bf16 v[88:91], a[12:15], a[152:155], v[88:91]
    buffer_load_dwordx4 v11, s[48:51], s38 offen lds
    v_mfma_f32_16x16x32_bf16 v[92:95], a[12:15], a[156:159], v[92:95]
    ds_read_b64_tr_b16 a[80:81], v19 offset:96
    v_mfma_f32_16x16x32_bf16 v[96:99], a[16:19], a[144:147], v[96:99]
    ds_read_b64_tr_b16 a[82:83], v20 offset:96
    v_mfma_f32_16x16x32_bf16 v[100:103], a[16:19], a[148:151], v[100:103]
    ds_read_b64_tr_b16 a[84:85], v19 offset:41056
    v_mfma_f32_16x16x32_bf16 v[104:107], a[16:19], a[152:155], v[104:107]
    ds_read_b64_tr_b16 a[86:87], v20 offset:41056
    v_mfma_f32_16x16x32_bf16 v[108:111], a[16:19], a[156:159], v[108:111]
    ds_read_b64_tr_b16 a[88:89], v19 offset:128
    s_add_u32 m0, s40, 3072
    v_mfma_f32_16x16x32_bf16 v[112:115], a[20:23], a[144:147], v[112:115]
    buffer_load_dwordx4 v12, s[48:51], s38 offen lds
    v_mfma_f32_16x16x32_bf16 v[116:119], a[20:23], a[148:151], v[116:119]
    ds_read_b64_tr_b16 a[90:91], v20 offset:128
    v_mfma_f32_16x16x32_bf16 v[120:123], a[20:23], a[152:155], v[120:123]
    ds_read_b64_tr_b16 a[92:93], v19 offset:41088
    v_mfma_f32_16x16x32_bf16 v[124:127], a[20:23], a[156:159], v[124:127]
    ds_read_b64_tr_b16 a[94:95], v20 offset:41088
    v_mfma_f32_16x16x32_bf16 v[128:131], a[24:27], a[144:147], v[128:131]
    ds_read_b64_tr_b16 a[96:97], v19 offset:160
    v_mfma_f32_16x16x32_bf16 v[132:135], a[24:27], a[148:151], v[132:135]
    ds_read_b64_tr_b16 a[98:99], v20 offset:160
    s_add_u32 m0, s40, 4096
    v_mfma_f32_16x16x32_bf16 v[136:139], a[24:27], a[152:155], v[136:139]
    buffer_load_dwordx4 v13, s[48:51], s38 offen lds
    v_mfma_f32_16x16x32_bf16 v[140:143], a[24:27], a[156:159], v[140:143]
    ds_read_b64_tr_b16 a[100:101], v19 offset:41120
    v_mfma_f32_16x16x32_bf16 v[144:147], a[28:31], a[144:147], v[144:147]
    ds_read_b64_tr_b16 a[102:103], v20 offset:41120
    v_mfma_f32_16x16x32_bf16 v[148:151], a[28:31], a[148:151], v[148:151]
    ds_read_b64_tr_b16 a[104:105], v19 offset:192
    v_mfma_f32_16x16x32_bf16 v[152:155], a[28:31], a[152:155], v[152:155]
    ds_read_b64_tr_b16 a[106:107], v20 offset:192
    v_mfma_f32_16x16x32_bf16 v[156:159], a[28:31], a[156:159], v[156:159]
    ds_read_b64_tr_b16 a[108:109], v19 offset:41152
    s_add_u32 m0, s40, 5120
    v_mfma_f32_16x16x32_bf16 v[160:163], a[32:35], a[144:147], v[160:163]
    buffer_load_dwordx4 v14, s[48:51], s38 offen lds
    v_mfma_f32_16x16x32_bf16 v[164:167], a[32:35], a[148:151], v[164:167]
    ds_read_b64_tr_b16 a[110:111], v20 offset:41152
    v_mfma_f32_16x16x32_bf16 v[168:171], a[32:35], a[152:155], v[168:171]
    v_mfma_f32_16x16x32_bf16 v[172:175], a[32:35], a[156:159], v[172:175]
    v_mfma_f32_16x16x32_bf16 v[176:179], a[36:39], a[144:147], v[176:179]
    v_mfma_f32_16x16x32_bf16 v[180:183], a[36:39], a[148:151], v[180:183]
    s_add_u32 m0, s40, 6144
    v_mfma_f32_16x16x32_bf16 v[184:187], a[36:39], a[152:155], v[184:187]
    buffer_load_dwordx4 v15, s[48:51], s38 offen lds
    v_mfma_f32_16x16x32_bf16 v[188:191], a[36:39], a[156:159], v[188:191]
    v_mfma_f32_16x16x32_bf16 v[192:195], a[40:43], a[144:147], v[192:195]
    v_mfma_f32_16x16x32_bf16 v[196:199], a[40:43], a[148:151], v[196:199]
    v_mfma_f32_16x16x32_bf16 v[200:203], a[40:43], a[152:155], v[200:203]
    v_mfma_f32_16x16x32_bf16 v[204:207], a[40:43], a[156:159], v[204:207]
    s_add_u32 m0, s40, 7168
    v_mfma_f32_16x16x32_bf16 v[208:211], a[44:47], a[144:147], v[208:211]
    buffer_load_dwordx4 v16, s[48:51], s38 offen lds
    v_mfma_f32_16x16x32_bf16 v[212:215], a[44:47], a[148:151], v[212:215]
    v_mfma_f32_16x16x32_bf16 v[216:219], a[44:47], a[152:155], v[216:219]
    s_add_u32 s41, s41, 1
    s_cmp_eq_u32 s41, 3
    s_cselect_b32 s41, 0, s41
    s_cselect_b32 s57, -2, 1
    s_mul_i32 s57, s57, 7168
    v_mfma_f32_16x16x32_bf16 v[220:223], a[44:47], a[156:159], v[220:223]
    v_add_u32 v17, s57, v17
    v_add_u32 v18, s57, v18
    v_mfma_f32_16x16x32_bf16 v[224:227], a[48:51], a[144:147], v[224:227]
    v_add_u32 v19, s57, v19
    v_add_u32 v20, s57, v20
    v_mfma_f32_16x16x32_bf16 v[228:231], a[48:51], a[148:151], v[228:231]
    s_add_u32 s38, s38, 128
    s_and_b32 s38, s38, 2047
    buffer_load_dword v1, v24, s[44:47], s43 offen
    v_mfma_f32_16x16x32_bf16 v[232:235], a[48:51], a[152:155], v[232:235]
    s_add_u32 s43, s43, 524288
    v_mfma_f32_16x16x32_bf16 v[236:239], a[48:51], a[156:159], v[236:239]
    v_mfma_f32_16x16x32_bf16 v[240:243], a[52:55], a[144:147], v[240:243]
    s_waitcnt vmcnt(17) lgkmcnt(0)
    s_barrier
    v_mfma_f32_16x16x32_bf16 v[244:247], a[52:55], a[148:151], v[244:247]
    s_cmp_lt_u32 s13, 2
    s_cbranch_scc1 gated_mix__ssm_conv_s4__swiglu_ffn__prompt_kernel_u2_o
gated_mix__ssm_conv_s4__swiglu_ffn__prompt_kernel_u2_b:
    s_sub_u32 s96, s96, 2
    v_mfma_f32_16x16x32_bf16 v[248:251], a[52:55], a[152:155], v[248:251]
    s_add_u32 s97, s96, 6
    s_cmp_lt_u32 s97, 2
    s_cbranch_scc1 gated_mix__ssm_conv_s4__swiglu_ffn__prompt_kernel_u2_f
gated_mix__ssm_conv_s4__swiglu_ffn__prompt_kernel_u2_g:
    v_mfma_f32_16x16x32_bf16 v[252:255], a[52:55], a[156:159], v[252:255]
    s_sub_u32 s13, s13, 2
    v_mfma_f32_16x16x32_bf16 v[32:35], a[56:59], a[160:163], v[32:35]
    ds_read_b64_tr_b16 a[0:1], v17 offset:0
    v_mfma_f32_16x16x32_bf16 v[36:39], a[56:59], a[164:167], v[36:39]
    ds_read_b64_tr_b16 a[2:3], v18 offset:0
    v_mfma_f32_16x16x32_bf16 v[40:43], a[56:59], a[168:171], v[40:43]
    ds_read_b64_tr_b16 a[4:5], v17 offset:40960
    s_add_u32 m0, s39, 0
    v_mfma_f32_16x16x32_bf16 v[44:47], a[56:59], a[172:175], v[44:47]
    buffer_load_dwordx4 v2, s[52:55], s37 offen lds
    v_mfma_f32_16x16x32_bf16 v[48:51], a[60:63], a[160:163], v[48:51]
    ds_read_b64_tr_b16 a[6:7], v18 offset:40960
    v_mfma_f32_16x16x32_bf16 v[52:55], a[60:63], a[164:167], v[52:55]
    ds_read_b64_tr_b16 a[8:9], v17 offset:32
    v_mfma_f32_16x16x32_bf16 v[56:59], a[60:63], a[168:171], v[56:59]
    ds_read_b64_tr_b16 a[10:11], v18 offset:32
    v_mfma_f32_16x16x32_bf16 v[60:63], a[60:63], a[172:175], v[60:63]
    ds_read_b64_tr_b16 a[12:13], v17 offset:40992
    v_mfma_f32_16x16x32_bf16 v[64:67], a[64:67], a[160:163], v[64:67]
    ds_read_b64_tr_b16 a[14:15], v18 offset:40992
    v_mfma_f32_16x16x32_bf16 v[68:71], a[64:67], a[164:167], v[68:71]
    ds_read_b64_tr_b16 a[16:17], v17 offset:64
    s_add_u32 m0, s39, 1024
    v_mfma_f32_16x16x32_bf16 v[72:75], a[64:67], a[168:171], v[72:75]
    buffer_load_dwordx4 v3, s[52:55], s37 offen lds
    v_mfma_f32_16x16x32_bf16 v[76:79], a[64:67], a[172:175], v[76:79]
    ds_read_b64_tr_b16 a[18:19], v18 offset:64
    v_mfma_f32_16x16x32_bf16 v[80:83], a[68:71], a[160:163], v[80:83]
    ds_read_b64_tr_b16 a[20:21], v17 offset:41024
    v_mfma_f32_16x16x32_bf16 v[84:87], a[68:71], a[164:167], v[84:87]
    ds_read_b64_tr_b16 a[22:23], v18 offset:41024
    v_mfma_f32_16x16x32_bf16 v[88:91], a[68:71], a[168:171], v[88:91]
    ds_read_b64_tr_b16 a[24:25], v17 offset:96
    v_mfma_f32_16x16x32_bf16 v[92:95], a[68:71], a[172:175], v[92:95]
    ds_read_b64_tr_b16 a[26:27], v18 offset:96
    v_mfma_f32_16x16x32_bf16 v[96:99], a[72:75], a[160:163], v[96:99]
    ds_read_b64_tr_b16 a[28:29], v17 offset:41056
    s_add_u32 m0, s39, 2048
    v_mfma_f32_16x16x32_bf16 v[100:103], a[72:75], a[164:167], v[100:103]
    buffer_load_dwordx4 v4, s[52:55], s37 offen lds
    v_mfma_f32_16x16x32_bf16 v[104:107], a[72:75], a[168:171], v[104:107]
    ds_read_b64_tr_b16 a[30:31], v18 offset:41056
    v_mfma_f32_16x16x32_bf16 v[108:111], a[72:75], a[172:175], v[108:111]
    ds_read_b64_tr_b16 a[32:33], v17 offset:128
    v_mfma_f32_16x16x32_bf16 v[112:115], a[76:79], a[160:163], v[112:115]
    ds_read_b64_tr_b16 a[34:35], v18 offset:128
    v_mfma_f32_16x16x32_bf16 v[116:119], a[76:79], a[164:167], v[116:119]
    ds_read_b64_tr_b16 a[36:37], v17 offset:41088
    v_mfma_f32_16x16x32_bf16 v[120:123], a[76:79], a[168:171], v[120:123]
    ds_read_b64_tr_b16 a[38:39], v18 offset:41088
    v_mfma_f32_16x16x32_bf16 v[124:127], a[76:79], a[172:175], v[124:127]
    ds_read_b64_tr_b16 a[40:41], v17 offset:160
    s_add_u32 m0, s39, 3072
    v_mfma_f32_16x16x32_bf16 v[128:131], a[80:83], a[160:163], v[128:131]
    buffer_load_dwordx4 v5, s[52:55], s37 offen lds
    v_mfma_f32_16x16x32_bf16 v[132:135], a[80:83], a[164:167], v[132:135]
    ds_read_b64_tr_b16 a[42:43], v18 offset:160
    v_mfma_f32_16x16x32_bf16 v[136:139], a[80:83], a[168:171], v[136:139]
    ds_read_b64_tr_b16 a[44:45], v17 offset:41120
    v_mfma_f32_16x16x32_bf16 v[140:143], a[80:83], a[172:175], v[140:143]
    ds_read_b64_tr_b16 a[46:47], v18 offset:41120
    v_mfma_f32_16x16x32_bf16 v[144:147], a[84:87], a[160:163], v[144:147]
    ds_read_b64_tr_b16 a[48:49], v17 offset:192
    v_mfma_f32_16x16x32_bf16 v[148:151], a[84:87], a[164:167], v[148:151]
    ds_read_b64_tr_b16 a[50:51], v18 offset:192
    v_mfma_f32_16x16x32_bf16 v[152:155], a[84:87], a[168:171], v[152:155]
    ds_read_b64_tr_b16 a[52:53], v17 offset:41152
    s_add_u32 m0, s39, 4096
    v_mfma_f32_16x16x32_bf16 v[156:159], a[84:87], a[172:175], v[156:159]
    buffer_load_dwordx4 v6, s[52:55], s37 offen lds
    v_mfma_f32_16x16x32_bf16 v[160:163], a[88:91], a[160:163], v[160:163]
    ds_read_b64_tr_b16 a[54:55], v18 offset:41152
    v_mfma_f32_16x16x32_bf16 v[164:167], a[88:91], a[164:167], v[164:167]
    ds_read_b128 a[112:115], v21 offset:32768
    v_mfma_f32_16x16x32_bf16 v[168:171], a[88:91], a[168:171], v[168:171]
    ds_read_b128 a[116:119], v21 offset:34816
    v_mfma_f32_16x16x32_bf16 v[172:175], a[88:91], a[172:175], v[172:175]
    ds_read_b128 a[120:123], v21 offset:36864
    v_mfma_f32_16x16x32_bf16 v[176:179], a[92:95], a[160:163], v[176:179]
    ds_read_b128 a[124:127], v21 offset:38912
    v_mfma_f32_16x16x32_bf16 v[180:183], a[92:95], a[164:167], v[180:183]
    ds_read_b128 a[128:131], v22 offset:32768
    s_add_u32 m0, s39, 5120
    v_mfma_f32_16x16x32_bf16 v[184:187], a[92:95], a[168:171], v[184:187]
    buffer_load_dwordx4 v7, s[52:55], s37 offen lds
    v_mfma_f32_16x16x32_bf16 v[188:191], a[92:95], a[172:175], v[188:191]
    ds_read_b128 a[132:135], v22 offset:34816
    v_mfma_f32_16x16x32_bf16 v[192:195], a[96:99], a[160:163], v[192:195]
    ds_read_b128 a[136:139], v22 offset:36864
    v_mfma_f32_16x16x32_bf16 v[196:199], a[96:99], a[164:167], v[196:199]
    ds_read_b128 a[140:143], v22 offset:38912
    v_mfma_f32_16x16x32_bf16 v[200:203], a[96:99], a[168:171], v[200:203]
    v_mfma_f32_16x16x32_bf16 v[204:207], a[96:99], a[172:175], v[204:207]
    v_mfma_f32_16x16x32_bf16 v[208:211], a[100:103], a[160:163], v[208:211]
    s_add_u32 m0, s39, 6144
    v_mfma_f32_16x16x32_bf16 v[212:215], a[100:103], a[164:167], v[212:215]
    buffer_load_dwordx4 v8, s[52:55], s37 offen lds
    v_mfma_f32_16x16x32_bf16 v[216:219], a[100:103], a[168:171], v[216:219]
    s_add_u32 s37, s37, 458752
    s_add_u32 s39, s39, 7168
    s_sub_u32 s56, s39, s40
    v_mfma_f32_16x16x32_bf16 v[220:223], a[100:103], a[172:175], v[220:223]
    s_cmp_ge_u32 s56, 29696
    s_cselect_b32 s56, 21504, 0
    s_sub_u32 s39, s39, s56
    s_cmp_ge_u32 s37, 7340032
    s_cselect_b32 s37, 0, s37
    v_mfma_f32_16x16x32_bf16 v[224:227], a[104:107], a[160:163], v[224:227]
    v_mfma_f32_16x16x32_bf16 v[228:231], a[104:107], a[164:167], v[228:231]
    v_mfma_f32_16x16x32_bf16 v[232:235], a[104:107], a[168:171], v[232:235]
    v_mfma_f32_16x16x32_bf16 v[236:239], a[104:107], a[172:175], v[236:239]
    v_mfma_f32_16x16x32_bf16 v[240:243], a[108:111], a[160:163], v[240:243]
    v_mfma_f32_16x16x32_bf16 v[244:247], a[108:111], a[164:167], v[244:247]
    v_mfma_f32_16x16x32_bf16 v[248:251], a[108:111], a[168:171], v[248:251]
    v_mfma_f32_16x16x32_bf16 v[252:255], a[108:111], a[172:175], v[252:255]
    s_waitcnt lgkmcnt(0)
    s_mov_b32 s42, 6
.p2align 6
gated_mix__ssm_conv_s4__swiglu_ffn__prompt_kernel_l1:
    v_mfma_f32_16x16x32_bf16 v[32:35], a[0:3], a[112:115], v[32:35]
    ds_read_b64_tr_b16 a[56:57], v19 offset:0
    s_cmp_eq_u32 s42, 1
    s_cselect_b32 s97, 0, 0x7ff00000
    buffer_load_dword v25, v30, s[8:11], s97 offen sc1
    v_mfma_f32_16x16x32_bf16 v[36:39], a[0:3], a[116:119], v[36:39]
    ds_read_b64_tr_b16 a[58:59], v20 offset:0
    s_add_u32 m0, s40, 32768
    v_mfma_f32_16x16x32_bf16 v[40:43], a[0:3], a[120:123], v[40:43]
    buffer_load_dwordx4 v9, s[48:51], s38 offen lds
    v_mfma_f32_16x16x32_bf16 v[44:47], a[0:3], a[124:127], v[44:47]
    ds_read_b64_tr_b16 a[60:61], v19 offset:40960
    v_mfma_f32_16x16x32_bf16 v[48:51], a[4:7], a[112:115], v[48:51]
    ds_read_b64_tr_b16 a[62:63], v20 offset:40960
    v_mfma_f32_16x16x32_bf16 v[52:55], a[4:7], a[116:119], v[52:55]
    ds_read_b64_tr_b16 a[64:65], v19 offset:32
    v_mfma_f32_16x16x32_bf16 v[56:59], a[4:7], a[120:123], v[56:59]
    ds_read_b64_tr_b16 a[66:67], v20 offset:32
    v_mfma_f32_16x16x32_bf16 v[60:63], a[4:7], a[124:127], v[60:63]
    ds_read_b64_tr_b16 a[68:69], v19 offset:40992
    s_add_u32 m0, s40, 33792
    v_mfma_f32_16x16x32_bf16 v[64:67], a[8:11], a[112:115], v[64:67]
    buffer_load_dwordx4 v10, s[48:51], s38 offen lds
    v_mfma_f32_16x16x32_bf16 v[68:71], a[8:11], a[116:119], v[68:71]
    ds_read_b64_tr_b16 a[70:71], v20 offset:40992
    v_mfma_f32_16x16x32_bf16 v[72:75], a[8:11], a[120:123], v[72:75]
    ds_read_b64_tr_b16 a[72:73], v19 offset:64
    v_mfma_f32_16x16x32_bf16 v[76:79], a[8:11], a[124:127], v[76:79]
    ds_read_b64_tr_b16 a[74:75], v20 offset:64
    v_mfma_f32_16x16x32_bf16 v[80:83], a[12:15], a[112:115], v[80:83]
    ds_read_b64_tr_b16 a[76:77], v19 offset:41024
    v_mfma_f32_16x16x32_bf16 v[84:87], a[12:15], a[116:119], v[84:87]
    ds_read_b64_tr_b16 a[78:79], v20 offset:41024
    s_add_u32 m0, s40, 34816
    v_mfma_f32_16x16x32_bf16 v[88:91], a[12:15], a[120:123], v[88:91]
    buffer_load_dwordx4 v11, s[48:51], s38 offen lds
    v_mfma_f32_16x16x32_bf16 v[92:95], a[12:15], a[124:127], v[92:95]
    ds_read_b64_tr_b16 a[80:81], v19 offset:96
    v_mfma_f32_16x16x32_bf16 v[96:99], a[16:19], a[112:115], v[96:99]
    ds_read_b64_tr_b16 a[82:83], v20 offset:96
    v_mfma_f32_16x16x32_bf16 v[100:103], a[16:19], a[116:119], v[100:103]
    ds_read_b64_tr_b16 a[84:85], v19 offset:41056
    v_mfma_f32_16x16x32_bf16 v[104:107], a[16:19], a[120:123], v[104:107]
    ds_read_b64_tr_b16 a[86:87], v20 offset:41056
    v_mfma_f32_16x16x32_bf16 v[108:111], a[16:19], a[124:127], v[108:111]
    ds_read_b64_tr_b16 a[88:89], v19 offset:128
    s_add_u32 m0, s40, 35840
    v_mfma_f32_16x16x32_bf16 v[112:115], a[20:23], a[112:115], v[112:115]
    buffer_load_dwordx4 v12, s[48:51], s38 offen lds
    v_mfma_f32_16x16x32_bf16 v[116:119], a[20:23], a[116:119], v[116:119]
    ds_read_b64_tr_b16 a[90:91], v20 offset:128
    v_mfma_f32_16x16x32_bf16 v[120:123], a[20:23], a[120:123], v[120:123]
    ds_read_b64_tr_b16 a[92:93], v19 offset:41088
    v_mfma_f32_16x16x32_bf16 v[124:127], a[20:23], a[124:127], v[124:127]
    ds_read_b64_tr_b16 a[94:95], v20 offset:41088
    v_mfma_f32_16x16x32_bf16 v[128:131], a[24:27], a[112:115], v[128:131]
    ds_read_b64_tr_b16 a[96:97], v19 offset:160
    v_mfma_f32_16x16x32_bf16 v[132:135], a[24:27], a[116:119], v[132:135]
    ds_read_b64_tr_b16 a[98:99], v20 offset:160
    s_add_u32 m0, s40, 36864
    v_mfma_f32_16x16x32_bf16 v[136:139], a[24:27], a[120:123], v[136:139]
    buffer_load_dwordx4 v13, s[48:51], s38 offen lds
    v_mfma_f32_16x16x32_bf16 v[140:143], a[24:27], a[124:127], v[140:143]
    ds_read_b64_tr_b16 a[100:101], v19 offset:41120
    v_mfma_f32_16x16x32_bf16 v[144:147], a[28:31], a[112:115], v[144:147]
    ds_read_b64_tr_b16 a[102:103], v20 offset:41120
    v_mfma_f32_16x16x32_bf16 v[148:151], a[28:31], a[116:119], v[148:151]
    ds_read_b64_tr_b16 a[104:105], v19 offset:192
    v_mfma_f32_16x16x32_bf16 v[152:155], a[28:31], a[120:123], v[152:155]
    ds_read_b64_tr_b16 a[106:107], v20 offset:192
    v_mfma_f32_16x16x32_bf16 v[156:159], a[28:31], a[124:127], v[156:159]
    ds_read_b64_tr_b16 a[108:109], v19 offset:41152
    s_add_u32 m0, s40, 37888
    v_mfma_f32_16x16x32_bf16 v[160:163], a[32:35], a[112:115], v[160:163]
    buffer_load_dwordx4 v14, s[48:51], s38 offen lds
    v_mfma_f32_16x16x32_bf16 v[164:167], a[32:35], a[116:119], v[164:167]
    ds_read_b64_tr_b16 a[110:111], v20 offset:41152
    v_mfma_f32_16x16x32_bf16 v[168:171], a[32:35], a[120:123], v[168:171]
    v_mfma_f32_16x16x32_bf16 v[172:175], a[32:35], a[124:127], v[172:175]
    v_mfma_f32_16x16x32_bf16 v[176:179], a[36:39], a[112:115], v[176:179]
    v_mfma_f32_16x16x32_bf16 v[180:183], a[36:39], a[116:119], v[180:183]
    s_add_u32 m0, s40, 38912
    v_mfma_f32_16x16x32_bf16 v[184:187], a[36:39], a[120:123], v[184:187]
    buffer_load_dwordx4 v15, s[48:51], s38 offen lds
    v_mfma_f32_16x16x32_bf16 v[188:191], a[36:39], a[124:127], v[188:191]
    v_mfma_f32_16x16x32_bf16 v[192:195], a[40:43], a[112:115], v[192:195]
    v_mfma_f32_16x16x32_bf16 v[196:199], a[40:43], a[116:119], v[196:199]
    v_mfma_f32_16x16x32_bf16 v[200:203], a[40:43], a[120:123], v[200:203]
    v_mfma_f32_16x16x32_bf16 v[204:207], a[40:43], a[124:127], v[204:207]
    s_add_u32 m0, s40, 39936
    v_mfma_f32_16x16x32_bf16 v[208:211], a[44:47], a[112:115], v[208:211]
    buffer_load_dwordx4 v16, s[48:51], s38 offen lds
    v_mfma_f32_16x16x32_bf16 v[212:215], a[44:47], a[116:119], v[212:215]
    v_mfma_f32_16x16x32_bf16 v[216:219], a[44:47], a[120:123], v[216:219]
    s_add_u32 s41, s41, 1
    s_cmp_eq_u32 s41, 3
    s_cselect_b32 s41, 0, s41
    s_cselect_b32 s57, -2, 1
    s_mul_i32 s57, s57, 7168
    v_mfma_f32_16x16x32_bf16 v[220:223], a[44:47], a[124:127], v[220:223]
    v_add_u32 v17, s57, v17
    v_add_u32 v18, s57, v18
    v_mfma_f32_16x16x32_bf16 v[224:227], a[48:51], a[112:115], v[224:227]
    s_cmp_gt_u32 s42, 2
    s_cselect_b32 s97, s19, 0x7ff00000
    v_add_u32 v19, s57, v19
    v_add_u32 v20, s57, v20
    v_mfma_f32_16x16x32_bf16 v[228:231], a[48:51], a[116:119], v[228:231]
    s_add_u32 s38, s38, 128
    s_and_b32 s38, s38, 2047
    buffer_load_dword v1, v23, s[52:55], s97 offen
    v_mfma_f32_16x16x32_bf16 v[232:235], a[48:51], a[120:123], v[232:235]
    s_add_u32 s19, s19, 917504
    s_cmp_ge_u32 s19, 7340032
    s_cselect_b32 s19, 0, s19
    v_mfma_f32_16x16x32_bf16 v[236:239], a[48:51], a[124:127], v[236:239]
    v_mfma_f32_16x16x32_bf16 v[240:243], a[52:55], a[112:115], v[240:243]
    s_waitcnt vmcnt(18) lgkmcnt(0)
    s_barrier
    v_mfma_f32_16x16x32_bf16 v[244:247], a[52:55], a[116:119], v[244:247]
    s_cmp_lt_u32 s13, 2
    s_cbranch_scc1 gated_mix__ssm_conv_s4__swiglu_ffn__prompt_kernel_u3_o
gated_mix__ssm_conv_s4__swiglu_ffn__prompt_kernel_u3_b:
    s_sub_u32 s96, s96, 2
    v_mfma_f32_16x16x32_bf16 v[248:251], a[52:55], a[120:123], v[248:251]
    s_add_u32 s97, s96, 6
    s_cmp_lt_u32 s97, 2
    s_cbranch_scc1 gated_mix__ssm_conv_s4__swiglu_ffn__prompt_kernel_u3_f
gated_mix__ssm_conv_s4__swiglu_ffn__prompt_kernel_u3_g:
    v_mfma_f32_16x16x32_bf16 v[252:255], a[52:55], a[124:127], v[252:255]
    s_sub_u32 s13, s13, 2
    v_mfma_f32_16x16x32_bf16 v[32:35], a[56:59], a[128:131], v[32:35]
    ds_read_b64_tr_b16 a[0:1], v17 offset:0
    v_mfma_f32_16x16x32_bf16 v[36:39], a[56:59], a[132:135], v[36:39]
    ds_read_b64_tr_b16 a[2:3], v18 offset:0
    v_mfma_f32_16x16x32_bf16 v[40:43], a[56:59], a[136:139], v[40:43]
    ds_read_b64_tr_b16 a[4:5], v17 offset:40960
    s_add_u32 m0, s39, 0
    v_mfma_f32_16x16x32_bf16 v[44:47], a[56:59], a[140:143], v[44:47]
    buffer_load_dwordx4 v2, s[52:55], s37 offen lds
    v_mfma_f32_16x16x32_bf16 v[48:51], a[60:63], a[128:131], v[48:51]
    ds_read_b64_tr_b16 a[6:7], v18 offset:40960
    v_mfma_f32_16x16x32_bf16 v[52:55], a[60:63], a[132:135], v[52:55]
    ds_read_b64_tr_b16 a[8:9], v17 offset:32
    v_mfma_f32_16x16x32_bf16 v[56:59], a[60:63], a[136:139], v[56:59]
    ds_read_b64_tr_b16 a[10:11], v18 offset:32
    v_mfma_f32_16x16x32_bf16 v[60:63], a[60:63], a[140:143], v[60:63]
    ds_read_b64_tr_b16 a[12:13], v17 offset:40992
    v_mfma_f32_16x16x32_bf16 v[64:67], a[64:67], a[128:131], v[64:67]
    ds_read_b64_tr_b16 a[14:15], v18 offset:40992
    v_mfma_f32_16x16x32_bf16 v[68:71], a[64:67], a[132:135], v[68:71]
    ds_read_b64_tr_b16 a[16:17], v17 offset:64
    s_add_u32 m0, s39, 1024
    v_mfma_f32_16x16x32_bf16 v[72:75], a[64:67], a[136:139], v[72:75]
    buffer_load_dwordx4 v3, s[52:55], s37 offen lds
    v_mfma_f32_16x16x32_bf16 v[76:79], a[64:67], a[140:143], v[76:79]
    ds_read_b64_tr_b16 a[18:19], v18 offset:64
    v_mfma_f32_16x16x32_bf16 v[80:83], a[68:71], a[128:131], v[80:83]
    ds_read_b64_tr_b16 a[20:21], v17 offset:41024
    v_mfma_f32_16x16x32_bf16 v[84:87], a[68:71], a[132:135], v[84:87]
    ds_read_b64_tr_b16 a[22:23], v18 offset:41024
    v_mfma_f32_16x16x32_bf16 v[88:91], a[68:71], a[136:139], v[88:91]
    ds_read_b64_tr_b16 a[24:25], v17 offset:96
    v_mfma_f32_16x16x32_bf16 v[92:95], a[68:71], a[140:143], v[92:95]
    ds_read_b64_tr_b16 a[26:27], v18 offset:96
    v_mfma_f32_16x16x32_bf16 v[96:99], a[72:75], a[128:131], v[96:99]
    ds_read_b64_tr_b16 a[28:29], v17 offset:41056
    s_add_u32 m0, s39, 2048
    v_mfma_f32_16x16x32_bf16 v[100:103], a[72:75], a[132:135], v[100:103]
    buffer_load_dwordx4 v4, s[52:55], s37 offen lds
    v_mfma_f32_16x16x32_bf16 v[104:107], a[72:75], a[136:139], v[104:107]
    ds_read_b64_tr_b16 a[30:31], v18 offset:41056
    v_mfma_f32_16x16x32_bf16 v[108:111], a[72:75], a[140:143], v[108:111]
    ds_read_b64_tr_b16 a[32:33], v17 offset:128
    v_mfma_f32_16x16x32_bf16 v[112:115], a[76:79], a[128:131], v[112:115]
    ds_read_b64_tr_b16 a[34:35], v18 offset:128
    v_mfma_f32_16x16x32_bf16 v[116:119], a[76:79], a[132:135], v[116:119]
    ds_read_b64_tr_b16 a[36:37], v17 offset:41088
    v_mfma_f32_16x16x32_bf16 v[120:123], a[76:79], a[136:139], v[120:123]
    ds_read_b64_tr_b16 a[38:39], v18 offset:41088
    v_mfma_f32_16x16x32_bf16 v[124:127], a[76:79], a[140:143], v[124:127]
    ds_read_b64_tr_b16 a[40:41], v17 offset:160
    s_add_u32 m0, s39, 3072
    v_mfma_f32_16x16x32_bf16 v[128:131], a[80:83], a[128:131], v[128:131]
    buffer_load_dwordx4 v5, s[52:55], s37 offen lds
    v_mfma_f32_16x16x32_bf16 v[132:135], a[80:83], a[132:135], v[132:135]
    ds_read_b64_tr_b16 a[42:43], v18 offset:160
    v_mfma_f32_16x16x32_bf16 v[136:139], a[80:83], a[136:139], v[136:139]
    ds_read_b64_tr_b16 a[44:45], v17 offset:41120
    v_mfma_f32_16x16x32_bf16 v[140:143], a[80:83], a[140:143], v[140:143]
    ds_read_b64_tr_b16 a[46:47], v18 offset:41120
    v_mfma_f32_16x16x32_bf16 v[144:147], a[84:87], a[128:131], v[144:147]
    ds_read_b64_tr_b16 a[48:49], v17 offset:192
    v_mfma_f32_16x16x32_bf16 v[148:151], a[84:87], a[132:135], v[148:151]
    ds_read_b64_tr_b16 a[50:51], v18 offset:192
    v_mfma_f32_16x16x32_bf16 v[152:155], a[84:87], a[136:139], v[152:155]
    ds_read_b64_tr_b16 a[52:53], v17 offset:41152
    s_add_u32 m0, s39, 4096
    v_mfma_f32_16x16x32_bf16 v[156:159], a[84:87], a[140:143], v[156:159]
    buffer_load_dwordx4 v6, s[52:55], s37 offen lds
    v_mfma_f32_16x16x32_bf16 v[160:163], a[88:91], a[128:131], v[160:163]
    ds_read_b64_tr_b16 a[54:55], v18 offset:41152
    v_mfma_f32_16x16x32_bf16 v[164:167], a[88:91], a[132:135], v[164:167]
    ds_read_b128 a[144:147], v21 offset:0
    v_mfma_f32_16x16x32_bf16 v[168:171], a[88:91], a[136:139], v[168:171]
    ds_read_b128 a[148:151], v21 offset:2048
    v_mfma_f32_16x16x32_bf16 v[172:175], a[88:91], a[140:143], v[172:175]
    ds_read_b128 a[152:155], v21 offset:4096
    v_mfma_f32_16x16x32_bf16 v[176:179], a[92:95], a[128:131], v[176:179]
    ds_read_b128 a[156:159], v21 offset:6144
    v_mfma_f32_16x16x32_bf16 v[180:183], a[92:95], a[132:135], v[180:183]
    ds_read_b128 a[160:163], v22 offset:0
    s_add_u32 m0, s39, 5120
    v_mfma_f32_16x16x32_bf16 v[184:187], a[92:95], a[136:139], v[184:187]
    buffer_load_dwordx4 v7, s[52:55], s37 offen lds
    v_mfma_f32_16x16x32_bf16 v[188:191], a[92:95], a[140:143], v[188:191]
    ds_read_b128 a[164:167], v22 offset:2048
    v_mfma_f32_16x16x32_bf16 v[192:195], a[96:99], a[128:131], v[192:195]
    ds_read_b128 a[168:171], v22 offset:4096
    v_mfma_f32_16x16x32_bf16 v[196:199], a[96:99], a[132:135], v[196:199]
    ds_read_b128 a[172:175], v22 offset:6144
    v_mfma_f32_16x16x32_bf16 v[200:203], a[96:99], a[136:139], v[200:203]
    v_mfma_f32_16x16x32_bf16 v[204:207], a[96:99], a[140:143], v[204:207]
    v_mfma_f32_16x16x32_bf16 v[208:211], a[100:103], a[128:131], v[208:211]
    s_add_u32 m0, s39, 6144
    v_mfma_f32_16x16x32_bf16 v[212:215], a[100:103], a[132:135], v[212:215]
    buffer_load_dwordx4 v8, s[52:55], s37 offen lds
    v_mfma_f32_16x16x32_bf16 v[216:219], a[100:103], a[136:139], v[216:219]
    s_add_u32 s37, s37, 458752
    s_add_u32 s39, s39, 7168
    s_sub_u32 s56, s39, s40
    v_mfma_f32_16x16x32_bf16 v[220:223], a[100:103], a[140:143], v[220:223]
    s_cmp_ge_u32 s56, 29696
    s_cselect_b32 s56, 21504, 0
    s_sub_u32 s39, s39, s56
    s_cmp_ge_u32 s37, 7340032
    s_cselect_b32 s37, 0, s37
    v_mfma_f32_16x16x32_bf16 v[224:227], a[104:107], a[128:131], v[224:227]
    v_mfma_f32_16x16x32_bf16 v[228:231], a[104:107], a[132:135], v[228:231]
    v_mfma_f32_16x16x32_bf16 v[232:235], a[104:107], a[136:139], v[232:235]
    v_mfma_f32_16x16x32_bf16 v[236:239], a[104:107], a[140:143], v[236:239]
    v_mfma_f32_16x16x32_bf16 v[240:243], a[108:111], a[128:131], v[240:243]
    v_mfma_f32_16x16x32_bf16 v[244:247], a[108:111], a[132:135], v[244:247]
    v_mfma_f32_16x16x32_bf16 v[248:251], a[108:111], a[136:139], v[248:251]
    v_mfma_f32_16x16x32_bf16 v[252:255], a[108:111], a[140:143], v[252:255]
    s_waitcnt lgkmcnt(0)
    v_mfma_f32_16x16x32_bf16 v[32:35], a[0:3], a[144:147], v[32:35]
    ds_read_b64_tr_b16 a[56:57], v19 offset:0
    v_mfma_f32_16x16x32_bf16 v[36:39], a[0:3], a[148:151], v[36:39]
    ds_read_b64_tr_b16 a[58:59], v20 offset:0
    s_add_u32 m0, s40, 0
    v_mfma_f32_16x16x32_bf16 v[40:43], a[0:3], a[152:155], v[40:43]
    buffer_load_dwordx4 v9, s[48:51], s38 offen lds
    v_mfma_f32_16x16x32_bf16 v[44:47], a[0:3], a[156:159], v[44:47]
    ds_read_b64_tr_b16 a[60:61], v19 offset:40960
    v_mfma_f32_16x16x32_bf16 v[48:51], a[4:7], a[144:147], v[48:51]
    ds_read_b64_tr_b16 a[62:63], v20 offset:40960
    v_mfma_f32_16x16x32_bf16 v[52:55], a[4:7], a[148:151], v[52:55]
    ds_read_b64_tr_b16 a[64:65], v19 offset:32
    v_mfma_f32_16x16x32_bf16 v[56:59], a[4:7], a[152:155], v[56:59]
    ds_read_b64_tr_b16 a[66:67], v20 offset:32
    v_mfma_f32_16x16x32_bf16 v[60:63], a[4:7], a[156:159], v[60:63]
    ds_read_b64_tr_b16 a[68:69], v19 offset:40992
    s_add_u32 m0, s40, 1024
    v_mfma_f32_16x16x32_bf16 v[64:67], a[8:11], a[144:147], v[64:67]
    buffer_load_dwordx4 v10, s[48:51], s38 offen lds
    v_mfma_f32_16x16x32_bf16 v[68:71], a[8:11], a[148:151], v[68:71]
    ds_read_b64_tr_b16 a[70:71], v20 offset:40992
    v_mfma_f32_16x16x32_bf16 v[72:75], a[8:11], a[152:155], v[72:75]
    ds_read_b64_tr_b16 a[72:73], v19 offset:64
    v_mfma_f32_16x16x32_bf16 v[76:79], a[8:11], a[156:159], v[76:79]
    ds_read_b64_tr_b16 a[74:75], v20 offset:64
    v_mfma_f32_16x16x32_bf16 v[80:83], a[12:15], a[144:147], v[80:83]
    ds_read_b64_tr_b16 a[76:77], v19 offset:41024
    v_mfma_f32_16x16x32_bf16 v[84:87], a[12:15], a[148:151], v[84:87]
    ds_read_b64_tr_b16 a[78:79], v20 offset:41024
    s_add_u32 m0, s40, 2048
    v_mfma_f32_16x16x32_bf16 v[88:91], a[12:15], a[152:155], v[88:91]
    buffer_load_dwordx4 v11, s[48:51], s38 offen lds
    v_mfma_f32_16x16x32_bf16 v[92:95], a[12:15], a[156:159], v[92:95]
    ds_read_b64_tr_b16 a[80:81], v19 offset:96
    v_mfma_f32_16x16x32_bf16 v[96:99], a[16:19], a[144:147], v[96:99]
    ds_read_b64_tr_b16 a[82:83], v20 offset:96
    v_mfma_f32_16x16x32_bf16 v[100:103], a[16:19], a[148:151], v[100:103]
    ds_read_b64_tr_b16 a[84:85], v19 offset:41056
    v_mfma_f32_16x16x32_bf16 v[104:107], a[16:19], a[152:155], v[104:107]
    ds_read_b64_tr_b16 a[86:87], v20 offset:41056
    v_mfma_f32_16x16x32_bf16 v[108:111], a[16:19], a[156:159], v[108:111]
    ds_read_b64_tr_b16 a[88:89], v19 offset:128
    s_add_u32 m0, s40, 3072
    v_mfma_f32_16x16x32_bf16 v[112:115], a[20:23], a[144:147], v[112:115]
    buffer_load_dwordx4 v12, s[48:51], s38 offen lds
    v_mfma_f32_16x16x32_bf16 v[116:119], a[20:23], a[148:151], v[116:119]
    ds_read_b64_tr_b16 a[90:91], v20 offset:128
    v_mfma_f32_16x16x32_bf16 v[120:123], a[20:23], a[152:155], v[120:123]
    ds_read_b64_tr_b16 a[92:93], v19 offset:41088
    v_mfma_f32_16x16x32_bf16 v[124:127], a[20:23], a[156:159], v[124:127]
    ds_read_b64_tr_b16 a[94:95], v20 offset:41088
    v_mfma_f32_16x16x32_bf16 v[128:131], a[24:27], a[144:147], v[128:131]
    ds_read_b64_tr_b16 a[96:97], v19 offset:160
    v_mfma_f32_16x16x32_bf16 v[132:135], a[24:27], a[148:151], v[132:135]
    ds_read_b64_tr_b16 a[98:99], v20 offset:160
    s_add_u32 m0, s40, 4096
    v_mfma_f32_16x16x32_bf16 v[136:139], a[24:27], a[152:155], v[136:139]
    buffer_load_dwordx4 v13, s[48:51], s38 offen lds
    v_mfma_f32_16x16x32_bf16 v[140:143], a[24:27], a[156:159], v[140:143]
    ds_read_b64_tr_b16 a[100:101], v19 offset:41120
    v_mfma_f32_16x16x32_bf16 v[144:147], a[28:31], a[144:147], v[144:147]
    ds_read_b64_tr_b16 a[102:103], v20 offset:41120
    v_mfma_f32_16x16x32_bf16 v[148:151], a[28:31], a[148:151], v[148:151]
    ds_read_b64_tr_b16 a[104:105], v19 offset:192
    v_mfma_f32_16x16x32_bf16 v[152:155], a[28:31], a[152:155], v[152:155]
    ds_read_b64_tr_b16 a[106:107], v20 offset:192
    v_mfma_f32_16x16x32_bf16 v[156:159], a[28:31], a[156:159], v[156:159]
    ds_read_b64_tr_b16 a[108:109], v19 offset:41152
    s_add_u32 m0, s40, 5120
    v_mfma_f32_16x16x32_bf16 v[160:163], a[32:35], a[144:147], v[160:163]
    buffer_load_dwordx4 v14, s[48:51], s38 offen lds
    v_mfma_f32_16x16x32_bf16 v[164:167], a[32:35], a[148:151], v[164:167]
    ds_read_b64_tr_b16 a[110:111], v20 offset:41152
    v_mfma_f32_16x16x32_bf16 v[168:171], a[32:35], a[152:155], v[168:171]
    v_mfma_f32_16x16x32_bf16 v[172:175], a[32:35], a[156:159], v[172:175]
    v_mfma_f32_16x16x32_bf16 v[176:179], a[36:39], a[144:147], v[176:179]
    v_mfma_f32_16x16x32_bf16 v[180:183], a[36:39], a[148:151], v[180:183]
    s_add_u32 m0, s40, 6144
    v_mfma_f32_16x16x32_bf16 v[184:187], a[36:39], a[152:155], v[184:187]
    buffer_load_dwordx4 v15, s[48:51], s38 offen lds
    v_mfma_f32_16x16x32_bf16 v[188:191], a[36:39], a[156:159], v[188:191]
    v_mfma_f32_16x16x32_bf16 v[192:195], a[40:43], a[144:147], v[192:195]
    v_mfma_f32_16x16x32_bf16 v[196:199], a[40:43], a[148:151], v[196:199]
    v_mfma_f32_16x16x32_bf16 v[200:203], a[40:43], a[152:155], v[200:203]
    v_mfma_f32_16x16x32_bf16 v[204:207], a[40:43], a[156:159], v[204:207]
    s_add_u32 m0, s40, 7168
    v_mfma_f32_16x16x32_bf16 v[208:211], a[44:47], a[144:147], v[208:211]
    buffer_load_dwordx4 v16, s[48:51], s38 offen lds
    v_mfma_f32_16x16x32_bf16 v[212:215], a[44:47], a[148:151], v[212:215]
    v_mfma_f32_16x16x32_bf16 v[216:219], a[44:47], a[152:155], v[216:219]
    s_add_u32 s41, s41, 1
    s_cmp_eq_u32 s41, 3
    s_cselect_b32 s41, 0, s41
    s_cselect_b32 s57, -2, 1
    s_mul_i32 s57, s57, 7168
    v_mfma_f32_16x16x32_bf16 v[220:223], a[44:47], a[156:159], v[220:223]
    v_add_u32 v17, s57, v17
    v_add_u32 v18, s57, v18
    v_mfma_f32_16x16x32_bf16 v[224:227], a[48:51], a[144:147], v[224:227]
    v_add_u32 v19, s57, v19
    v_add_u32 v20, s57, v20
    v_mfma_f32_16x16x32_bf16 v[228:231], a[48:51], a[148:151], v[228:231]
    s_add_u32 s38, s38, 128
    s_and_b32 s38, s38, 2047
    buffer_load_dword v1, v24, s[44:47], s43 offen
    v_mfma_f32_16x16x32_bf16 v[232:235], a[48:51], a[152:155], v[232:235]
    s_add_u32 s43, s43, 524288
    v_mfma_f32_16x16x32_bf16 v[236:239], a[48:51], a[156:159], v[236:239]
    v_mfma_f32_16x16x32_bf16 v[240:243], a[52:55], a[144:147], v[240:243]
    s_waitcnt vmcnt(17) lgkmcnt(0)
    s_barrier
    v_mfma_f32_16x16x32_bf16 v[244:247], a[52:55], a[148:151], v[244:247]
    s_cmp_lt_u32 s13, 2
    s_cbranch_scc1 gated_mix__ssm_conv_s4__swiglu_ffn__prompt_kernel_u4_o
gated_mix__ssm_conv_s4__swiglu_ffn__prompt_kernel_u4_b:
    s_sub_u32 s96, s96, 2
    v_mfma_f32_16x16x32_bf16 v[248:251], a[52:55], a[152:155], v[248:251]
    s_add_u32 s97, s96, 6
    s_cmp_lt_u32 s97, 2
    s_cbranch_scc1 gated_mix__ssm_conv_s4__swiglu_ffn__prompt_kernel_u4_f
gated_mix__ssm_conv_s4__swiglu_ffn__prompt_kernel_u4_g:
    v_mfma_f32_16x16x32_bf16 v[252:255], a[52:55], a[156:159], v[252:255]
    s_sub_u32 s13, s13, 2
    v_mfma_f32_16x16x32_bf16 v[32:35], a[56:59], a[160:163], v[32:35]
    ds_read_b64_tr_b16 a[0:1], v17 offset:0
    v_mfma_f32_16x16x32_bf16 v[36:39], a[56:59], a[164:167], v[36:39]
    ds_read_b64_tr_b16 a[2:3], v18 offset:0
    v_mfma_f32_16x16x32_bf16 v[40:43], a[56:59], a[168:171], v[40:43]
    ds_read_b64_tr_b16 a[4:5], v17 offset:40960
    s_add_u32 m0, s39, 0
    v_mfma_f32_16x16x32_bf16 v[44:47], a[56:59], a[172:175], v[44:47]
    buffer_load_dwordx4 v2, s[52:55], s37 offen lds
    v_mfma_f32_16x16x32_bf16 v[48:51], a[60:63], a[160:163], v[48:51]
    ds_read_b64_tr_b16 a[6:7], v18 offset:40960
    v_mfma_f32_16x16x32_bf16 v[52:55], a[60:63], a[164:167], v[52:55]
    ds_read_b64_tr_b16 a[8:9], v17 offset:32
    v_mfma_f32_16x16x32_bf16 v[56:59], a[60:63], a[168:171], v[56:59]
    ds_read_b64_tr_b16 a[10:11], v18 offset:32
    v_mfma_f32_16x16x32_bf16 v[60:63], a[60:63], a[172:175], v[60:63]
    ds_read_b64_tr_b16 a[12:13], v17 offset:40992
    v_mfma_f32_16x16x32_bf16 v[64:67], a[64:67], a[160:163], v[64:67]
    ds_read_b64_tr_b16 a[14:15], v18 offset:40992
    v_mfma_f32_16x16x32_bf16 v[68:71], a[64:67], a[164:167], v[68:71]
    ds_read_b64_tr_b16 a[16:17], v17 offset:64
    s_add_u32 m0, s39, 1024
    v_mfma_f32_16x16x32_bf16 v[72:75], a[64:67], a[168:171], v[72:75]
    buffer_load_dwordx4 v3, s[52:55], s37 offen lds
    v_mfma_f32_16x16x32_bf16 v[76:79], a[64:67], a[172:175], v[76:79]
    ds_read_b64_tr_b16 a[18:19], v18 offset:64
    v_mfma_f32_16x16x32_bf16 v[80:83], a[68:71], a[160:163], v[80:83]
    ds_read_b64_tr_b16 a[20:21], v17 offset:41024
    v_mfma_f32_16x16x32_bf16 v[84:87], a[68:71], a[164:167], v[84:87]
    ds_read_b64_tr_b16 a[22:23], v18 offset:41024
    v_mfma_f32_16x16x32_bf16 v[88:91], a[68:71], a[168:171], v[88:91]
    ds_read_b64_tr_b16 a[24:25], v17 offset:96
    v_mfma_f32_16x16x32_bf16 v[92:95], a[68:71], a[172:175], v[92:95]
    ds_read_b64_tr_b16 a[26:27], v18 offset:96
    v_mfma_f32_16x16x32_bf16 v[96:99], a[72:75], a[160:163], v[96:99]
    ds_read_b64_tr_b16 a[28:29], v17 offset:41056
    s_add_u32 m0, s39, 2048
    v_mfma_f32_16x16x32_bf16 v[100:103], a[72:75], a[164:167], v[100:103]
    buffer_load_dwordx4 v4, s[52:55], s37 offen lds
    v_mfma_f32_16x16x32_bf16 v[104:107], a[72:75], a[168:171], v[104:107]
    ds_read_b64_tr_b16 a[30:31], v18 offset:41056
    v_mfma_f32_16x16x32_bf16 v[108:111], a[72:75], a[172:175], v[108:111]
    ds_read_b64_tr_b16 a[32:33], v17 offset:128
    v_mfma_f32_16x16x32_bf16 v[112:115], a[76:79], a[160:163], v[112:115]
    ds_read_b64_tr_b16 a[34:35], v18 offset:128
    v_mfma_f32_16x16x32_bf16 v[116:119], a[76:79], a[164:167], v[116:119]
    ds_read_b64_tr_b16 a[36:37], v17 offset:41088
    v_mfma_f32_16x16x32_bf16 v[120:123], a[76:79], a[168:171], v[120:123]
    ds_read_b64_tr_b16 a[38:39], v18 offset:41088
    v_mfma_f32_16x16x32_bf16 v[124:127], a[76:79], a[172:175], v[124:127]
    ds_read_b64_tr_b16 a[40:41], v17 offset:160
    s_add_u32 m0, s39, 3072
    v_mfma_f32_16x16x32_bf16 v[128:131], a[80:83], a[160:163], v[128:131]
    buffer_load_dwordx4 v5, s[52:55], s37 offen lds
    v_mfma_f32_16x16x32_bf16 v[132:135], a[80:83], a[164:167], v[132:135]
    ds_read_b64_tr_b16 a[42:43], v18 offset:160
    v_mfma_f32_16x16x32_bf16 v[136:139], a[80:83], a[168:171], v[136:139]
    ds_read_b64_tr_b16 a[44:45], v17 offset:41120
    v_mfma_f32_16x16x32_bf16 v[140:143], a[80:83], a[172:175], v[140:143]
    ds_read_b64_tr_b16 a[46:47], v18 offset:41120
    v_mfma_f32_16x16x32_bf16 v[144:147], a[84:87], a[160:163], v[144:147]
    ds_read_b64_tr_b16 a[48:49], v17 offset:192
    v_mfma_f32_16x16x32_bf16 v[148:151], a[84:87], a[164:167], v[148:151]
    ds_read_b64_tr_b16 a[50:51], v18 offset:192
    v_mfma_f32_16x16x32_bf16 v[152:155], a[84:87], a[168:171], v[152:155]
    ds_read_b64_tr_b16 a[52:53], v17 offset:41152
    s_add_u32 m0, s39, 4096
    v_mfma_f32_16x16x32_bf16 v[156:159], a[84:87], a[172:175], v[156:159]
    buffer_load_dwordx4 v6, s[52:55], s37 offen lds
    v_mfma_f32_16x16x32_bf16 v[160:163], a[88:91], a[160:163], v[160:163]
    ds_read_b64_tr_b16 a[54:55], v18 offset:41152
    v_mfma_f32_16x16x32_bf16 v[164:167], a[88:91], a[164:167], v[164:167]
    ds_read_b128 a[112:115], v21 offset:32768
    v_mfma_f32_16x16x32_bf16 v[168:171], a[88:91], a[168:171], v[168:171]
    ds_read_b128 a[116:119], v21 offset:34816
    v_mfma_f32_16x16x32_bf16 v[172:175], a[88:91], a[172:175], v[172:175]
    ds_read_b128 a[120:123], v21 offset:36864
    v_mfma_f32_16x16x32_bf16 v[176:179], a[92:95], a[160:163], v[176:179]
    ds_read_b128 a[124:127], v21 offset:38912
    v_mfma_f32_16x16x32_bf16 v[180:183], a[92:95], a[164:167], v[180:183]
    ds_read_b128 a[128:131], v22 offset:32768
    s_add_u32 m0, s39, 5120
    v_mfma_f32_16x16x32_bf16 v[184:187], a[92:95], a[168:171], v[184:187]
    buffer_load_dwordx4 v7, s[52:55], s37 offen lds
    v_mfma_f32_16x16x32_bf16 v[188:191], a[92:95], a[172:175], v[188:191]
    ds_read_b128 a[132:135], v22 offset:34816
    v_mfma_f32_16x16x32_bf16 v[192:195], a[96:99], a[160:163], v[192:195]
    ds_read_b128 a[136:139], v22 offset:36864
    v_mfma_f32_16x16x32_bf16 v[196:199], a[96:99], a[164:167], v[196:199]
    ds_read_b128 a[140:143], v22 offset:38912
    v_mfma_f32_16x16x32_bf16 v[200:203], a[96:99], a[168:171], v[200:203]
    v_mfma_f32_16x16x32_bf16 v[204:207], a[96:99], a[172:175], v[204:207]
    v_mfma_f32_16x16x32_bf16 v[208:211], a[100:103], a[160:163], v[208:211]
    s_add_u32 m0, s39, 6144
    v_mfma_f32_16x16x32_bf16 v[212:215], a[100:103], a[164:167], v[212:215]
    buffer_load_dwordx4 v8, s[52:55], s37 offen lds
    v_mfma_f32_16x16x32_bf16 v[216:219], a[100:103], a[168:171], v[216:219]
    s_add_u32 s37, s37, 458752
    s_add_u32 s39, s39, 7168
    s_sub_u32 s56, s39, s40
    v_mfma_f32_16x16x32_bf16 v[220:223], a[100:103], a[172:175], v[220:223]
    s_cmp_ge_u32 s56, 29696
    s_cselect_b32 s56, 21504, 0
    s_sub_u32 s39, s39, s56
    s_cmp_ge_u32 s37, 7340032
    s_cselect_b32 s37, 0, s37
    v_mfma_f32_16x16x32_bf16 v[224:227], a[104:107], a[160:163], v[224:227]
    v_mfma_f32_16x16x32_bf16 v[228:231], a[104:107], a[164:167], v[228:231]
    v_mfma_f32_16x16x32_bf16 v[232:235], a[104:107], a[168:171], v[232:235]
    v_mfma_f32_16x16x32_bf16 v[236:239], a[104:107], a[172:175], v[236:239]
    v_mfma_f32_16x16x32_bf16 v[240:243], a[108:111], a[160:163], v[240:243]
    v_mfma_f32_16x16x32_bf16 v[244:247], a[108:111], a[164:167], v[244:247]
    s_sub_u32 s42, s42, 1
    s_cmp_lg_u32 s42, 0
    v_mfma_f32_16x16x32_bf16 v[248:251], a[108:111], a[168:171], v[248:251]
    v_mfma_f32_16x16x32_bf16 v[252:255], a[108:111], a[172:175], v[252:255]
    s_waitcnt lgkmcnt(0)
    s_cbranch_scc1 gated_mix__ssm_conv_s4__swiglu_ffn__prompt_kernel_l1
    v_cmp_eq_u32 vcc, 0x01010101, v25
    s_lshl_b32 s58, s33, 14
    s_lshl_b32 s59, s32, 10
    v_lshlrev_b32 v26, 4, v0
    s_add_u32 s58, s58, s59
    s_add_u32 s43, s58, 33554432
    s_cmp_eq_u64 vcc, -1
    s_cbranch_scc0 gated_mix__ssm_conv_s4__swiglu_ffn__prompt_kernel_ipoll
gated_mix__ssm_conv_s4__swiglu_ffn__prompt_kernel_iok:
    v_mfma_f32_16x16x32_bf16 v[32:35], a[0:3], a[112:115], v[32:35]
    ds_read_b64_tr_b16 a[56:57], v19 offset:0
    buffer_load_dwordx4 a[192:195], v26, s[28:31], s43 offen sc1
    v_mfma_f32_16x16x32_bf16 v[36:39], a[0:3], a[116:119], v[36:39]
    ds_read_b64_tr_b16 a[58:59], v20 offset:0
    s_add_u32 s43, s43, 4096
    v_mfma_f32_16x16x32_bf16 v[40:43], a[0:3], a[120:123], v[40:43]
    ds_read_b64_tr_b16 a[60:61], v19 offset:40960
    v_mfma_f32_16x16x32_bf16 v[44:47], a[0:3], a[124:127], v[44:47]
    ds_read_b64_tr_b16 a[62:63], v20 offset:40960
    buffer_load_dwordx4 a[196:199], v26, s[28:31], s43 offen sc1
    v_mfma_f32_16x16x32_bf16 v[48:51], a[4:7], a[112:115], v[48:51]
    ds_read_b64_tr_b16 a[64:65], v19 offset:32
    s_add_u32 s43, s43, 4096
    v_mfma_f32_16x16x32_bf16 v[52:55], a[4:7], a[116:119], v[52:55]
    ds_read_b64_tr_b16 a[66:67], v20 offset:32
    v_mfma_f32_16x16x32_bf16 v[56:59], a[4:7], a[120:123], v[56:59]
    ds_read_b64_tr_b16 a[68:69], v19 offset:40992
    buffer_load_dwordx4 a[200:203], v26, s[28:31], s43 offen sc1
    v_mfma_f32_16x16x32_bf16 v[60:63], a[4:7], a[124:127], v[60:63]
    ds_read_b64_tr_b16 a[70:71], v20 offset:40992
    s_add_u32 s43, s43, 4096
    v_mfma_f32_16x16x32_bf16 v[64:67], a[8:11], a[112:115], v[64:67]
    ds_read_b64_tr_b16 a[72:73], v19 offset:64
    v_mfma_f32_16x16x32_bf16 v[68:71], a[8:11], a[116:119], v[68:71]
    ds_read_b64_tr_b16 a[74:75], v20 offset:64
    buffer_load_dwordx4 a[204:207], v26, s[28:31], s43 offen sc1
    v_mfma_f32_16x16x32_bf16 v[72:75], a[8:11], a[120:123], v[72:75]
    ds_read_b64_tr_b16 a[76:77], v19 offset:41024
    s_add_u32 s43, s43, 4096
    v_mfma_f32_16x16x32_bf16 v[76:79], a[8:11], a[124:127], v[76:79]
    ds_read_b64_tr_b16 a[78:79], v20 offset:41024
    v_mfma_f32_16x16x32_bf16 v[80:83], a[12:15], a[112:115], v[80:83]
    ds_read_b64_tr_b16 a[80:81], v19 offset:96
    v_mfma_f32_16x16x32_bf16 v[84:87], a[12:15], a[116:119], v[84:87]
    ds_read_b64_tr_b16 a[82:83], v20 offset:96
    v_mfma_f32_16x16x32_bf16 v[88:91], a[12:15], a[120:123], v[88:91]
    ds_read_b64_tr_b16 a[84:85], v19 offset:41056
    s_lshl_b32 s58, s32, 8
    s_add_u32 s58, s58, 32704
    v_add_u32 v13, s58, v30
    v_mfma_f32_16x16x32_bf16 v[92:95], a[12:15], a[124:127], v[92:95]
    ds_read_b64_tr_b16 a[86:87], v20 offset:41056
    v_add_u32 v14, 81920, v13
    v_mfma_f32_16x16x32_bf16 v[96:99], a[16:19], a[112:115], v[96:99]
    ds_read_b64_tr_b16 a[88:89], v19 offset:128
    v_mfma_f32_16x16x32_bf16 v[100:103], a[16:19], a[116:119], v[100:103]
    ds_read_b64_tr_b16 a[90:91], v20 offset:128
    v_mfma_f32_16x16x32_bf16 v[104:107], a[16:19], a[120:123], v[104:107]
    ds_read_b64_tr_b16 a[92:93], v19 offset:41088
    v_mfma_f32_16x16x32_bf16 v[108:111], a[16:19], a[124:127], v[108:111]
    ds_read_b64_tr_b16 a[94:95], v20 offset:41088
    v_mfma_f32_16x16x32_bf16 v[112:115], a[20:23], a[112:115], v[112:115]
    ds_read_b64_tr_b16 a[96:97], v19 offset:160
    v_mfma_f32_16x16x32_bf16 v[116:119], a[20:23], a[116:119], v[116:119]
    ds_read_b64_tr_b16 a[98:99], v20 offset:160
    v_mfma_f32_16x16x32_bf16 v[120:123], a[20:23], a[120:123], v[120:123]
    ds_read_b64_tr_b16 a[100:101], v19 offset:41120
    v_mfma_f32_16x16x32_bf16 v[124:127], a[20:23], a[124:127], v[124:127]
    ds_read_b64_tr_b16 a[102:103], v20 offset:41120
    v_mfma_f32_16x16x32_bf16 v[128:131], a[24:27], a[112:115], v[128:131]
    ds_read_b64_tr_b16 a[104:105], v19 offset:192
    v_mfma_f32_16x16x32_bf16 v[132:135], a[24:27], a[116:119], v[132:135]
    ds_read_b64_tr_b16 a[106:107], v20 offset:192
    v_mfma_f32_16x16x32_bf16 v[136:139], a[24:27], a[120:123], v[136:139]
    ds_read_b64_tr_b16 a[108:109], v19 offset:41152
    v_mfma_f32_16x16x32_bf16 v[140:143], a[24:27], a[124:127], v[140:143]
    ds_read_b64_tr_b16 a[110:111], v20 offset:41152
    v_mfma_f32_16x16x32_bf16 v[144:147], a[28:31], a[112:115], v[144:147]
    s_and_b32 s56, s2, 7
    s_lshr_b32 s57, s2, 3
    s_and_b32 s58, s56, 2
    s_lshl_b32 s58, s58, 2
    v_mfma_f32_16x16x32_bf16 v[148:151], a[28:31], a[116:119], v[148:151]
    s_and_b32 s59, s57, 7
    s_add_u32 s96, s58, s59
    s_and_b32 s58, s56, 1
    s_lshl_b32 s58, s58, 2
    v_mfma_f32_16x16x32_bf16 v[152:155], a[28:31], a[120:123], v[152:155]
    s_lshr_b32 s59, s57, 3
    s_add_u32 s58, s58, s59
    s_lshl_b32 s58, s58, 1
    s_lshr_b32 s59, s56, 2
    s_add_u32 s97, s58, s59
    v_mfma_f32_16x16x32_bf16 v[156:159], a[28:31], a[124:127], v[156:159]
    s_lshl_b32 s20, s2, 15
    s_lshl_b32 s58, s32, 13
    s_add_u32 s20, s20, s58
    s_add_u32 s20, s20, 25165824
    v_mfma_f32_16x16x32_bf16 v[160:163], a[32:35], a[112:115], v[160:163]
    s_add_u32 s21, s20, 4096
    s_xor_b32 s22, s20, 131072
    s_add_u32 s23, s22, 4096
    v_lshlrev_b32 v12, 4, v0
    v_mfma_f32_16x16x32_bf16 v[164:167], a[32:35], a[116:119], v[164:167]
    v_accvgpr_write_b32 a208, -1
    v_accvgpr_write_b32 a209, -1
    v_mfma_f32_16x16x32_bf16 v[168:171], a[32:35], a[120:123], v[168:171]
    v_accvgpr_write_b32 a210, -1
    v_accvgpr_write_b32 a211, -1
    v_mfma_f32_16x16x32_bf16 v[172:175], a[32:35], a[124:127], v[172:175]
    s_lshl_b32 s58, s32, 10
    v_lshlrev_b32 v2, 4, v0
    v_mfma_f32_16x16x32_bf16 v[176:179], a[36:39], a[112:115], v[176:179]
    s_add_u32 s58, s58, 32704
    v_add_u32 v2, s58, v2
    v_mfma_f32_16x16x32_bf16 v[180:183], a[36:39], a[116:119], v[180:183]
    v_add_u32 v3, 81920, v2
    v_mfma_f32_16x16x32_bf16 v[184:187], a[36:39], a[120:123], v[184:187]
    v_and_b32 v4, 31, v0
    v_lshlrev_b32 v4, 4, v4
    v_mfma_f32_16x16x32_bf16 v[188:191], a[36:39], a[124:127], v[188:191]
    v_lshrrev_b32 v5, 5, v0
    v_lshl_add_u32 v4, v5, 3, v4
    v_mfma_f32_16x16x32_bf16 v[192:195], a[40:43], a[112:115], v[192:195]
    v_add_u32 v4, s40, v4
    v_lshlrev_b32 v5, 3, v0
    v_mfma_f32_16x16x32_bf16 v[196:199], a[40:43], a[116:119], v[196:199]
    v_add_u32 v5, s40, v5
    v_and_b32 v6, 7, v0
    v_mfma_f32_16x16x32_bf16 v[200:203], a[40:43], a[120:123], v[200:203]
    v_lshlrev_b32 v6, 3, v6
    v_add_u32 v6, s40, v6
    v_mfma_f32_16x16x32_bf16 v[204:207], a[40:43], a[124:127], v[204:207]
    v_mov_b32 v8, 0
    v_mov_b32 v9, 0
    v_mfma_f32_16x16x32_bf16 v[208:211], a[44:47], a[112:115], v[208:211]
    v_mfma_f32_16x16x32_bf16 v[212:215], a[44:47], a[116:119], v[212:215]
    v_mfma_f32_16x16x32_bf16 v[216:219], a[44:47], a[120:123], v[216:219]
    s_add_u32 s41, s41, 1
    s_cmp_eq_u32 s41, 3
    s_cselect_b32 s41, 0, s41
    s_cselect_b32 s57, -2, 1
    s_mul_i32 s57, s57, 7168
    v_mfma_f32_16x16x32_bf16 v[220:223], a[44:47], a[124:127], v[220:223]
    v_add_u32 v17, s57, v17
    v_add_u32 v18, s57, v18
    v_mfma_f32_16x16x32_bf16 v[224:227], a[48:51], a[112:115], v[224:227]
    v_add_u32 v19, s57, v19
    v_add_u32 v20, s57, v20
    v_mfma_f32_16x16x32_bf16 v[228:231], a[48:51], a[116:119], v[228:231]
    v_mfma_f32_16x16x32_bf16 v[232:235], a[48:51], a[120:123], v[232:235]
    v_mfma_f32_16x16x32_bf16 v[236:239], a[48:51], a[124:127], v[236:239]
    v_mfma_f32_16x16x32_bf16 v[240:243], a[52:55], a[112:115], v[240:243]
    s_waitcnt vmcnt(12) lgkmcnt(0)
    s_barrier
    v_mfma_f32_16x16x32_bf16 v[244:247], a[52:55], a[116:119], v[244:247]
    v_mfma_f32_16x16x32_bf16 v[248:251], a[52:55], a[120:123], v[248:251]
    v_mfma_f32_16x16x32_bf16 v[252:255], a[52:55], a[124:127], v[252:255]
    v_mfma_f32_16x16x32_bf16 v[32:35], a[56:59], a[128:131], v[32:35]
    ds_read_b64_tr_b16 a[0:1], v17 offset:0
    v_mfma_f32_16x16x32_bf16 v[36:39], a[56:59], a[132:135], v[36:39]
    ds_read_b64_tr_b16 a[2:3], v18 offset:0
    v_mfma_f32_16x16x32_bf16 v[40:43], a[56:59], a[136:139], v[40:43]
    ds_read_b64_tr_b16 a[4:5], v17 offset:40960
    v_mfma_f32_16x16x32_bf16 v[44:47], a[56:59], a[140:143], v[44:47]
    ds_read_b64_tr_b16 a[6:7], v18 offset:40960
    v_mfma_f32_16x16x32_bf16 v[48:51], a[60:63], a[128:131], v[48:51]
    ds_read_b64_tr_b16 a[8:9], v17 offset:32
    v_mfma_f32_16x16x32_bf16 v[52:55], a[60:63], a[132:135], v[52:55]
    ds_read_b64_tr_b16 a[10:11], v18 offset:32
    v_mfma_f32_16x16x32_bf16 v[56:59], a[60:63], a[136:139], v[56:59]
    ds_read_b64_tr_b16 a[12:13], v17 offset:40992
    v_mfma_f32_16x16x32_bf16 v[60:63], a[60:63], a[140:143], v[60:63]
    ds_read_b64_tr_b16 a[14:15], v18 offset:40992
    v_mfma_f32_16x16x32_bf16 v[64:67], a[64:67], a[128:131], v[64:67]
    ds_read_b64_tr_b16 a[16:17], v17 offset:64
    v_mfma_f32_16x16x32_bf16 v[68:71], a[64:67], a[132:135], v[68:71]
    ds_read_b64_tr_b16 a[18:19], v18 offset:64
    v_mfma_f32_16x16x32_bf16 v[72:75], a[64:67], a[136:139], v[72:75]
    ds_read_b64_tr_b16 a[20:21], v17 offset:41024
    v_mfma_f32_16x16x32_bf16 v[76:79], a[64:67], a[140:143], v[76:79]
    ds_read_b64_tr_b16 a[22:23], v18 offset:41024
    v_mfma_f32_16x16x32_bf16 v[80:83], a[68:71], a[128:131], v[80:83]
    ds_read_b64_tr_b16 a[24:25], v17 offset:96
    v_mfma_f32_16x16x32_bf16 v[84:87], a[68:71], a[132:135], v[84:87]
    ds_read_b64_tr_b16 a[26:27], v18 offset:96
    v_mfma_f32_16x16x32_bf16 v[88:91], a[68:71], a[136:139], v[88:91]
    ds_read_b64_tr_b16 a[28:29], v17 offset:41056
    v_mfma_f32_16x16x32_bf16 v[92:95], a[68:71], a[140:143], v[92:95]
    ds_read_b64_tr_b16 a[30:31], v18 offset:41056
    v_mfma_f32_16x16x32_bf16 v[96:99], a[72:75], a[128:131], v[96:99]
    ds_read_b64_tr_b16 a[32:33], v17 offset:128
    v_mfma_f32_16x16x32_bf16 v[100:103], a[72:75], a[132:135], v[100:103]
    ds_read_b64_tr_b16 a[34:35], v18 offset:128
    v_mfma_f32_16x16x32_bf16 v[104:107], a[72:75], a[136:139], v[104:107]
    ds_read_b64_tr_b16 a[36:37], v17 offset:41088
    v_mfma_f32_16x16x32_bf16 v[108:111], a[72:75], a[140:143], v[108:111]
    ds_read_b64_tr_b16 a[38:39], v18 offset:41088
    v_mfma_f32_16x16x32_bf16 v[112:115], a[76:79], a[128:131], v[112:115]
    ds_read_b64_tr_b16 a[40:41], v17 offset:160
    v_mfma_f32_16x16x32_bf16 v[116:119], a[76:79], a[132:135], v[116:119]
    ds_read_b64_tr_b16 a[42:43], v18 offset:160
    v_mfma_f32_16x16x32_bf16 v[120:123], a[76:79], a[136:139], v[120:123]
    ds_read_b64_tr_b16 a[44:45], v17 offset:41120
    v_mfma_f32_16x16x32_bf16 v[124:127], a[76:79], a[140:143], v[124:127]
    ds_read_b64_tr_b16 a[46:47], v18 offset:41120
    v_mfma_f32_16x16x32_bf16 v[128:131], a[80:83], a[128:131], v[128:131]
    ds_read_b64_tr_b16 a[48:49], v17 offset:192
    buffer_store_dwordx4 a[208:211], v12, s[28:31], s20 offen offset:0 sc1
    v_mfma_f32_16x16x32_bf16 v[132:135], a[80:83], a[132:135], v[132:135]
    ds_read_b64_tr_b16 a[50:51], v18 offset:192
    v_mfma_f32_16x16x32_bf16 v[136:139], a[80:83], a[136:139], v[136:139]
    ds_read_b64_tr_b16 a[52:53], v17 offset:41152
    v_mfma_f32_16x16x32_bf16 v[140:143], a[80:83], a[140:143], v[140:143]
    ds_read_b64_tr_b16 a[54:55], v18 offset:41152
    v_mfma_f32_16x16x32_bf16 v[144:147], a[84:87], a[128:131], v[144:147]
    ds_read_b128 a[144:147], v21 offset:0
    buffer_store_dwordx4 a[208:211], v12, s[28:31], s20 offen offset:1024 sc1
    v_mfma_f32_16x16x32_bf16 v[148:151], a[84:87], a[132:135], v[148:151]
    ds_read_b128 a[148:151], v21 offset:2048
    v_mfma_f32_16x16x32_bf16 v[152:155], a[84:87], a[136:139], v[152:155]
    ds_read_b128 a[152:155], v21 offset:4096
    v_mfma_f32_16x16x32_bf16 v[156:159], a[84:87], a[140:143], v[156:159]
    ds_read_b128 a[156:159], v21 offset:6144
    v_mfma_f32_16x16x32_bf16 v[160:163], a[88:91], a[128:131], v[160:163]
    ds_read_b128 a[160:163], v22 offset:0
    buffer_store_dwordx4 a[208:211], v12, s[28:31], s20 offen offset:2048 sc1
    v_mfma_f32_16x16x32_bf16 v[164:167], a[88:91], a[132:135], v[164:167]
    ds_read_b128 a[164:167], v22 offset:2048
    v_mfma_f32_16x16x32_bf16 v[168:171], a[88:91], a[136:139], v[168:171]
    ds_read_b128 a[168:171], v22 offset:4096
    v_mfma_f32_16x16x32_bf16 v[172:175], a[88:91], a[140:143], v[172:175]
    ds_read_b128 a[172:175], v22 offset:6144
    v_mfma_f32_16x16x32_bf16 v[176:179], a[92:95], a[128:131], v[176:179]
    buffer_store_dwordx4 a[208:211], v12, s[28:31], s20 offen offset:3072 sc1
    v_mfma_f32_16x16x32_bf16 v[180:183], a[92:95], a[132:135], v[180:183]
    ds_write_b64 v4, a[176:177] offset:36864
    v_mfma_f32_16x16x32_bf16 v[184:187], a[92:95], a[136:139], v[184:187]
    ds_write_b64 v4, a[178:179] offset:37376
    v_mfma_f32_16x16x32_bf16 v[188:191], a[92:95], a[140:143], v[188:191]
    ds_write_b64 v4, a[180:181] offset:37888
    v_mfma_f32_16x16x32_bf16 v[192:195], a[96:99], a[128:131], v[192:195]
    ds_write_b64 v4, a[182:183] offset:38400
    v_mfma_f32_16x16x32_bf16 v[196:199], a[96:99], a[132:135], v[196:199]
    ds_write_b64 v4, a[184:185] offset:38912
    v_mfma_f32_16x16x32_bf16 v[200:203], a[96:99], a[136:139], v[200:203]
    ds_write_b64 v4, a[186:187] offset:39424
    v_mfma_f32_16x16x32_bf16 v[204:207], a[96:99], a[140:143], v[204:207]
    ds_write_b64 v4, a[188:189] offset:39936
    v_mfma_f32_16x16x32_bf16 v[208:211], a[100:103], a[128:131], v[208:211]
    ds_write_b64 v4, a[190:191] offset:40448
    v_mfma_f32_16x16x32_bf16 v[212:215], a[100:103], a[132:135], v[212:215]
    ds_write_b64 v5, v[8:9] offset:32192
    v_mfma_f32_16x16x32_bf16 v[216:219], a[100:103], a[136:139], v[216:219]
    ds_write_b64 v6, v[8:9] offset:36800
    v_mfma_f32_16x16x32_bf16 v[220:223], a[100:103], a[140:143], v[220:223]
    v_mfma_f32_16x16x32_bf16 v[224:227], a[104:107], a[128:131], v[224:227]
    v_mfma_f32_16x16x32_bf16 v[228:231], a[104:107], a[132:135], v[228:231]
    v_mfma_f32_16x16x32_bf16 v[232:235], a[104:107], a[136:139], v[232:235]
    v_mfma_f32_16x16x32_bf16 v[236:239], a[104:107], a[140:143], v[236:239]
    v_mfma_f32_16x16x32_bf16 v[240:243], a[108:111], a[128:131], v[240:243]
    v_mfma_f32_16x16x32_bf16 v[244:247], a[108:111], a[132:135], v[244:247]
    v_mfma_f32_16x16x32_bf16 v[248:251], a[108:111], a[136:139], v[248:251]
    v_mfma_f32_16x16x32_bf16 v[252:255], a[108:111], a[140:143], v[252:255]
    s_waitcnt lgkmcnt(0)
    v_mfma_f32_16x16x32_bf16 v[32:35], a[0:3], a[144:147], v[32:35]
    ds_read_b64_tr_b16 a[56:57], v19 offset:0
    v_mfma_f32_16x16x32_bf16 v[36:39], a[0:3], a[148:151], v[36:39]
    ds_read_b64_tr_b16 a[58:59], v20 offset:0
    s_waitcnt vmcnt(4)
    v_mfma_f32_16x16x32_bf16 v[40:43], a[0:3], a[152:155], v[40:43]
    ds_read_b64_tr_b16 a[60:61], v19 offset:40960
    v_accvgpr_read_b32 v25, a192
    v_mfma_f32_16x16x32_bf16 v[44:47], a[0:3], a[156:159], v[44:47]
    ds_read_b64_tr_b16 a[62:63], v20 offset:40960
    v_accvgpr_read_b32 v26, a193
    v_mfma_f32_16x16x32_bf16 v[48:51], a[4:7], a[144:147], v[48:51]
    ds_read_b64_tr_b16 a[64:65], v19 offset:32
    v_accvgpr_read_b32 v27, a194
    v_mfma_f32_16x16x32_bf16 v[52:55], a[4:7], a[148:151], v[52:55]
    ds_read_b64_tr_b16 a[66:67], v20 offset:32
    v_accvgpr_read_b32 v28, a195
    v_mfma_f32_16x16x32_bf16 v[56:59], a[4:7], a[152:155], v[56:59]
    ds_read_b64_tr_b16 a[68:69], v19 offset:40992
    v_perm_b32 v29, v27, v25, s100
    v_mfma_f32_16x16x32_bf16 v[60:63], a[4:7], a[156:159], v[60:63]
    ds_read_b64_tr_b16 a[70:71], v20 offset:40992
    ds_write_b32 v13, v29 offset:0
    v_mfma_f32_16x16x32_bf16 v[64:67], a[8:11], a[144:147], v[64:67]
    ds_read_b64_tr_b16 a[72:73], v19 offset:64
    v_perm_b32 v31, v27, v25, s101
    v_mfma_f32_16x16x32_bf16 v[68:71], a[8:11], a[148:151], v[68:71]
    ds_read_b64_tr_b16 a[74:75], v20 offset:64
    ds_write_b32 v13, v31 offset:40960
    v_mfma_f32_16x16x32_bf16 v[72:75], a[8:11], a[152:155], v[72:75]
    ds_read_b64_tr_b16 a[76:77], v19 offset:41024
    v_perm_b32 v29, v28, v26, s100
    v_mfma_f32_16x16x32_bf16 v[76:79], a[8:11], a[156:159], v[76:79]
    ds_read_b64_tr_b16 a[78:79], v20 offset:41024
    ds_write_b32 v14, v29 offset:0
    v_mfma_f32_16x16x32_bf16 v[80:83], a[12:15], a[144:147], v[80:83]
    ds_read_b64_tr_b16 a[80:81], v19 offset:96
    v_perm_b32 v31, v28, v26, s101
    v_mfma_f32_16x16x32_bf16 v[84:87], a[12:15], a[148:151], v[84:87]
    ds_read_b64_tr_b16 a[82:83], v20 offset:96
    ds_write_b32 v14, v31 offset:40960
    v_mfma_f32_16x16x32_bf16 v[88:91], a[12:15], a[152:155], v[88:91]
    ds_read_b64_tr_b16 a[84:85], v19 offset:41056
    v_accvgpr_read_b32 v25, a196
    v_mfma_f32_16x16x32_bf16 v[92:95], a[12:15], a[156:159], v[92:95]
    ds_read_b64_tr_b16 a[86:87], v20 offset:41056
    v_accvgpr_read_b32 v26, a197
    v_mfma_f32_16x16x32_bf16 v[96:99], a[16:19], a[144:147], v[96:99]
    ds_read_b64_tr_b16 a[88:89], v19 offset:128
    v_accvgpr_read_b32 v27, a198
    v_mfma_f32_16x16x32_bf16 v[100:103], a[16:19], a[148:151], v[100:103]
    ds_read_b64_tr_b16 a[90:91], v20 offset:128
    v_accvgpr_read_b32 v28, a199
    v_mfma_f32_16x16x32_bf16 v[104:107], a[16:19], a[152:155], v[104:107]
    ds_read_b64_tr_b16 a[92:93], v19 offset:41088
    v_perm_b32 v29, v27, v25, s100
    v_mfma_f32_16x16x32_bf16 v[108:111], a[16:19], a[156:159], v[108:111]
    ds_read_b64_tr_b16 a[94:95], v20 offset:41088
    ds_write_b32 v13, v29 offset:1024
    v_mfma_f32_16x16x32_bf16 v[112:115], a[20:23], a[144:147], v[112:115]
    ds_read_b64_tr_b16 a[96:97], v19 offset:160
    v_perm_b32 v31, v27, v25, s101
    v_mfma_f32_16x16x32_bf16 v[116:119], a[20:23], a[148:151], v[116:119]
    ds_read_b64_tr_b16 a[98:99], v20 offset:160
    ds_write_b32 v13, v31 offset:41984
    v_mfma_f32_16x16x32_bf16 v[120:123], a[20:23], a[152:155], v[120:123]
    ds_read_b64_tr_b16 a[100:101], v19 offset:41120
    v_perm_b32 v29, v28, v26, s100
    v_mfma_f32_16x16x32_bf16 v[124:127], a[20:23], a[156:159], v[124:127]
    ds_read_b64_tr_b16 a[102:103], v20 offset:41120
    ds_write_b32 v14, v29 offset:1024
    v_mfma_f32_16x16x32_bf16 v[128:131], a[24:27], a[144:147], v[128:131]
    ds_read_b64_tr_b16 a[104:105], v19 offset:192
    v_perm_b32 v31, v28, v26, s101
    v_mfma_f32_16x16x32_bf16 v[132:135], a[24:27], a[148:151], v[132:135]
    ds_read_b64_tr_b16 a[106:107], v20 offset:192
    ds_write_b32 v14, v31 offset:41984
    v_mfma_f32_16x16x32_bf16 v[136:139], a[24:27], a[152:155], v[136:139]
    ds_read_b64_tr_b16 a[108:109], v19 offset:41152
    v_accvgpr_read_b32 v25, a200
    v_mfma_f32_16x16x32_bf16 v[140:143], a[24:27], a[156:159], v[140:143]
    ds_read_b64_tr_b16 a[110:111], v20 offset:41152
    v_accvgpr_read_b32 v26, a201
    v_mfma_f32_16x16x32_bf16 v[144:147], a[28:31], a[144:147], v[144:147]
    v_bfe_u32 v2, v0, 4, 1
    v_lshrrev_b32 v3, 5, v0
    v_accvgpr_read_b32 v27, a202
    v_mfma_f32_16x16x32_bf16 v[148:151], a[28:31], a[148:151], v[148:151]
    v_bfe_u32 v4, v0, 2, 2
    v_and_b32 v5, 3, v0
    v_accvgpr_read_b32 v28, a203
    v_mfma_f32_16x16x32_bf16 v[152:155], a[28:31], a[152:155], v[152:155]
    v_lshlrev_b32 v6, 5, v2
    v_lshl_add_u32 v6, v5, 3, v6
    v_perm_b32 v29, v27, v25, s100
    v_mfma_f32_16x16x32_bf16 v[156:159], a[28:31], a[156:159], v[156:159]
    v_lshlrev_b32 v9, 6, v3
    v_lshl_add_u32 v9, v4, 3, v9
    ds_write_b32 v13, v29 offset:2048
    v_mfma_f32_16x16x32_bf16 v[160:163], a[32:35], a[144:147], v[160:163]
    v_sub_u32 v6, v6, v9
    s_add_u32 s58, s40, 36896
    v_perm_b32 v31, v27, v25, s101
    v_mfma_f32_16x16x32_bf16 v[164:167], a[32:35], a[148:151], v[164:167]
    v_add_u32 v7, s58, v6
    v_lshlrev_b32 v6, 8, v2
    ds_write_b32 v13, v31 offset:43008
    v_mfma_f32_16x16x32_bf16 v[168:171], a[32:35], a[152:155], v[168:171]
    v_lshl_add_u32 v6, v5, 6, v6
    s_add_u32 s58, s40, 32256
    v_perm_b32 v29, v28, v26, s100
    v_mfma_f32_16x16x32_bf16 v[172:175], a[32:35], a[156:159], v[172:175]
    v_add3_u32 v8, v6, v9, s58
    ds_write_b32 v14, v29 offset:2048
    v_mfma_f32_16x16x32_bf16 v[176:179], a[36:39], a[144:147], v[176:179]
    v_lshrrev_b32 v9, 3, v0
    v_bfe_u32 v6, v9, 1, 1
    v_perm_b32 v31, v28, v26, s101
    v_mfma_f32_16x16x32_bf16 v[180:183], a[36:39], a[148:151], v[180:183]
    v_lshlrev_b32 v6, 1, v6
    v_and_b32 v3, 7, v0
    ds_write_b32 v14, v31 offset:43008
    v_mfma_f32_16x16x32_bf16 v[184:187], a[36:39], a[152:155], v[184:187]
    v_xor_b32 v6, v6, v3
    v_lshlrev_b32 v9, 11, v9
    v_accvgpr_read_b32 v25, a204
    v_mfma_f32_16x16x32_bf16 v[188:191], a[36:39], a[156:159], v[188:191]
    v_lshl_add_u32 v2, v6, 4, v9
    v_xor_b32 v3, 64, v2
    v_accvgpr_read_b32 v26, a205
    v_mfma_f32_16x16x32_bf16 v[192:195], a[40:43], a[144:147], v[192:195]
    v_add_u32 v3, 0x4000, v3
    v_add_u32 v4, 0x8000, v2
    v_accvgpr_read_b32 v27, a206
    v_mfma_f32_16x16x32_bf16 v[196:199], a[40:43], a[148:151], v[196:199]
    v_add_u32 v5, 0x8000, v3
    v_lshlrev_b32 v6, 4, v0
    v_accvgpr_read_b32 v28, a207
    v_mfma_f32_16x16x32_bf16 v[200:203], a[40:43], a[152:155], v[200:203]
    s_and_b32 s58, s97, 1
    s_lshl_b32 s58, s58, 1
    s_and_b32 s59, s32, 1
    s_add_u32 s58, s58, s59
    s_mul_i32 s38, s58, 1835008
    v_perm_b32 v29, v27, v25, s100
    v_mfma_f32_16x16x32_bf16 v[204:207], a[40:43], a[156:159], v[204:207]
    s_lshr_b32 s59, s32, 1
    s_lshl_b32 s58, s59, 15
    s_add_u32 s38, s38, s58
    s_lshl_b32 s58, s97, 7
    s_add_u32 s39, s38, s58
    s_xor_b32 s38, s39, 128
    ds_write_b32 v13, v29 offset:3072
    v_mfma_f32_16x16x32_bf16 v[208:211], a[44:47], a[144:147], v[208:211]
    s_lshl_b32 s59, s59, 11
    s_and_b32 s58, s32, 1
    s_mul_i32 s58, s58, 40960
    s_add_u32 s18, s58, s59
    s_add_u32 s19, s18, 81920
    v_perm_b32 v31, v27, v25, s101
    v_mfma_f32_16x16x32_bf16 v[212:215], a[44:47], a[148:151], v[212:215]
    s_lshl_b32 s58, s36, 3
    s_lshl_b32 s59, s32, 1
    s_add_u32 s58, s58, s59
    s_mul_i32 s58, s58, 224
    ds_write_b32 v13, v31 offset:44032
    v_mfma_f32_16x16x32_bf16 v[216:219], a[44:47], a[152:155], v[216:219]
    s_mul_i32 s59, s35, 7
    s_add_u32 s58, s58, s59
    s_lshl_b32 s60, s58, 10
    v_perm_b32 v29, v28, v26, s100
    v_mfma_f32_16x16x32_bf16 v[220:223], a[44:47], a[156:159], v[220:223]
    s_add_u32 s61, s60, 229376
    s_add_u32 s62, s60, 4096
    s_add_u32 s63, s61, 4096
    s_mov_b32 s27, 0xbfb8aa3b
    ds_write_b32 v14, v29 offset:3072
    v_mfma_f32_16x16x32_bf16 v[224:227], a[48:51], a[144:147], v[224:227]
    s_lshl_b32 s58, s32, 1
    s_add_u32 s58, s58, 24576
    v_lshlrev_b32 v10, 3, v0
    v_perm_b32 v31, v28, v26, s101
    v_mfma_f32_16x16x32_bf16 v[228:231], a[48:51], a[148:151], v[228:231]
    v_add_u32 v10, s58, v10
    v_add_u32 v11, 81920, v10
    ds_write_b32 v14, v31 offset:44032
    v_mfma_f32_16x16x32_bf16 v[232:235], a[48:51], a[152:155], v[232:235]
    v_mfma_f32_16x16x32_bf16 v[236:239], a[48:51], a[156:159], v[236:239]
    v_mfma_f32_16x16x32_bf16 v[240:243], a[52:55], a[144:147], v[240:243]
    s_waitcnt vmcnt(4) lgkmcnt(0)
    s_barrier
    v_mfma_f32_16x16x32_bf16 v[244:247], a[52:55], a[148:151], v[244:247]
    v_mfma_f32_16x16x32_bf16 v[248:251], a[52:55], a[152:155], v[248:251]
    v_mfma_f32_16x16x32_bf16 v[252:255], a[52:55], a[156:159], v[252:255]
    v_mfma_f32_16x16x32_bf16 v[32:35], a[56:59], a[160:163], v[32:35]
    ds_read_b64_tr_b16 a[0:1], v7 offset:32
    ds_read_b64_tr_b16 a[2:3], v7 offset:0
    v_mfma_f32_16x16x32_bf16 v[36:39], a[56:59], a[164:167], v[36:39]
    ds_read_b64_tr_b16 a[4:5], v8 offset:384
    ds_read_b64_tr_b16 a[6:7], v8 offset:416
    v_mfma_f32_16x16x32_bf16 v[40:43], a[56:59], a[168:171], v[40:43]
    ds_read_b64_tr_b16 a[8:9], v7 offset:160
    ds_read_b64_tr_b16 a[10:11], v7 offset:128
    v_mfma_f32_16x16x32_bf16 v[44:47], a[56:59], a[172:175], v[44:47]
    ds_read_b64_tr_b16 a[12:13], v8 offset:256
    ds_read_b64_tr_b16 a[14:15], v8 offset:288
    v_mfma_f32_16x16x32_bf16 v[48:51], a[60:63], a[160:163], v[48:51]
    ds_read_b64_tr_b16 a[16:17], v7 offset:288
    ds_read_b64_tr_b16 a[18:19], v7 offset:256
    v_mfma_f32_16x16x32_bf16 v[52:55], a[60:63], a[164:167], v[52:55]
    ds_read_b64_tr_b16 a[20:21], v8 offset:128
    ds_read_b64_tr_b16 a[22:23], v8 offset:160
    v_mfma_f32_16x16x32_bf16 v[56:59], a[60:63], a[168:171], v[56:59]
    v_mfma_f32_16x16x32_bf16 v[60:63], a[60:63], a[172:175], v[60:63]
    v_mfma_f32_16x16x32_bf16 v[64:67], a[64:67], a[160:163], v[64:67]
    s_add_u32 m0, s18, 0
    v_mul_f32 v48, v32, v48
    buffer_load_dwordx4 v2, s[44:47], s38 offen lds
    v_mfma_f32_16x16x32_bf16 v[68:71], a[64:67], a[164:167], v[68:71]
    v_mul_f32 v49, v33, v49
    v_mul_f32 v50, v34, v50
    v_mfma_f32_16x16x32_bf16 v[72:75], a[64:67], a[168:171], v[72:75]
    v_mul_f32 v51, v35, v51
    v_mul_f32 v52, v36, v52
    v_mfma_f32_16x16x32_bf16 v[76:79], a[64:67], a[172:175], v[76:79]
    v_mul_f32 v53, v37, v53
    v_mul_f32 v54, v38, v54
    v_mfma_f32_16x16x32_bf16 v[80:83], a[68:71], a[160:163], v[80:83]
    v_mul_f32 v55, v39, v55
    v_mul_f32 v32, s27, v32
    v_mfma_f32_16x16x32_bf16 v[84:87], a[68:71], a[164:167], v[84:87]
    v_mul_f32 v33, s27, v33
    v_mul_f32 v34, s27, v34
    v_mfma_f32_16x16x32_bf16 v[88:91], a[68:71], a[168:171], v[88:91]
    v_mul_f32 v35, s27, v35
    v_mul_f32 v36, s27, v36
    v_mfma_f32_16x16x32_bf16 v[92:95], a[68:71], a[172:175], v[92:95]
    v_mul_f32 v37, s27, v37
    v_mul_f32 v38, s27, v38
    v_mfma_f32_16x16x32_bf16 v[96:99], a[72:75], a[160:163], v[96:99]
    s_add_u32 m0, s18, 1024
    v_mul_f32 v39, s27, v39
    buffer_load_dwordx4 v3, s[44:47], s38 offen lds
    v_mfma_f32_16x16x32_bf16 v[100:103], a[72:75], a[164:167], v[100:103]
    v_exp_f32 v32, v32
    v_mfma_f32_16x16x32_bf16 v[104:107], a[72:75], a[168:171], v[104:107]
    v_exp_f32 v33, v33
    v_mfma_f32_16x16x32_bf16 v[108:111], a[72:75], a[172:175], v[108:111]
    v_exp_f32 v34, v34
    v_mfma_f32_16x16x32_bf16 v[112:115], a[76:79], a[160:163], v[112:115]
    v_exp_f32 v35, v35
    v_mfma_f32_16x16x32_bf16 v[116:119], a[76:79], a[164:167], v[116:119]
    v_exp_f32 v36, v36
    v_mfma_f32_16x16x32_bf16 v[120:123], a[76:79], a[168:171], v[120:123]
    v_exp_f32 v37, v37
    v_mfma_f32_16x16x32_bf16 v[124:127], a[76:79], a[172:175], v[124:127]
    v_exp_f32 v38, v38
    v_mfma_f32_16x16x32_bf16 v[128:131], a[80:83], a[160:163], v[128:131]
    s_add_u32 m0, s19, 0
    v_exp_f32 v39, v39
    buffer_load_dwordx4 v2, s[44:47], s39 offen lds
    v_mfma_f32_16x16x32_bf16 v[132:135], a[80:83], a[164:167], v[132:135]
    v_add_f32 v32, 1.0, v32
    v_add_f32 v33, 1.0, v33
    v_mfma_f32_16x16x32_bf16 v[136:139], a[80:83], a[168:171], v[136:139]
    v_add_f32 v34, 1.0, v34
    v_add_f32 v35, 1.0, v35
    v_mfma_f32_16x16x32_bf16 v[140:143], a[80:83], a[172:175], v[140:143]
    v_add_f32 v36, 1.0, v36
    v_add_f32 v37, 1.0, v37
    v_mfma_f32_16x16x32_bf16 v[144:147], a[84:87], a[160:163], v[144:147]
    v_add_f32 v38, 1.0, v38
    v_add_f32 v39, 1.0, v39
    v_mfma_f32_16x16x32_bf16 v[148:151], a[84:87], a[164:167], v[148:151]
    v_rcp_f32 v32, v32
    v_mfma_f32_16x16x32_bf16 v[152:155], a[84:87], a[168:171], v[152:155]
    v_rcp_f32 v33, v33
    v_mfma_f32_16x16x32_bf16 v[156:159], a[84:87], a[172:175], v[156:159]
    v_rcp_f32 v34, v34
    v_mfma_f32_16x16x32_bf16 v[160:163], a[88:91], a[160:163], v[160:163]
    s_add_u32 m0, s19, 1024
    v_rcp_f32 v35, v35
    buffer_load_dwordx4 v3, s[44:47], s39 offen lds
    s_add_u32 s38, s38, 65536
    s_add_u32 s39, s39, 65536
    v_mfma_f32_16x16x32_bf16 v[164:167], a[88:91], a[164:167], v[164:167]
    v_rcp_f32 v36, v36
    v_mfma_f32_16x16x32_bf16 v[168:171], a[88:91], a[168:171], v[168:171]
    v_rcp_f32 v37, v37
    v_mfma_f32_16x16x32_bf16 v[172:175], a[88:91], a[172:175], v[172:175]
    v_rcp_f32 v38, v38
    v_mfma_f32_16x16x32_bf16 v[176:179], a[92:95], a[160:163], v[176:179]
    v_rcp_f32 v39, v39
    v_mfma_f32_16x16x32_bf16 v[180:183], a[92:95], a[164:167], v[180:183]
    v_mul_f32 v32, v32, v48
    v_mul_f32 v33, v33, v49
    v_mfma_f32_16x16x32_bf16 v[184:187], a[92:95], a[168:171], v[184:187]
    v_mul_f32 v34, v34, v50
    v_mul_f32 v35, v35, v51
    v_mfma_f32_16x16x32_bf16 v[188:191], a[92:95], a[172:175], v[188:191]
    v_mul_f32 v36, v36, v52
    v_mul_f32 v37, v37, v53
    v_mfma_f32_16x16x32_bf16 v[192:195], a[96:99], a[160:163], v[192:195]
    s_add_u32 m0, s18, 4096
    v_mul_f32 v38, v38, v54
    buffer_load_dwordx4 v2, s[44:47], s38 offen lds
    v_mfma_f32_16x16x32_bf16 v[196:199], a[96:99], a[164:167], v[196:199]
    v_mul_f32 v39, v39, v55
    v_cvt_pk_bf16_f32 v32, v32, v33
    v_mfma_f32_16x16x32_bf16 v[200:203], a[96:99], a[168:171], v[200:203]
    v_cvt_pk_bf16_f32 v33, v34, v35
    v_cvt_pk_bf16_f32 v34, v36, v37
    v_mfma_f32_16x16x32_bf16 v[204:207], a[96:99], a[172:175], v[204:207]
    v_cvt_pk_bf16_f32 v35, v38, v39
    v_permlane16_swap_b32 v32, v34
    v_mfma_f32_16x16x32_bf16 v[208:211], a[100:103], a[160:163], v[208:211]
    v_permlane16_swap_b32 v33, v35
    buffer_store_dwordx4 v[32:35], v6, s[28:31], s60 offen offset:0 sc1
    v_mfma_f32_16x16x32_bf16 v[212:215], a[100:103], a[164:167], v[212:215]
    v_mul_f32 v56, v40, v56
    v_mul_f32 v57, v41, v57
    v_mfma_f32_16x16x32_bf16 v[216:219], a[100:103], a[168:171], v[216:219]
    v_mul_f32 v58, v42, v58
    s_add_u32 m0, s18, 5120
    v_mul_f32 v59, v43, v59
    buffer_load_dwordx4 v3, s[44:47], s38 offen lds
    v_mfma_f32_16x16x32_bf16 v[220:223], a[100:103], a[172:175], v[220:223]
    v_mul_f32 v60, v44, v60
    v_mul_f32 v61, v45, v61
    v_mfma_f32_16x16x32_bf16 v[224:227], a[104:107], a[160:163], v[224:227]
    v_mul_f32 v62, v46, v62
    v_mul_f32 v63, v47, v63
    v_mfma_f32_16x16x32_bf16 v[228:231], a[104:107], a[164:167], v[228:231]
    v_mul_f32 v40, s27, v40
    v_mul_f32 v41, s27, v41
    v_mfma_f32_16x16x32_bf16 v[232:235], a[104:107], a[168:171], v[232:235]
    v_mul_f32 v42, s27, v42
    v_mul_f32 v43, s27, v43
    v_mfma_f32_16x16x32_bf16 v[236:239], a[104:107], a[172:175], v[236:239]
    v_mul_f32 v44, s27, v44
    v_mul_f32 v45, s27, v45
    v_mfma_f32_16x16x32_bf16 v[240:243], a[108:111], a[160:163], v[240:243]
    v_mul_f32 v46, s27, v46
    v_mul_f32 v47, s27, v47
    v_mfma_f32_16x16x32_bf16 v[244:247], a[108:111], a[164:167], v[244:247]
    v_exp_f32 v40, v40
    v_mfma_f32_16x16x32_bf16 v[248:251], a[108:111], a[168:171], v[248:251]
    s_add_u32 m0, s19, 4096
    v_exp_f32 v41, v41
    buffer_load_dwordx4 v2, s[44:47], s39 offen lds
    v_mfma_f32_16x16x32_bf16 v[252:255], a[108:111], a[172:175], v[252:255]
    v_exp_f32 v42, v42
    v_exp_f32 v43, v43
    v_exp_f32 v44, v44
    v_exp_f32 v45, v45
    v_exp_f32 v46, v46
    v_exp_f32 v47, v47
    v_add_f32 v40, 1.0, v40
    v_add_f32 v41, 1.0, v41
    v_add_f32 v42, 1.0, v42
    v_add_f32 v43, 1.0, v43
    v_add_f32 v44, 1.0, v44
    v_add_f32 v45, 1.0, v45
    v_add_f32 v46, 1.0, v46
    v_add_f32 v47, 1.0, v47
    v_rcp_f32 v40, v40
    v_rcp_f32 v41, v41
    v_rcp_f32 v42, v42
    s_add_u32 m0, s19, 5120
    v_rcp_f32 v43, v43
    buffer_load_dwordx4 v3, s[44:47], s39 offen lds
    s_add_u32 s38, s38, 65536
    s_add_u32 s39, s39, 65536
    v_rcp_f32 v44, v44
    v_rcp_f32 v45, v45
    v_rcp_f32 v46, v46
    v_rcp_f32 v47, v47
    v_mul_f32 v40, v40, v56
    v_mul_f32 v41, v41, v57
    v_mul_f32 v42, v42, v58
    v_mul_f32 v43, v43, v59
    v_mul_f32 v44, v44, v60
    v_mul_f32 v45, v45, v61
    v_mul_f32 v46, v46, v62
    v_mul_f32 v47, v47, v63
    v_cvt_pk_bf16_f32 v40, v40, v41
    v_cvt_pk_bf16_f32 v41, v42, v43
    v_cvt_pk_bf16_f32 v42, v44, v45
    v_cvt_pk_bf16_f32 v43, v46, v47
    s_nop 0
    v_permlane16_swap_b32 v40, v42
    v_permlane16_swap_b32 v41, v43
    buffer_store_dwordx4 v[40:43], v6, s[28:31], s61 offen offset:0 sc1
    s_add_u32 m0, s18, 8192
    s_nop 0
    buffer_load_dwordx4 v2, s[44:47], s38 offen lds
    s_waitcnt lgkmcnt(8)
    v_mfma_f32_32x32x16_bf16 v[48:63], a[4:7], a[0:3], 0
    ds_read_b64_tr_b16 a[24:25], v7 offset:416
    ds_read_b64_tr_b16 a[26:27], v7 offset:384
    ds_read_b64_tr_b16 a[28:29], v8 offset:0
    ds_read_b64_tr_b16 a[30:31], v8 offset:32
    v_mul_f32 v80, v64, v80
    v_mul_f32 v81, v65, v81
    v_mul_f32 v82, v66, v82
    v_mul_f32 v83, v67, v83
    v_mul_f32 v84, v68, v84
    v_mul_f32 v85, v69, v85
    v_mul_f32 v86, v70, v86
    v_mul_f32 v87, v71, v87
    v_mul_f32 v64, s27, v64
    v_mul_f32 v65, s27, v65
    v_mul_f32 v66, s27, v66
    v_mul_f32 v67, s27, v67
    v_mul_f32 v68, s27, v68
    s_waitcnt lgkmcnt(8)
    v_mfma_f32_32x32x16_bf16 v[48:63], a[12:15], a[8:11], v[48:63]
    ds_read_b64_tr_b16 a[32:33], v7 offset:544
    ds_read_b64_tr_b16 a[34:35], v7 offset:512
    ds_read_b64_tr_b16 a[36:37], v8 offset:896
    ds_read_b64_tr_b16 a[38:39], v8 offset:928
    v_mul_f32 v69, s27, v69
    v_mul_f32 v70, s27, v70
    v_mul_f32 v71, s27, v71
    s_add_u32 m0, s18, 9216
    v_exp_f32 v64, v64
    buffer_load_dwordx4 v3, s[44:47], s38 offen lds
    v_exp_f32 v65, v65
    s_waitcnt lgkmcnt(8)
    v_mfma_f32_32x32x16_bf16 v[48:63], a[20:23], a[16:19], v[48:63]
    ds_read_b64_tr_b16 a[40:41], v7 offset:672
    ds_read_b64_tr_b16 a[42:43], v7 offset:640
    ds_read_b64_tr_b16 a[44:45], v8 offset:768
    ds_read_b64_tr_b16 a[46:47], v8 offset:800
    v_exp_f32 v66, v66
    v_exp_f32 v67, v67
    v_exp_f32 v68, v68
    v_exp_f32 v69, v69
    v_exp_f32 v70, v70
    v_exp_f32 v71, v71
    v_add_f32 v64, 1.0, v64
    s_waitcnt lgkmcnt(8)
    v_mfma_f32_32x32x16_bf16 v[48:63], a[28:31], a[24:27], v[48:63]
    ds_read_b64_tr_b16 a[48:49], v7 offset:800
    ds_read_b64_tr_b16 a[50:51], v7 offset:768
    ds_read_b64_tr_b16 a[52:53], v8 offset:640
    ds_read_b64_tr_b16 a[54:55], v8 offset:672
    v_add_f32 v65, 1.0, v65
    s_add_u32 m0, s19, 8192
    v_add_f32 v66, 1.0, v66
    buffer_load_dwordx4 v2, s[44:47], s39 offen lds
    v_add_f32 v67, 1.0, v67
    v_add_f32 v68, 1.0, v68
    v_add_f32 v69, 1.0, v69
    v_add_f32 v70, 1.0, v70
    s_waitcnt lgkmcnt(8)
    v_mfma_f32_32x32x16_bf16 v[32:47], a[36:39], a[0:3], 0
    ds_read_b64_tr_b16 a[112:113], v7 offset:928
    ds_read_b64_tr_b16 a[114:115], v7 offset:896
    ds_read_b64_tr_b16 a[116:117], v8 offset:512
    ds_read_b64_tr_b16 a[118:119], v8 offset:544
    v_add_f32 v71, 1.0, v71
    v_rcp_f32 v64, v64
    v_rcp_f32 v65, v65
    v_rcp_f32 v66, v66
    v_rcp_f32 v67, v67
    v_rcp_f32 v68, v68
    v_rcp_f32 v69, v69
    s_waitcnt lgkmcnt(8)
    v_mfma_f32_32x32x16_bf16 v[32:47], a[44:47], a[8:11], v[32:47]
    ds_read_b64_tr_b16 a[120:121], v7 offset:1056
    ds_read_b64_tr_b16 a[122:123], v7 offset:1024
    ds_read_b64_tr_b16 a[124:125], v8 offset:1408
    ds_read_b64_tr_b16 a[126:127], v8 offset:1440
    s_add_u32 m0, s19, 9216
    v_rcp_f32 v70, v70
    buffer_load_dwordx4 v3, s[44:47], s39 offen lds
    s_add_u32 s38, s38, 65536
    s_add_u32 s39, s39, 65536
    v_rcp_f32 v71, v71
    v_mul_f32 v64, v64, v80
    v_mul_f32 v65, v65, v81
    s_waitcnt lgkmcnt(8)
    v_mfma_f32_32x32x16_bf16 v[32:47], a[52:55], a[16:19], v[32:47]
    ds_read_b64_tr_b16 a[128:129], v7 offset:1184
    ds_read_b64_tr_b16 a[130:131], v7 offset:1152
    ds_read_b64_tr_b16 a[132:133], v8 offset:1280
    ds_read_b64_tr_b16 a[134:135], v8 offset:1312
    v_mul_f32 v66, v66, v82
    v_mul_f32 v67, v67, v83
    v_mul_f32 v68, v68, v84
    v_mul_f32 v69, v69, v85
    v_mul_f32 v70, v70, v86
    v_mul_f32 v71, v71, v87
    v_cvt_pk_bf16_f32 v64, v64, v65
    v_cvt_pk_bf16_f32 v65, v66, v67
    v_cvt_pk_bf16_f32 v66, v68, v69
    v_cvt_pk_bf16_f32 v67, v70, v71
    s_nop 0
    v_permlane16_swap_b32 v64, v66
    v_permlane16_swap_b32 v65, v67
    buffer_store_dwordx4 v[64:67], v6, s[28:31], s60 offen offset:1024 sc1
    s_waitcnt lgkmcnt(8)
    v_mfma_f32_32x32x16_bf16 v[32:47], a[116:119], a[24:27], v[32:47]
    ds_read_b64_tr_b16 a[136:137], v7 offset:1312
    ds_read_b64_tr_b16 a[138:139], v7 offset:1280
    ds_read_b64_tr_b16 a[140:141], v8 offset:1152
    ds_read_b64_tr_b16 a[142:143], v8 offset:1184
    s_add_u32 m0, s18, 12288
    v_mul_f32 v88, v72, v88
    buffer_load_dwordx4 v2, s[44:47], s38 offen lds
    v_mul_f32 v89, v73, v89
    v_mul_f32 v90, v74, v90
    v_mul_f32 v91, v75, v91
    v_mul_f32 v92, v76, v92
    v_mul_f32 v93, v77, v93
    v_mfma_f32_32x32x16_bf16 v[32:47], a[4:7], a[32:35], v[32:47]
    v_mul_f32 v94, v78, v94
    v_mul_f32 v95, v79, v95
    v_mul_f32 v72, s27, v72
    v_mul_f32 v73, s27, v73
    v_mul_f32 v74, s27, v74
    v_mul_f32 v75, s27, v75
    v_mul_f32 v76, s27, v76
    v_mul_f32 v77, s27, v77
    v_mul_f32 v78, s27, v78
    v_mul_f32 v79, s27, v79
    v_exp_f32 v72, v72
    v_exp_f32 v73, v73
    v_exp_f32 v74, v74
    v_exp_f32 v75, v75
    v_mfma_f32_32x32x16_bf16 v[32:47], a[12:15], a[40:43], v[32:47]
    v_exp_f32 v76, v76
    s_add_u32 m0, s18, 13312
    v_exp_f32 v77, v77
    buffer_load_dwordx4 v3, s[44:47], s38 offen lds
    v_exp_f32 v78, v78
    v_exp_f32 v79, v79
    v_add_f32 v72, 1.0, v72
    v_add_f32 v73, 1.0, v73
    v_mfma_f32_32x32x16_bf16 v[32:47], a[20:23], a[48:51], v[32:47]
    v_add_f32 v74, 1.0, v74
    v_add_f32 v75, 1.0, v75
    v_add_f32 v76, 1.0, v76
    v_add_f32 v77, 1.0, v77
    v_add_f32 v78, 1.0, v78
    v_add_f32 v79, 1.0, v79
    v_rcp_f32 v72, v72
    v_rcp_f32 v73, v73
    v_rcp_f32 v74, v74
    v_rcp_f32 v75, v75
    v_rcp_f32 v76, v76
    v_rcp_f32 v77, v77
    v_mfma_f32_32x32x16_bf16 v[32:47], a[28:31], a[112:115], v[32:47]
    s_add_u32 m0, s19, 12288
    v_rcp_f32 v78, v78
    buffer_load_dwordx4 v2, s[44:47], s39 offen lds
    v_rcp_f32 v79, v79
    v_mul_f32 v72, v72, v88
    v_mul_f32 v73, v73, v89
    v_mul_f32 v74, v74, v90
    v_mul_f32 v75, v75, v91
    v_mul_f32 v76, v76, v92
    v_mul_f32 v77, v77, v93
    v_mul_f32 v78, v78, v94
    v_mul_f32 v79, v79, v95
    v_cvt_pk_bf16_f32 v72, v72, v73
    v_cvt_pk_bf16_f32 v73, v74, v75
    v_cvt_pk_bf16_f32 v74, v76, v77
    v_cvt_pk_bf16_f32 v75, v78, v79
    s_nop 0
    v_permlane16_swap_b32 v72, v74
    v_permlane16_swap_b32 v73, v75
    buffer_store_dwordx4 v[72:75], v6, s[28:31], s61 offen offset:1024 sc1
    v_mfma_f32_32x32x16_bf16 v[80:95], a[36:39], a[32:35], 0
    v_mul_f32 v112, v96, v112
    v_mul_f32 v113, v97, v113
    v_mul_f32 v114, v98, v114
    v_mul_f32 v115, v99, v115
    s_add_u32 m0, s19, 13312
    v_mul_f32 v116, v100, v116
    buffer_load_dwordx4 v3, s[44:47], s39 offen lds
    s_add_u32 s38, s38, 65536
    s_add_u32 s39, s39, 65536
    v_mul_f32 v117, v101, v117
    v_mul_f32 v118, v102, v118
    v_mul_f32 v119, v103, v119
    v_mul_f32 v96, s27, v96
    v_mul_f32 v97, s27, v97
    v_mfma_f32_32x32x16_bf16 v[80:95], a[44:47], a[40:43], v[80:95]
    v_mul_f32 v98, s27, v98
    v_mul_f32 v99, s27, v99
    v_mul_f32 v100, s27, v100
    v_mul_f32 v101, s27, v101
    v_mul_f32 v102, s27, v102
    v_mul_f32 v103, s27, v103
    v_exp_f32 v96, v96
    v_exp_f32 v97, v97
    v_exp_f32 v98, v98
    v_exp_f32 v99, v99
    v_exp_f32 v100, v100
    v_exp_f32 v101, v101
    v_mfma_f32_32x32x16_bf16 v[80:95], a[52:55], a[48:51], v[80:95]
    v_exp_f32 v102, v102
    s_add_u32 m0, s18, 16384
    v_exp_f32 v103, v103
    buffer_load_dwordx4 v2, s[44:47], s38 offen lds
    v_add_f32 v96, 1.0, v96
    v_add_f32 v97, 1.0, v97
    v_add_f32 v98, 1.0, v98
    v_add_f32 v99, 1.0, v99
    v_add_f32 v100, 1.0, v100
    v_add_f32 v101, 1.0, v101
    v_mfma_f32_32x32x16_bf16 v[80:95], a[116:119], a[112:115], v[80:95]
    v_add_f32 v102, 1.0, v102
    v_add_f32 v103, 1.0, v103
    v_rcp_f32 v96, v96
    v_rcp_f32 v97, v97
    v_rcp_f32 v98, v98
    v_rcp_f32 v99, v99
    v_rcp_f32 v100, v100
    v_rcp_f32 v101, v101
    v_rcp_f32 v102, v102
    v_rcp_f32 v103, v103
    s_waitcnt lgkmcnt(8)
    v_mfma_f32_32x32x16_bf16 v[80:95], a[124:127], a[0:3], v[80:95]
    ds_read_b64_tr_b16 a[144:145], v7 offset:1440
    ds_read_b64_tr_b16 a[146:147], v7 offset:1408
    ds_read_b64_tr_b16 a[148:149], v8 offset:1024
    ds_read_b64_tr_b16 a[150:151], v8 offset:1056
    s_add_u32 m0, s18, 17408
    v_mul_f32 v96, v96, v112
    buffer_load_dwordx4 v3, s[44:47], s38 offen lds
    v_mul_f32 v97, v97, v113
    v_mul_f32 v98, v98, v114
    v_mul_f32 v99, v99, v115
    v_mul_f32 v100, v100, v116
    v_mul_f32 v101, v101, v117
    s_waitcnt lgkmcnt(8)
    v_mfma_f32_32x32x16_bf16 v[80:95], a[132:135], a[8:11], v[80:95]
    ds_read_b64_tr_b16 a[152:153], v7 offset:1568
    ds_read_b64_tr_b16 a[154:155], v7 offset:1536
    ds_read_b64_tr_b16 a[156:157], v8 offset:1920
    ds_read_b64_tr_b16 a[158:159], v8 offset:1952
    v_mul_f32 v102, v102, v118
    v_mul_f32 v103, v103, v119
    v_cvt_pk_bf16_f32 v96, v96, v97
    v_cvt_pk_bf16_f32 v97, v98, v99
    v_cvt_pk_bf16_f32 v98, v100, v101
    v_cvt_pk_bf16_f32 v99, v102, v103
    s_nop 0
    v_permlane16_swap_b32 v96, v98
    v_permlane16_swap_b32 v97, v99
    buffer_store_dwordx4 v[96:99], v6, s[28:31], s60 offen offset:2048 sc1
    s_waitcnt lgkmcnt(8)
    v_mfma_f32_32x32x16_bf16 v[80:95], a[140:143], a[16:19], v[80:95]
    ds_read_b64_tr_b16 a[176:177], v7 offset:1696
    ds_read_b64_tr_b16 a[178:179], v7 offset:1664
    ds_read_b64_tr_b16 a[180:181], v8 offset:1792
    ds_read_b64_tr_b16 a[182:183], v8 offset:1824
    s_add_u32 m0, s19, 16384
    v_mul_f32 v120, v104, v120
    buffer_load_dwordx4 v2, s[44:47], s39 offen lds
    v_mul_f32 v121, v105, v121
    v_mul_f32 v122, v106, v122
    v_mul_f32 v123, v107, v123
    v_mul_f32 v124, v108, v124
    v_mul_f32 v125, v109, v125
    s_waitcnt lgkmcnt(8)
    v_mfma_f32_32x32x16_bf16 v[80:95], a[148:151], a[24:27], v[80:95]
    ds_read_b64_tr_b16 a[184:185], v7 offset:1824
    ds_read_b64_tr_b16 a[186:187], v7 offset:1792
    ds_read_b64_tr_b16 a[188:189], v8 offset:1664
    ds_read_b64_tr_b16 a[190:191], v8 offset:1696
    v_mul_f32 v126, v110, v126
    v_mul_f32 v127, v111, v127
    v_mul_f32 v104, s27, v104
    v_mul_f32 v105, s27, v105
    v_mul_f32 v106, s27, v106
    v_mul_f32 v107, s27, v107
    v_mul_f32 v108, s27, v108
    v_mul_f32 v109, s27, v109
    v_mul_f32 v110, s27, v110
    v_mul_f32 v111, s27, v111
    v_exp_f32 v104, v104
    v_exp_f32 v105, v105
    v_mfma_f32_32x32x16_bf16 v[80:95], a[4:7], a[120:123], v[80:95]
    v_exp_f32 v106, v106
    s_add_u32 m0, s19, 17408
    v_exp_f32 v107, v107
    buffer_load_dwordx4 v3, s[44:47], s39 offen lds
    s_add_u32 s38, s38, 65536
    s_add_u32 s39, s39, 65536
    v_exp_f32 v108, v108
    v_exp_f32 v109, v109
    v_exp_f32 v110, v110
    v_mfma_f32_32x32x16_bf16 v[80:95], a[12:15], a[128:131], v[80:95]
    v_exp_f32 v111, v111
    v_add_f32 v104, 1.0, v104
    v_add_f32 v105, 1.0, v105
    v_add_f32 v106, 1.0, v106
    v_add_f32 v107, 1.0, v107
    v_add_f32 v108, 1.0, v108
    v_add_f32 v109, 1.0, v109
    v_add_f32 v110, 1.0, v110
    v_add_f32 v111, 1.0, v111
    v_rcp_f32 v104, v104
    v_rcp_f32 v105, v105
    v_rcp_f32 v106, v106
    v_rcp_f32 v107, v107
    v_mfma_f32_32x32x16_bf16 v[80:95], a[20:23], a[136:139], v[80:95]
    s_add_u32 m0, s18, 20480
    v_rcp_f32 v108, v108
    buffer_load_dwordx4 v2, s[44:47], s38 offen lds
    v_rcp_f32 v109, v109
    v_rcp_f32 v110, v110
    v_rcp_f32 v111, v111
    v_mul_f32 v104, v104, v120
    v_mul_f32 v105, v105, v121
    v_mfma_f32_32x32x16_bf16 v[80:95], a[28:31], a[144:147], v[80:95]
    v_mul_f32 v106, v106, v122
    v_mul_f32 v107, v107, v123
    v_mul_f32 v108, v108, v124
    v_mul_f32 v109, v109, v125
    v_mul_f32 v110, v110, v126
    v_mul_f32 v111, v111, v127
    v_cvt_pk_bf16_f32 v104, v104, v105
    v_cvt_pk_bf16_f32 v105, v106, v107
    v_cvt_pk_bf16_f32 v106, v108, v109
    v_cvt_pk_bf16_f32 v107, v110, v111
    s_nop 0
    v_permlane16_swap_b32 v104, v106
    v_permlane16_swap_b32 v105, v107
    buffer_store_dwordx4 v[104:107], v6, s[28:31], s61 offen offset:2048 sc1
    v_mfma_f32_32x32x16_bf16 v[64:79], a[124:127], a[32:35], 0
    s_add_u32 m0, s18, 21504
    s_nop 0
    buffer_load_dwordx4 v3, s[44:47], s38 offen lds
    v_mul_f32 v144, v128, v144
    v_mul_f32 v145, v129, v145
    v_mul_f32 v146, v130, v146
    v_mul_f32 v147, v131, v147
    v_mul_f32 v148, v132, v148
    v_mul_f32 v149, v133, v149
    v_mul_f32 v150, v134, v150
    v_mul_f32 v151, v135, v151
    v_mul_f32 v128, s27, v128
    v_mul_f32 v129, s27, v129
    v_mfma_f32_32x32x16_bf16 v[64:79], a[132:135], a[40:43], v[64:79]
    v_mul_f32 v130, s27, v130
    v_mul_f32 v131, s27, v131
    v_mul_f32 v132, s27, v132
    v_mul_f32 v133, s27, v133
    v_mul_f32 v134, s27, v134
    v_mul_f32 v135, s27, v135
    v_exp_f32 v128, v128
    v_exp_f32 v129, v129
    v_exp_f32 v130, v130
    v_exp_f32 v131, v131
    v_exp_f32 v132, v132
    s_add_u32 m0, s19, 20480
    v_exp_f32 v133, v133
    buffer_load_dwordx4 v2, s[44:47], s39 offen lds
    v_mfma_f32_32x32x16_bf16 v[64:79], a[140:143], a[48:51], v[64:79]
    v_exp_f32 v134, v134
    v_exp_f32 v135, v135
    v_add_f32 v128, 1.0, v128
    v_add_f32 v129, 1.0, v129
    v_add_f32 v130, 1.0, v130
    v_add_f32 v131, 1.0, v131
    v_add_f32 v132, 1.0, v132
    v_add_f32 v133, 1.0, v133
    v_add_f32 v134, 1.0, v134
    v_add_f32 v135, 1.0, v135
    v_rcp_f32 v128, v128
    v_rcp_f32 v129, v129
    v_rcp_f32 v130, v130
    v_mfma_f32_32x32x16_bf16 v[64:79], a[148:151], a[112:115], v[64:79]
    v_rcp_f32 v131, v131
    v_rcp_f32 v132, v132
    v_rcp_f32 v133, v133
    s_add_u32 m0, s19, 21504
    v_rcp_f32 v134, v134
    buffer_load_dwordx4 v3, s[44:47], s39 offen lds
    s_add_u32 s38, s38, 65536
    s_add_u32 s39, s39, 65536
    v_rcp_f32 v135, v135
    v_mfma_f32_32x32x16_bf16 v[64:79], a[36:39], a[120:123], v[64:79]
    v_mul_f32 v128, v128, v144
    v_mul_f32 v129, v129, v145
    v_mul_f32 v130, v130, v146
    v_mul_f32 v131, v131, v147
    v_mul_f32 v132, v132, v148
    v_mul_f32 v133, v133, v149
    v_mul_f32 v134, v134, v150
    v_mul_f32 v135, v135, v151
    v_cvt_pk_bf16_f32 v128, v128, v129
    v_cvt_pk_bf16_f32 v129, v130, v131
    v_cvt_pk_bf16_f32 v130, v132, v133
    v_cvt_pk_bf16_f32 v131, v134, v135
    s_nop 0
    v_permlane16_swap_b32 v128, v130
    v_permlane16_swap_b32 v129, v131
    buffer_store_dwordx4 v[128:131], v6, s[28:31], s60 offen offset:3072 sc1
    v_mfma_f32_32x32x16_bf16 v[64:79], a[44:47], a[128:131], v[64:79]
    v_mul_f32 v152, v136, v152
    v_mul_f32 v153, v137, v153
    v_mul_f32 v154, v138, v154
    v_mul_f32 v155, v139, v155
    v_mul_f32 v156, v140, v156
    v_mul_f32 v157, v141, v157
    v_mul_f32 v158, v142, v158
    v_mul_f32 v159, v143, v159
    v_mul_f32 v136, s27, v136
    v_mul_f32 v137, s27, v137
    v_mul_f32 v138, s27, v138
    v_mul_f32 v139, s27, v139
    v_mul_f32 v140, s27, v140
    v_mul_f32 v141, s27, v141
    v_mul_f32 v142, s27, v142
    v_mul_f32 v143, s27, v143
    v_exp_f32 v136, v136
    v_mfma_f32_32x32x16_bf16 v[64:79], a[52:55], a[136:139], v[64:79]
    v_exp_f32 v137, v137
    v_exp_f32 v138, v138
    v_exp_f32 v139, v139
    v_exp_f32 v140, v140
    v_exp_f32 v141, v141
    v_exp_f32 v142, v142
    v_exp_f32 v143, v143
    v_add_f32 v136, 1.0, v136
    v_add_f32 v137, 1.0, v137
    v_add_f32 v138, 1.0, v138
    v_mfma_f32_32x32x16_bf16 v[64:79], a[116:119], a[144:147], v[64:79]
    v_add_f32 v139, 1.0, v139
    v_add_f32 v140, 1.0, v140
    v_add_f32 v141, 1.0, v141
    v_add_f32 v142, 1.0, v142
    v_add_f32 v143, 1.0, v143
    v_rcp_f32 v136, v136
    v_rcp_f32 v137, v137
    v_rcp_f32 v138, v138
    v_rcp_f32 v139, v139
    v_rcp_f32 v140, v140
    v_rcp_f32 v141, v141
    s_waitcnt lgkmcnt(8)
    v_mfma_f32_32x32x16_bf16 v[64:79], a[156:159], a[0:3], v[64:79]
    ds_read_b64_tr_b16 a[192:193], v7 offset:1952
    ds_read_b64_tr_b16 a[194:195], v7 offset:1920
    ds_read_b64_tr_b16 a[196:197], v8 offset:1536
    ds_read_b64_tr_b16 a[198:199], v8 offset:1568
    v_rcp_f32 v142, v142
    v_rcp_f32 v143, v143
    v_mul_f32 v136, v136, v152
    v_mul_f32 v137, v137, v153
    v_mul_f32 v138, v138, v154
    v_mul_f32 v139, v139, v155
    v_mul_f32 v140, v140, v156
    v_mul_f32 v141, v141, v157
    v_mul_f32 v142, v142, v158
    v_mul_f32 v143, v143, v159
    v_cvt_pk_bf16_f32 v136, v136, v137
    s_waitcnt lgkmcnt(8)
    v_mfma_f32_32x32x16_bf16 v[64:79], a[180:183], a[8:11], v[64:79]
    ds_read_b64_tr_b16 a[200:201], v7 offset:2080
    ds_read_b64_tr_b16 a[202:203], v7 offset:2048
    ds_read_b64_tr_b16 a[204:205], v8 offset:2432
    ds_read_b64_tr_b16 a[206:207], v8 offset:2464
    v_cvt_pk_bf16_f32 v137, v138, v139
    v_cvt_pk_bf16_f32 v138, v140, v141
    v_cvt_pk_bf16_f32 v139, v142, v143
    s_nop 0
    v_permlane16_swap_b32 v136, v138
    v_permlane16_swap_b32 v137, v139
    buffer_store_dwordx4 v[136:139], v6, s[28:31], s61 offen offset:3072 sc1
    v_mul_f32 v176, v160, v176
    v_mul_f32 v177, v161, v177
    s_waitcnt lgkmcnt(8)
    v_mfma_f32_32x32x16_bf16 v[64:79], a[188:191], a[16:19], v[64:79]
    ds_read_b64_tr_b16 a[208:209], v7 offset:2208
    ds_read_b64_tr_b16 a[210:211], v7 offset:2176
    ds_read_b64_tr_b16 a[212:213], v8 offset:2304
    ds_read_b64_tr_b16 a[214:215], v8 offset:2336
    v_mul_f32 v178, v162, v178
    v_mul_f32 v179, v163, v179
    v_mul_f32 v180, v164, v180
    v_mul_f32 v181, v165, v181
    v_mul_f32 v182, v166, v182
    v_mul_f32 v183, v167, v183
    v_mul_f32 v160, s27, v160
    v_mul_f32 v161, s27, v161
    v_mul_f32 v162, s27, v162
    v_mul_f32 v163, s27, v163
    v_mul_f32 v164, s27, v164
    v_mul_f32 v165, s27, v165
    v_mul_f32 v166, s27, v166
    s_waitcnt lgkmcnt(8)
    v_mfma_f32_32x32x16_bf16 v[64:79], a[196:199], a[24:27], v[64:79]
    ds_read_b64_tr_b16 a[216:217], v7 offset:2336
    ds_read_b64_tr_b16 a[218:219], v7 offset:2304
    ds_read_b64_tr_b16 a[220:221], v8 offset:2176
    ds_read_b64_tr_b16 a[222:223], v8 offset:2208
    v_mul_f32 v167, s27, v167
    v_exp_f32 v160, v160
    v_exp_f32 v161, v161
    v_exp_f32 v162, v162
    v_exp_f32 v163, v163
    v_exp_f32 v164, v164
    v_exp_f32 v165, v165
    v_mfma_f32_32x32x16_bf16 v[64:79], a[4:7], a[152:155], v[64:79]
    v_exp_f32 v166, v166
    v_exp_f32 v167, v167
    v_add_f32 v160, 1.0, v160
    v_add_f32 v161, 1.0, v161
    v_add_f32 v162, 1.0, v162
    v_add_f32 v163, 1.0, v163
    v_add_f32 v164, 1.0, v164
    v_add_f32 v165, 1.0, v165
    v_add_f32 v166, 1.0, v166
    v_add_f32 v167, 1.0, v167
    v_rcp_f32 v160, v160
    v_rcp_f32 v161, v161
    v_rcp_f32 v162, v162
    v_mfma_f32_32x32x16_bf16 v[64:79], a[12:15], a[176:179], v[64:79]
    v_rcp_f32 v163, v163
    v_rcp_f32 v164, v164
    v_rcp_f32 v165, v165
    v_rcp_f32 v166, v166
    v_rcp_f32 v167, v167
    v_mul_f32 v160, v160, v176
    v_mul_f32 v161, v161, v177
    v_mul_f32 v162, v162, v178
    v_mul_f32 v163, v163, v179
    v_mul_f32 v164, v164, v180
    v_mul_f32 v165, v165, v181
    v_mul_f32 v166, v166, v182
    v_mfma_f32_32x32x16_bf16 v[64:79], a[20:23], a[184:187], v[64:79]
    v_mul_f32 v167, v167, v183
    v_cvt_pk_bf16_f32 v160, v160, v161
    v_cvt_pk_bf16_f32 v161, v162, v163
    v_cvt_pk_bf16_f32 v162, v164, v165
    v_cvt_pk_bf16_f32 v163, v166, v167
    s_nop 0
    v_permlane16_swap_b32 v160, v162
    v_permlane16_swap_b32 v161, v163
    buffer_store_dwordx4 v[160:163], v6, s[28:31], s62 offen offset:0 sc1
    v_mul_f32 v184, v168, v184
    v_mul_f32 v185, v169, v185
    v_mul_f32 v186, v170, v186
    v_mul_f32 v187, v171, v187
    v_mfma_f32_32x32x16_bf16 v[64:79], a[28:31], a[192:195], v[64:79]
    v_mul_f32 v188, v172, v188
    v_mul_f32 v189, v173, v189
    v_mul_f32 v190, v174, v190
    v_mul_f32 v191, v175, v191
    v_mul_f32 v168, s27, v168
    v_mul_f32 v169, s27, v169
    v_mul_f32 v170, s27, v170
    v_mul_f32 v171, s27, v171
    v_mul_f32 v172, s27, v172
    v_mul_f32 v173, s27, v173
    v_mul_f32 v174, s27, v174
    v_mul_f32 v175, s27, v175
    v_exp_f32 v168, v168
    v_exp_f32 v169, v169
    v_exp_f32 v170, v170
    v_mfma_f32_32x32x16_bf16 v[112:127], a[124:127], a[120:123], 0
    v_exp_f32 v171, v171
    v_exp_f32 v172, v172
    v_exp_f32 v173, v173
    v_exp_f32 v174, v174
    v_exp_f32 v175, v175
    v_add_f32 v168, 1.0, v168
    v_add_f32 v169, 1.0, v169
    v_add_f32 v170, 1.0, v170
    v_add_f32 v171, 1.0, v171
    v_add_f32 v172, 1.0, v172
    v_add_f32 v173, 1.0, v173
    v_add_f32 v174, 1.0, v174
    v_mfma_f32_32x32x16_bf16 v[112:127], a[132:135], a[128:131], v[112:127]
    v_add_f32 v175, 1.0, v175
    v_rcp_f32 v168, v168
    v_rcp_f32 v169, v169
    v_rcp_f32 v170, v170
    v_rcp_f32 v171, v171
    v_rcp_f32 v172, v172
    v_rcp_f32 v173, v173
    v_rcp_f32 v174, v174
    v_rcp_f32 v175, v175
    v_mfma_f32_32x32x16_bf16 v[112:127], a[140:143], a[136:139], v[112:127]
    v_mul_f32 v168, v168, v184
    v_mul_f32 v169, v169, v185
    v_mul_f32 v170, v170, v186
    v_mul_f32 v171, v171, v187
    v_mul_f32 v172, v172, v188
    v_mul_f32 v173, v173, v189
    v_mul_f32 v174, v174, v190
    v_mul_f32 v175, v175, v191
    v_cvt_pk_bf16_f32 v168, v168, v169
    v_cvt_pk_bf16_f32 v169, v170, v171
    v_cvt_pk_bf16_f32 v170, v172, v173
    v_cvt_pk_bf16_f32 v171, v174, v175
    s_nop 0
    v_permlane16_swap_b32 v168, v170
    v_permlane16_swap_b32 v169, v171
    buffer_store_dwordx4 v[168:171], v6, s[28:31], s63 offen offset:0 sc1
    v_mfma_f32_32x32x16_bf16 v[112:127], a[148:151], a[144:147], v[112:127]
    v_mul_f32 v208, v192, v208
    v_mul_f32 v209, v193, v209
    v_mul_f32 v210, v194, v210
    v_mul_f32 v211, v195, v211
    v_mul_f32 v212, v196, v212
    v_mul_f32 v213, v197, v213
    v_mul_f32 v214, v198, v214
    v_mul_f32 v215, v199, v215
    v_mul_f32 v192, s27, v192
    v_mul_f32 v193, s27, v193
    v_mul_f32 v194, s27, v194
    v_mul_f32 v195, s27, v195
    v_mul_f32 v196, s27, v196
    v_mul_f32 v197, s27, v197
    v_mul_f32 v198, s27, v198
    v_mul_f32 v199, s27, v199
    v_exp_f32 v192, v192
    v_mfma_f32_32x32x16_bf16 v[112:127], a[156:159], a[32:35], v[112:127]
    v_exp_f32 v193, v193
    v_exp_f32 v194, v194
    v_exp_f32 v195, v195
    v_exp_f32 v196, v196
    v_exp_f32 v197, v197
    v_exp_f32 v198, v198
    v_exp_f32 v199, v199
    v_add_f32 v192, 1.0, v192
    v_add_f32 v193, 1.0, v193
    v_add_f32 v194, 1.0, v194
    v_mfma_f32_32x32x16_bf16 v[112:127], a[180:183], a[40:43], v[112:127]
    v_add_f32 v195, 1.0, v195
    v_add_f32 v196, 1.0, v196
    v_add_f32 v197, 1.0, v197
    v_add_f32 v198, 1.0, v198
    v_add_f32 v199, 1.0, v199
    v_rcp_f32 v192, v192
    v_rcp_f32 v193, v193
    v_rcp_f32 v194, v194
    v_rcp_f32 v195, v195
    v_rcp_f32 v196, v196
    v_rcp_f32 v197, v197
    v_mfma_f32_32x32x16_bf16 v[112:127], a[188:191], a[48:51], v[112:127]
    v_rcp_f32 v198, v198
    v_rcp_f32 v199, v199
    v_mul_f32 v192, v192, v208
    v_mul_f32 v193, v193, v209
    v_mul_f32 v194, v194, v210
    v_mul_f32 v195, v195, v211
    v_mul_f32 v196, v196, v212
    v_mul_f32 v197, v197, v213
    v_mul_f32 v198, v198, v214
    v_mul_f32 v199, v199, v215
    v_cvt_pk_bf16_f32 v192, v192, v193
    v_cvt_pk_bf16_f32 v193, v194, v195
    v_cvt_pk_bf16_f32 v194, v196, v197
    v_cvt_pk_bf16_f32 v195, v198, v199
    s_nop 0
    v_permlane16_swap_b32 v192, v194
    v_mfma_f32_32x32x16_bf16 v[112:127], a[196:199], a[112:115], v[112:127]
    v_permlane16_swap_b32 v193, v195
    buffer_store_dwordx4 v[192:195], v6, s[28:31], s62 offen offset:1024 sc1
    v_mul_f32 v216, v200, v216
    v_mul_f32 v217, v201, v217
    v_mul_f32 v218, v202, v218
    v_mul_f32 v219, v203, v219
    v_mul_f32 v220, v204, v220
    v_mul_f32 v221, v205, v221
    v_mul_f32 v222, v206, v222
    v_mul_f32 v223, v207, v223
    v_mul_f32 v200, s27, v200
    v_mul_f32 v201, s27, v201
    v_mfma_f32_32x32x16_bf16 v[112:127], a[36:39], a[152:155], v[112:127]
    v_mul_f32 v202, s27, v202
    v_mul_f32 v203, s27, v203
    v_mul_f32 v204, s27, v204
    v_mul_f32 v205, s27, v205
    v_mul_f32 v206, s27, v206
    v_mul_f32 v207, s27, v207
    v_exp_f32 v200, v200
    v_exp_f32 v201, v201
    v_exp_f32 v202, v202
    v_exp_f32 v203, v203
    v_exp_f32 v204, v204
    v_exp_f32 v205, v205
    v_mfma_f32_32x32x16_bf16 v[112:127], a[44:47], a[176:179], v[112:127]
    v_exp_f32 v206, v206
    v_exp_f32 v207, v207
    v_add_f32 v200, 1.0, v200
    v_add_f32 v201, 1.0, v201
    v_add_f32 v202, 1.0, v202
    v_add_f32 v203, 1.0, v203
    v_add_f32 v204, 1.0, v204
    v_add_f32 v205, 1.0, v205
    v_add_f32 v206, 1.0, v206
    v_add_f32 v207, 1.0, v207
    v_rcp_f32 v200, v200
    v_rcp_f32 v201, v201
    v_rcp_f32 v202, v202
    v_mfma_f32_32x32x16_bf16 v[112:127], a[52:55], a[184:187], v[112:127]
    v_rcp_f32 v203, v203
    v_rcp_f32 v204, v204
    v_rcp_f32 v205, v205
    v_rcp_f32 v206, v206
    v_rcp_f32 v207, v207
    v_mul_f32 v200, v200, v216
    v_mul_f32 v201, v201, v217
    v_mul_f32 v202, v202, v218
    v_mul_f32 v203, v203, v219
    v_mul_f32 v204, v204, v220
    v_mul_f32 v205, v205, v221
    v_mul_f32 v206, v206, v222
    v_mfma_f32_32x32x16_bf16 v[112:127], a[116:119], a[192:195], v[112:127]
    v_mul_f32 v207, v207, v223
    v_cvt_pk_bf16_f32 v200, v200, v201
    v_cvt_pk_bf16_f32 v201, v202, v203
    v_cvt_pk_bf16_f32 v202, v204, v205
    v_cvt_pk_bf16_f32 v203, v206, v207
    s_nop 0
    v_permlane16_swap_b32 v200, v202
    v_permlane16_swap_b32 v201, v203
    buffer_store_dwordx4 v[200:203], v6, s[28:31], s63 offen offset:1024 sc1
    v_mul_f32 v240, v224, v240
    v_mul_f32 v241, v225, v241
    v_mul_f32 v242, v226, v242
    v_mul_f32 v243, v227, v243
    s_waitcnt lgkmcnt(8)
    v_mfma_f32_32x32x16_bf16 v[112:127], a[204:207], a[0:3], v[112:127]
    ds_read_b64_tr_b16 a[224:225], v7 offset:2464
    ds_read_b64_tr_b16 a[226:227], v7 offset:2432
    ds_read_b64_tr_b16 a[228:229], v8 offset:2048
    ds_read_b64_tr_b16 a[230:231], v8 offset:2080
    v_mul_f32 v244, v228, v244
    v_mul_f32 v245, v229, v245
    v_mul_f32 v246, v230, v246
    v_mul_f32 v247, v231, v247
    v_mul_f32 v224, s27, v224
    v_mul_f32 v225, s27, v225
    v_mul_f32 v226, s27, v226
    v_mul_f32 v227, s27, v227
    v_mul_f32 v228, s27, v228
    v_mul_f32 v229, s27, v229
    v_mul_f32 v230, s27, v230
    v_mul_f32 v231, s27, v231
    v_exp_f32 v224, v224
    s_waitcnt lgkmcnt(8)
    v_mfma_f32_32x32x16_bf16 v[112:127], a[212:215], a[8:11], v[112:127]
    ds_read_b64_tr_b16 a[232:233], v7 offset:2592
    ds_read_b64_tr_b16 a[234:235], v7 offset:2560
    ds_read_b64_tr_b16 a[236:237], v8 offset:2944
    ds_read_b64_tr_b16 a[238:239], v8 offset:2976
    v_exp_f32 v225, v225
    v_exp_f32 v226, v226
    v_exp_f32 v227, v227
    v_exp_f32 v228, v228
    v_exp_f32 v229, v229
    v_exp_f32 v230, v230
    v_exp_f32 v231, v231
    s_waitcnt lgkmcnt(8)
    v_mfma_f32_32x32x16_bf16 v[112:127], a[220:223], a[16:19], v[112:127]
    ds_read_b64_tr_b16 a[240:241], v7 offset:2720
    ds_read_b64_tr_b16 a[242:243], v7 offset:2688
    ds_read_b64_tr_b16 a[244:245], v8 offset:2816
    ds_read_b64_tr_b16 a[246:247], v8 offset:2848
    v_add_f32 v224, 1.0, v224
    v_add_f32 v225, 1.0, v225
    v_add_f32 v226, 1.0, v226
    v_add_f32 v227, 1.0, v227
    v_add_f32 v228, 1.0, v228
    v_add_f32 v229, 1.0, v229
    v_add_f32 v230, 1.0, v230
    v_add_f32 v231, 1.0, v231
    v_rcp_f32 v224, v224
    v_rcp_f32 v225, v225
    v_rcp_f32 v226, v226
    s_waitcnt lgkmcnt(8)
    v_mfma_f32_32x32x16_bf16 v[112:127], a[228:231], a[24:27], v[112:127]
    ds_read_b64_tr_b16 a[248:249], v7 offset:2848
    ds_read_b64_tr_b16 a[250:251], v7 offset:2816
    ds_read_b64_tr_b16 a[252:253], v8 offset:2688
    ds_read_b64_tr_b16 a[254:255], v8 offset:2720
    v_rcp_f32 v227, v227
    v_rcp_f32 v228, v228
    v_rcp_f32 v229, v229
    v_rcp_f32 v230, v230
    v_rcp_f32 v231, v231
    v_mul_f32 v224, v224, v240
    v_mul_f32 v225, v225, v241
    v_mul_f32 v226, v226, v242
    v_mfma_f32_32x32x16_bf16 v[112:127], a[4:7], a[200:203], v[112:127]
    v_mul_f32 v227, v227, v243
    v_mul_f32 v228, v228, v244
    v_mul_f32 v229, v229, v245
    v_mul_f32 v230, v230, v246
    v_mul_f32 v231, v231, v247
    v_cvt_pk_bf16_f32 v224, v224, v225
    v_cvt_pk_bf16_f32 v225, v226, v227
    v_cvt_pk_bf16_f32 v226, v228, v229
    v_cvt_pk_bf16_f32 v227, v230, v231
    s_nop 0
    v_permlane16_swap_b32 v224, v226
    v_permlane16_swap_b32 v225, v227
    buffer_store_dwordx4 v[224:227], v6, s[28:31], s62 offen offset:2048 sc1
    v_mfma_f32_32x32x16_bf16 v[112:127], a[12:15], a[208:211], v[112:127]
    v_mul_f32 v248, v232, v248
    v_mul_f32 v249, v233, v249
    v_mul_f32 v250, v234, v250
    v_mul_f32 v251, v235, v251
    v_mul_f32 v252, v236, v252
    v_mul_f32 v253, v237, v253
    v_mul_f32 v254, v238, v254
    v_mul_f32 v255, v239, v255
    v_mul_f32 v232, s27, v232
    v_mul_f32 v233, s27, v233
    v_mul_f32 v234, s27, v234
    v_mul_f32 v235, s27, v235
    v_mul_f32 v236, s27, v236
    v_mul_f32 v237, s27, v237
    v_mul_f32 v238, s27, v238
    v_mul_f32 v239, s27, v239
    v_exp_f32 v232, v232
    v_mfma_f32_32x32x16_bf16 v[112:127], a[20:23], a[216:219], v[112:127]
    v_exp_f32 v233, v233
    v_exp_f32 v234, v234
    v_exp_f32 v235, v235
    v_exp_f32 v236, v236
    v_exp_f32 v237, v237
    v_exp_f32 v238, v238
    v_exp_f32 v239, v239
    v_add_f32 v232, 1.0, v232
    v_add_f32 v233, 1.0, v233
    v_add_f32 v234, 1.0, v234
    v_mfma_f32_32x32x16_bf16 v[112:127], a[28:31], a[224:227], v[112:127]
    v_add_f32 v235, 1.0, v235
    v_add_f32 v236, 1.0, v236
    v_add_f32 v237, 1.0, v237
    v_add_f32 v238, 1.0, v238
    v_add_f32 v239, 1.0, v239
    v_rcp_f32 v232, v232
    v_rcp_f32 v233, v233
    v_rcp_f32 v234, v234
    v_rcp_f32 v235, v235
    v_rcp_f32 v236, v236
    v_rcp_f32 v237, v237
    v_mfma_f32_32x32x16_bf16 v[96:111], a[156:159], a[120:123], 0
    v_rcp_f32 v238, v238
    v_rcp_f32 v239, v239
    v_mul_f32 v232, v232, v248
    v_mul_f32 v233, v233, v249
    v_mul_f32 v234, v234, v250
    v_mul_f32 v235, v235, v251
    v_mul_f32 v236, v236, v252
    v_mul_f32 v237, v237, v253
    v_mul_f32 v238, v238, v254
    v_mul_f32 v239, v239, v255
    v_cvt_pk_bf16_f32 v232, v232, v233
    v_cvt_pk_bf16_f32 v233, v234, v235
    v_cvt_pk_bf16_f32 v234, v236, v237
    v_cvt_pk_bf16_f32 v235, v238, v239
    s_nop 0
    v_permlane16_swap_b32 v232, v234
    v_mfma_f32_32x32x16_bf16 v[96:111], a[180:183], a[128:131], v[96:111]
    v_permlane16_swap_b32 v233, v235
    buffer_store_dwordx4 v[232:235], v6, s[28:31], s63 offen offset:2048 sc1
    s_mov_b32 s4, s92
    s_and_b32 s5, s93, 0xffff
    s_mov_b32 s6, 0x400000
    s_mov_b32 s7, 0x00020000
    v_lshrrev_b32 v12, 5, v0
    v_lshlrev_b32 v12, 10, v12
    v_bfe_u32 v13, v0, 4, 1
    v_lshl_add_u32 v12, v13, 9, v12
    v_and_b32 v13, 15, v0
    v_lshl_add_u32 v16, v13, 4, v12
    s_and_b32 s58, s32, 1
    s_mul_i32 s59, s58, 229376
    v_add_u32 v12, s59, v16
    v_mfma_f32_32x32x16_bf16 v[96:111], a[188:191], a[136:139], v[96:111]
    s_sub_u32 s59, 229376, s59
    v_add_u32 v13, s59, v16
    s_lshl_b32 s37, s96, 2
    s_and_b32 s59, s32, 2
    s_add_u32 s37, s37, s59
    s_mul_i32 s37, s37, 224
    s_and_b32 s59, s97, 1
    s_lshl_b32 s59, s59, 1
    s_add_u32 s59, s59, s58
    s_mul_i32 s59, s59, 56
    s_add_u32 s37, s37, s59
    s_lshl_b32 s37, s37, 10
    v_mfma_f32_32x32x16_bf16 v[96:111], a[196:199], a[144:147], v[96:111]
    s_mul_i32 s58, s58, 40960
    v_lshrrev_b32 v17, 4, v0
    v_bfe_u32 v18, v0, 2, 2
    v_lshl_add_u32 v17, v17, 3, v18
    v_bfe_u32 v18, v17, 1, 1
    v_bfe_u32 v19, v17, 3, 1
    v_lshl_add_u32 v18, v19, 1, v18
    v_mfma_f32_32x32x16_bf16 v[96:111], a[124:127], a[152:155], v[96:111]
    v_lshlrev_b32 v17, 7, v17
    v_lshl_add_u32 v17, v18, 5, v17
    v_and_b32 v18, 3, v0
    v_lshl_add_u32 v17, v18, 3, v17
    v_add_u32 v17, s58, v17
    v_xor_b32 v18, 32, v17
    v_mfma_f32_32x32x16_bf16 v[96:111], a[132:135], a[176:179], v[96:111]
    v_xor_b32 v19, 64, v17
    v_xor_b32 v20, 0x60, v17
    v_add_u32 v14, 81920, v17
    v_add_u32 v15, 81920, v18
    v_add_u32 v16, 81920, v19
    v_add_u32 v29, 81920, v20
    v_mfma_f32_32x32x16_bf16 v[96:111], a[140:143], a[184:187], v[96:111]
    s_lshr_b32 s16, s96, 1
    s_mul_i32 s16, s16, 4352
    s_and_b32 s57, s97, 1
    s_lshl_b32 s57, s57, 6
    s_add_u32 s16, s16, s57
    s_add_u32 s16, s16, 22020096
    v_and_b32 v26, 15, v0
    v_lshlrev_b32 v26, 2, v26
    v_add_f32_dpp v192, v51, v50 wave_shr:1 row_mask:0xf bank_mask:0xf bound_ctrl:0
    v_mfma_f32_32x32x16_bf16 v[96:111], a[148:151], a[192:195], v[96:111]
    v_add_f32_dpp v193, v51, v54 wave_ror:1 row_mask:0xf bank_mask:0xf
    v_add_f32_dpp v194, v55, v58 wave_ror:1 row_mask:0xf bank_mask:0xf
    v_add_f32_dpp v195, v59, v62 wave_ror:1 row_mask:0xf bank_mask:0xf
    v_add_f32_dpp v193, v55, v54 wave_shr:1 row_mask:0xf bank_mask:0xf
    v_add_f32_dpp v194, v59, v58 wave_shr:1 row_mask:0xf bank_mask:0xf
    v_add_f32_dpp v195, v63, v62 wave_shr:1 row_mask:0xf bank_mask:0xf
    v_mfma_f32_32x32x16_bf16 v[96:111], a[204:207], a[32:35], v[96:111]
    v_add_f32_dpp v50, v192, v49 wave_shr:1 row_mask:0xf bank_mask:0xf bound_ctrl:0
    v_add_f32_dpp v54, v192, v53 wave_ror:1 row_mask:0xf bank_mask:0xf
    v_add_f32_dpp v58, v193, v57 wave_ror:1 row_mask:0xf bank_mask:0xf
    v_add_f32_dpp v62, v194, v61 wave_ror:1 row_mask:0xf bank_mask:0xf
    v_add_f32_dpp v54, v193, v53 wave_shr:1 row_mask:0xf bank_mask:0xf
    v_add_f32_dpp v58, v194, v57 wave_shr:1 row_mask:0xf bank_mask:0xf
    v_mfma_f32_32x32x16_bf16 v[96:111], a[212:215], a[40:43], v[96:111]
    v_add_f32_dpp v62, v195, v61 wave_shr:1 row_mask:0xf bank_mask:0xf
    v_add_f32_dpp v49, v50, v48 wave_shr:1 row_mask:0xf bank_mask:0xf bound_ctrl:0
    v_add_f32_dpp v53, v50, v52 wave_ror:1 row_mask:0xf bank_mask:0xf
    v_add_f32_dpp v57, v54, v56 wave_ror:1 row_mask:0xf bank_mask:0xf
    v_add_f32_dpp v61, v58, v60 wave_ror:1 row_mask:0xf bank_mask:0xf
    v_add_f32_dpp v53, v54, v52 wave_shr:1 row_mask:0xf bank_mask:0xf
    v_mfma_f32_32x32x16_bf16 v[96:111], a[220:223], a[48:51], v[96:111]
    v_add_f32_dpp v57, v58, v56 wave_shr:1 row_mask:0xf bank_mask:0xf
    v_add_f32_dpp v61, v62, v60 wave_shr:1 row_mask:0xf bank_mask:0xf
    v_cvt_pk_bf16_f32 v48, v49, v53
    v_cvt_pk_bf16_f32 v56, v57, v61
    ds_write_b16 v10, v48 offset:0
    v_mfma_f32_32x32x16_bf16 v[96:111], a[228:231], a[112:115], v[96:111]
    ds_write_b16_d16_hi v10, v48 offset:512
    ds_write_b16 v10, v56 offset:1024
    ds_write_b16_d16_hi v10, v56 offset:1536
    v_mfma_f32_32x32x16_bf16 v[96:111], a[36:39], a[200:203], v[96:111]
    v_add_f32_dpp v196, v63, v34 wave_ror:1 row_mask:0xf bank_mask:0xf
    v_add_f32_dpp v197, v35, v38 wave_ror:1 row_mask:0xf bank_mask:0xf
    v_add_f32_dpp v198, v39, v42 wave_ror:1 row_mask:0xf bank_mask:0xf
    v_add_f32_dpp v199, v43, v46 wave_ror:1 row_mask:0xf bank_mask:0xf
    v_add_f32_dpp v196, v35, v34 wave_shr:1 row_mask:0xf bank_mask:0xf
    v_add_f32_dpp v197, v39, v38 wave_shr:1 row_mask:0xf bank_mask:0xf
    v_mfma_f32_32x32x16_bf16 v[96:111], a[44:47], a[208:211], v[96:111]
    v_add_f32_dpp v198, v43, v42 wave_shr:1 row_mask:0xf bank_mask:0xf
    v_add_f32_dpp v199, v47, v46 wave_shr:1 row_mask:0xf bank_mask:0xf
    v_add_f32_dpp v34, v195, v33 wave_ror:1 row_mask:0xf bank_mask:0xf
    v_add_f32_dpp v38, v196, v37 wave_ror:1 row_mask:0xf bank_mask:0xf
    v_add_f32_dpp v42, v197, v41 wave_ror:1 row_mask:0xf bank_mask:0xf
    v_add_f32_dpp v46, v198, v45 wave_ror:1 row_mask:0xf bank_mask:0xf
    v_mfma_f32_32x32x16_bf16 v[96:111], a[52:55], a[216:219], v[96:111]
    v_add_f32_dpp v34, v196, v33 wave_shr:1 row_mask:0xf bank_mask:0xf
    v_add_f32_dpp v38, v197, v37 wave_shr:1 row_mask:0xf bank_mask:0xf
    v_add_f32_dpp v42, v198, v41 wave_shr:1 row_mask:0xf bank_mask:0xf
    v_add_f32_dpp v46, v199, v45 wave_shr:1 row_mask:0xf bank_mask:0xf
    v_add_f32_dpp v33, v62, v32 wave_ror:1 row_mask:0xf bank_mask:0xf
    v_add_f32_dpp v37, v34, v36 wave_ror:1 row_mask:0xf bank_mask:0xf
    v_mfma_f32_32x32x16_bf16 v[96:111], a[116:119], a[224:227], v[96:111]
    v_add_f32_dpp v41, v38, v40 wave_ror:1 row_mask:0xf bank_mask:0xf
    v_add_f32_dpp v45, v42, v44 wave_ror:1 row_mask:0xf bank_mask:0xf
    v_add_f32_dpp v33, v34, v32 wave_shr:1 row_mask:0xf bank_mask:0xf
    v_add_f32_dpp v37, v38, v36 wave_shr:1 row_mask:0xf bank_mask:0xf
    v_add_f32_dpp v41, v42, v40 wave_shr:1 row_mask:0xf bank_mask:0xf
    v_add_f32_dpp v45, v46, v44 wave_shr:1 row_mask:0xf bank_mask:0xf
    s_waitcnt lgkmcnt(12)
    v_mfma_f32_32x32x16_bf16 v[96:111], a[236:239], a[0:3], v[96:111]
    v_cvt_pk_bf16_f32 v32, v33, v37
    v_cvt_pk_bf16_f32 v40, v41, v45
    s_waitcnt vmcnt(0)
    s_barrier
    s_cmp_lg_u32 s32, 0
    s_cbranch_scc1 gated_mix__ssm_conv_s4__swiglu_ffn__prompt_kernel_sigh
    s_mul_i32 s98, s36, 4352
    s_lshl_b32 s99, s35, 2
    s_add_u32 s98, s98, s99
    s_add_u32 s98, s98, 22020096
    v_mov_b32 v1, 1
    v_mov_b32 v9, 0
    s_mov_b64 exec, 1
    buffer_store_dword v1, v9, s[28:31], s98 offen sc1
    s_mov_b64 exec, -1
gated_mix__ssm_conv_s4__swiglu_ffn__prompt_kernel_sigh:
    ds_write_b16 v10, v32 offset:2048
    ds_write_b16_d16_hi v10, v32 offset:2560
    s_waitcnt lgkmcnt(10)
    v_mfma_f32_32x32x16_bf16 v[96:111], a[244:247], a[8:11], v[96:111]
    ds_read_b64_tr_b16 a[56:57], v7 offset:2976
    ds_read_b64_tr_b16 a[58:59], v7 offset:2944
    ds_write_b16 v10, v40 offset:3072
    ds_write_b16_d16_hi v10, v40 offset:3584
    s_waitcnt lgkmcnt(10)
    v_mfma_f32_32x32x16_bf16 v[96:111], a[252:255], a[16:19], v[96:111]
    ds_read_b64_tr_b16 a[60:61], v8 offset:2560
    ds_read_b64_tr_b16 a[62:63], v8 offset:2592
    v_add_f32_dpp v200, v47, v82 wave_ror:1 row_mask:0xf bank_mask:0xf
    v_add_f32_dpp v201, v83, v86 wave_ror:1 row_mask:0xf bank_mask:0xf
    v_add_f32_dpp v202, v87, v90 wave_ror:1 row_mask:0xf bank_mask:0xf
    v_add_f32_dpp v203, v91, v94 wave_ror:1 row_mask:0xf bank_mask:0xf
    s_waitcnt lgkmcnt(0)
    v_mfma_f32_32x32x16_bf16 v[96:111], a[60:63], a[24:27], v[96:111]
    ds_read_b64_tr_b16 a[64:65], v7 offset:3104
    ds_read_b64_tr_b16 a[66:67], v7 offset:3072
    ds_read_b64_tr_b16 a[68:69], v8 offset:3456
    ds_read_b64_tr_b16 a[70:71], v8 offset:3488
    ds_read_b64_tr_b16 a[72:73], v7 offset:3232
    ds_read_b64_tr_b16 a[74:75], v7 offset:3200
    v_mfma_f32_32x32x16_bf16 v[96:111], a[4:7], a[232:235], v[96:111]
    ds_read_b64_tr_b16 a[76:77], v8 offset:3328
    ds_read_b64_tr_b16 a[78:79], v8 offset:3360
    ds_read_b64_tr_b16 a[80:81], v7 offset:3360
    ds_read_b64_tr_b16 a[82:83], v7 offset:3328
    ds_read_b64_tr_b16 a[84:85], v8 offset:3200
    ds_read_b64_tr_b16 a[86:87], v8 offset:3232
    v_mfma_f32_32x32x16_bf16 v[96:111], a[12:15], a[240:243], v[96:111]
    v_add_f32_dpp v200, v83, v82 wave_shr:1 row_mask:0xf bank_mask:0xf
    v_add_f32_dpp v201, v87, v86 wave_shr:1 row_mask:0xf bank_mask:0xf
    v_add_f32_dpp v202, v91, v90 wave_shr:1 row_mask:0xf bank_mask:0xf
    v_add_f32_dpp v203, v95, v94 wave_shr:1 row_mask:0xf bank_mask:0xf
    v_add_f32_dpp v82, v199, v81 wave_ror:1 row_mask:0xf bank_mask:0xf
    v_add_f32_dpp v86, v200, v85 wave_ror:1 row_mask:0xf bank_mask:0xf
    v_mfma_f32_32x32x16_bf16 v[96:111], a[20:23], a[248:251], v[96:111]
    v_add_f32_dpp v90, v201, v89 wave_ror:1 row_mask:0xf bank_mask:0xf
    v_add_f32_dpp v94, v202, v93 wave_ror:1 row_mask:0xf bank_mask:0xf
    v_add_f32_dpp v82, v200, v81 wave_shr:1 row_mask:0xf bank_mask:0xf
    v_add_f32_dpp v86, v201, v85 wave_shr:1 row_mask:0xf bank_mask:0xf
    v_add_f32_dpp v90, v202, v89 wave_shr:1 row_mask:0xf bank_mask:0xf
    v_add_f32_dpp v94, v203, v93 wave_shr:1 row_mask:0xf bank_mask:0xf
    v_mfma_f32_32x32x16_bf16 v[96:111], a[28:31], a[56:59], v[96:111]
    v_add_f32_dpp v81, v46, v80 wave_ror:1 row_mask:0xf bank_mask:0xf
    v_add_f32_dpp v85, v82, v84 wave_ror:1 row_mask:0xf bank_mask:0xf
    v_add_f32_dpp v89, v86, v88 wave_ror:1 row_mask:0xf bank_mask:0xf
    v_add_f32_dpp v93, v90, v92 wave_ror:1 row_mask:0xf bank_mask:0xf
    v_add_f32_dpp v81, v82, v80 wave_shr:1 row_mask:0xf bank_mask:0xf
    v_add_f32_dpp v85, v86, v84 wave_shr:1 row_mask:0xf bank_mask:0xf
    v_mfma_f32_32x32x16_bf16 v[144:159], a[156:159], a[152:155], 0
    v_add_f32_dpp v89, v90, v88 wave_shr:1 row_mask:0xf bank_mask:0xf
    v_add_f32_dpp v93, v94, v92 wave_shr:1 row_mask:0xf bank_mask:0xf
    v_cvt_pk_bf16_f32 v80, v81, v85
    v_cvt_pk_bf16_f32 v88, v89, v93
    ds_write_b16 v10, v80 offset:40960
    v_mfma_f32_32x32x16_bf16 v[144:159], a[180:183], a[176:179], v[144:159]
    ds_write_b16_d16_hi v10, v80 offset:41472
    ds_write_b16 v10, v88 offset:41984
    ds_write_b16_d16_hi v10, v88 offset:42496
    v_mfma_f32_32x32x16_bf16 v[144:159], a[188:191], a[184:187], v[144:159]
    v_add_f32_dpp v204, v95, v66 wave_ror:1 row_mask:0xf bank_mask:0xf
    v_add_f32_dpp v205, v67, v70 wave_ror:1 row_mask:0xf bank_mask:0xf
    v_add_f32_dpp v206, v71, v74 wave_ror:1 row_mask:0xf bank_mask:0xf
    v_add_f32_dpp v207, v75, v78 wave_ror:1 row_mask:0xf bank_mask:0xf
    v_add_f32_dpp v204, v67, v66 wave_shr:1 row_mask:0xf bank_mask:0xf
    v_add_f32_dpp v205, v71, v70 wave_shr:1 row_mask:0xf bank_mask:0xf
    v_mfma_f32_32x32x16_bf16 v[144:159], a[196:199], a[192:195], v[144:159]
    v_add_f32_dpp v206, v75, v74 wave_shr:1 row_mask:0xf bank_mask:0xf
    v_add_f32_dpp v207, v79, v78 wave_shr:1 row_mask:0xf bank_mask:0xf
    v_add_f32_dpp v66, v203, v65 wave_ror:1 row_mask:0xf bank_mask:0xf
    v_add_f32_dpp v70, v204, v69 wave_ror:1 row_mask:0xf bank_mask:0xf
    v_add_f32_dpp v74, v205, v73 wave_ror:1 row_mask:0xf bank_mask:0xf
    v_add_f32_dpp v78, v206, v77 wave_ror:1 row_mask:0xf bank_mask:0xf
    v_mfma_f32_32x32x16_bf16 v[144:159], a[204:207], a[120:123], v[144:159]
    v_add_f32_dpp v66, v204, v65 wave_shr:1 row_mask:0xf bank_mask:0xf
    v_add_f32_dpp v70, v205, v69 wave_shr:1 row_mask:0xf bank_mask:0xf
    v_add_f32_dpp v74, v206, v73 wave_shr:1 row_mask:0xf bank_mask:0xf
    v_add_f32_dpp v78, v207, v77 wave_shr:1 row_mask:0xf bank_mask:0xf
    v_add_f32_dpp v65, v94, v64 wave_ror:1 row_mask:0xf bank_mask:0xf
    v_add_f32_dpp v69, v66, v68 wave_ror:1 row_mask:0xf bank_mask:0xf
    v_mfma_f32_32x32x16_bf16 v[144:159], a[212:215], a[128:131], v[144:159]
    v_add_f32_dpp v73, v70, v72 wave_ror:1 row_mask:0xf bank_mask:0xf
    v_add_f32_dpp v77, v74, v76 wave_ror:1 row_mask:0xf bank_mask:0xf
    v_add_f32_dpp v65, v66, v64 wave_shr:1 row_mask:0xf bank_mask:0xf
    v_add_f32_dpp v69, v70, v68 wave_shr:1 row_mask:0xf bank_mask:0xf
    v_add_f32_dpp v73, v74, v72 wave_shr:1 row_mask:0xf bank_mask:0xf
    v_add_f32_dpp v77, v78, v76 wave_shr:1 row_mask:0xf bank_mask:0xf
    v_mfma_f32_32x32x16_bf16 v[144:159], a[220:223], a[136:139], v[144:159]
    v_cvt_pk_bf16_f32 v64, v65, v69
    v_cvt_pk_bf16_f32 v72, v73, v77
    ds_write_b16 v10, v64 offset:43008
    ds_write_b16_d16_hi v10, v64 offset:43520
    v_mfma_f32_32x32x16_bf16 v[144:159], a[228:231], a[144:147], v[144:159]
    ds_write_b16 v10, v72 offset:44032
    ds_write_b16_d16_hi v10, v72 offset:44544
    v_add_f32_dpp v208, v79, v114 wave_ror:1 row_mask:0xf bank_mask:0xf
    v_add_f32_dpp v209, v115, v118 wave_ror:1 row_mask:0xf bank_mask:0xf
    v_mfma_f32_32x32x16_bf16 v[144:159], a[124:127], a[200:203], v[144:159]
    v_add_f32_dpp v210, v119, v122 wave_ror:1 row_mask:0xf bank_mask:0xf
    v_add_f32_dpp v211, v123, v126 wave_ror:1 row_mask:0xf bank_mask:0xf
    v_add_f32_dpp v208, v115, v114 wave_shr:1 row_mask:0xf bank_mask:0xf
    v_add_f32_dpp v209, v119, v118 wave_shr:1 row_mask:0xf bank_mask:0xf
    v_add_f32_dpp v210, v123, v122 wave_shr:1 row_mask:0xf bank_mask:0xf
    v_add_f32_dpp v211, v127, v126 wave_shr:1 row_mask:0xf bank_mask:0xf
    v_mfma_f32_32x32x16_bf16 v[144:159], a[132:135], a[208:211], v[144:159]
    v_add_f32_dpp v114, v207, v113 wave_ror:1 row_mask:0xf bank_mask:0xf
    v_add_f32_dpp v118, v208, v117 wave_ror:1 row_mask:0xf bank_mask:0xf
    v_add_f32_dpp v122, v209, v121 wave_ror:1 row_mask:0xf bank_mask:0xf
    v_add_f32_dpp v126, v210, v125 wave_ror:1 row_mask:0xf bank_mask:0xf
    v_add_f32_dpp v114, v208, v113 wave_shr:1 row_mask:0xf bank_mask:0xf
    v_add_f32_dpp v118, v209, v117 wave_shr:1 row_mask:0xf bank_mask:0xf
    v_mfma_f32_32x32x16_bf16 v[144:159], a[140:143], a[216:219], v[144:159]
    v_add_f32_dpp v122, v210, v121 wave_shr:1 row_mask:0xf bank_mask:0xf
    v_add_f32_dpp v126, v211, v125 wave_shr:1 row_mask:0xf bank_mask:0xf
    v_add_f32_dpp v113, v78, v112 wave_ror:1 row_mask:0xf bank_mask:0xf
    v_add_f32_dpp v117, v114, v116 wave_ror:1 row_mask:0xf bank_mask:0xf
    v_add_f32_dpp v121, v118, v120 wave_ror:1 row_mask:0xf bank_mask:0xf
    v_add_f32_dpp v125, v122, v124 wave_ror:1 row_mask:0xf bank_mask:0xf
    v_mfma_f32_32x32x16_bf16 v[144:159], a[148:151], a[224:227], v[144:159]
    v_add_f32_dpp v113, v114, v112 wave_shr:1 row_mask:0xf bank_mask:0xf
    v_add_f32_dpp v117, v118, v116 wave_shr:1 row_mask:0xf bank_mask:0xf
    v_add_f32_dpp v121, v122, v120 wave_shr:1 row_mask:0xf bank_mask:0xf
    v_add_f32_dpp v125, v126, v124 wave_shr:1 row_mask:0xf bank_mask:0xf
    v_cvt_pk_bf16_f32 v112, v113, v117
    v_cvt_pk_bf16_f32 v120, v121, v125
    v_mfma_f32_32x32x16_bf16 v[144:159], a[236:239], a[32:35], v[144:159]
    ds_write_b16 v11, v112 offset:0
    ds_write_b16_d16_hi v11, v112 offset:512
    ds_write_b16 v11, v120 offset:1024
    v_mfma_f32_32x32x16_bf16 v[144:159], a[244:247], a[40:43], v[144:159]
    ds_write_b16_d16_hi v11, v120 offset:1536
    v_add_f32_dpp v212, v127, v98 wave_ror:1 row_mask:0xf bank_mask:0xf
    v_add_f32_dpp v213, v99, v102 wave_ror:1 row_mask:0xf bank_mask:0xf
    v_add_f32_dpp v214, v103, v106 wave_ror:1 row_mask:0xf bank_mask:0xf
    v_add_f32_dpp v215, v107, v110 wave_ror:1 row_mask:0xf bank_mask:0xf
    v_mfma_f32_32x32x16_bf16 v[144:159], a[252:255], a[48:51], v[144:159]
    v_add_f32_dpp v212, v99, v98 wave_shr:1 row_mask:0xf bank_mask:0xf
    v_add_f32_dpp v213, v103, v102 wave_shr:1 row_mask:0xf bank_mask:0xf
    v_add_f32_dpp v214, v107, v106 wave_shr:1 row_mask:0xf bank_mask:0xf
    v_add_f32_dpp v215, v111, v110 wave_shr:1 row_mask:0xf bank_mask:0xf
    v_add_f32_dpp v98, v211, v97 wave_ror:1 row_mask:0xf bank_mask:0xf
    v_add_f32_dpp v102, v212, v101 wave_ror:1 row_mask:0xf bank_mask:0xf
    v_mfma_f32_32x32x16_bf16 v[144:159], a[60:63], a[112:115], v[144:159]
    v_add_f32_dpp v106, v213, v105 wave_ror:1 row_mask:0xf bank_mask:0xf
    v_add_f32_dpp v110, v214, v109 wave_ror:1 row_mask:0xf bank_mask:0xf
    v_add_f32_dpp v98, v212, v97 wave_shr:1 row_mask:0xf bank_mask:0xf
    v_add_f32_dpp v102, v213, v101 wave_shr:1 row_mask:0xf bank_mask:0xf
    v_add_f32_dpp v106, v214, v105 wave_shr:1 row_mask:0xf bank_mask:0xf
    v_add_f32_dpp v110, v215, v109 wave_shr:1 row_mask:0xf bank_mask:0xf
    v_mfma_f32_32x32x16_bf16 v[144:159], a[36:39], a[232:235], v[144:159]
    v_add_f32_dpp v97, v126, v96 wave_ror:1 row_mask:0xf bank_mask:0xf
    v_add_f32_dpp v101, v98, v100 wave_ror:1 row_mask:0xf bank_mask:0xf
    v_add_f32_dpp v105, v102, v104 wave_ror:1 row_mask:0xf bank_mask:0xf
    v_add_f32_dpp v109, v106, v108 wave_ror:1 row_mask:0xf bank_mask:0xf
    v_add_f32_dpp v97, v98, v96 wave_shr:1 row_mask:0xf bank_mask:0xf
    v_add_f32_dpp v101, v102, v100 wave_shr:1 row_mask:0xf bank_mask:0xf
    v_mfma_f32_32x32x16_bf16 v[144:159], a[44:47], a[240:243], v[144:159]
    v_add_f32_dpp v105, v106, v104 wave_shr:1 row_mask:0xf bank_mask:0xf
    v_add_f32_dpp v109, v110, v108 wave_shr:1 row_mask:0xf bank_mask:0xf
    v_cvt_pk_bf16_f32 v96, v97, v101
    v_cvt_pk_bf16_f32 v104, v105, v109
    ds_write_b16 v11, v96 offset:2048
    v_mfma_f32_32x32x16_bf16 v[144:159], a[52:55], a[248:251], v[144:159]
    ds_write_b16_d16_hi v11, v96 offset:2560
    ds_write_b16 v11, v104 offset:3072
    ds_write_b16_d16_hi v11, v104 offset:3584
    v_mfma_f32_32x32x16_bf16 v[144:159], a[116:119], a[56:59], v[144:159]
    s_waitcnt lgkmcnt(15)
    v_mfma_f32_32x32x16_bf16 v[144:159], a[68:71], a[0:3], v[144:159]
    v_mfma_f32_32x32x16_bf16 v[144:159], a[76:79], a[8:11], v[144:159]
    v_mfma_f32_32x32x16_bf16 v[144:159], a[84:87], a[16:19], v[144:159]
    ds_read_b64_tr_b16 a[88:89], v7 offset:3488
    ds_read_b64_tr_b16 a[90:91], v7 offset:3456
    ds_read_b64_tr_b16 a[92:93], v8 offset:3072
    ds_read_b64_tr_b16 a[94:95], v8 offset:3104
    s_waitcnt lgkmcnt(0)
    v_mfma_f32_32x32x16_bf16 v[144:159], a[92:95], a[24:27], v[144:159]
    ds_read_b64_tr_b16 a[96:97], v7 offset:3616
    ds_read_b64_tr_b16 a[98:99], v7 offset:3584
    ds_read_b64_tr_b16 a[100:101], v8 offset:3968
    ds_read_b64_tr_b16 a[102:103], v8 offset:4000
    ds_read_b64_tr_b16 a[104:105], v7 offset:3744
    ds_read_b64_tr_b16 a[106:107], v7 offset:3712
    v_mfma_f32_32x32x16_bf16 v[144:159], a[4:7], a[64:67], v[144:159]
    ds_read_b64_tr_b16 a[108:109], v8 offset:3840
    ds_read_b64_tr_b16 a[110:111], v8 offset:3872
    ds_read_b64_tr_b16 a[160:161], v7 offset:3872
    ds_read_b64_tr_b16 a[162:163], v7 offset:3840
    ds_read_b64_tr_b16 a[164:165], v8 offset:3712
    ds_read_b64_tr_b16 a[166:167], v8 offset:3744
    v_mfma_f32_32x32x16_bf16 v[144:159], a[12:15], a[72:75], v[144:159]
    v_mfma_f32_32x32x16_bf16 v[144:159], a[20:23], a[80:83], v[144:159]
    v_mfma_f32_32x32x16_bf16 v[144:159], a[28:31], a[88:91], v[144:159]
    v_mfma_f32_32x32x16_bf16 v[128:143], a[204:207], a[152:155], 0
    v_mfma_f32_32x32x16_bf16 v[128:143], a[212:215], a[176:179], v[128:143]
    v_mfma_f32_32x32x16_bf16 v[128:143], a[220:223], a[184:187], v[128:143]
    s_nop 8
    v_add_f32_dpp v216, v111, v146 wave_ror:1 row_mask:0xf bank_mask:0xf
    v_add_f32_dpp v217, v147, v150 wave_ror:1 row_mask:0xf bank_mask:0xf
    v_add_f32_dpp v218, v151, v154 wave_ror:1 row_mask:0xf bank_mask:0xf
    v_add_f32_dpp v219, v155, v158 wave_ror:1 row_mask:0xf bank_mask:0xf
    v_add_f32_dpp v216, v147, v146 wave_shr:1 row_mask:0xf bank_mask:0xf
    v_add_f32_dpp v217, v151, v150 wave_shr:1 row_mask:0xf bank_mask:0xf
    v_mfma_f32_32x32x16_bf16 v[128:143], a[228:231], a[192:195], v[128:143]
    v_add_f32_dpp v218, v155, v154 wave_shr:1 row_mask:0xf bank_mask:0xf
    v_add_f32_dpp v219, v159, v158 wave_shr:1 row_mask:0xf bank_mask:0xf
    v_add_f32_dpp v146, v215, v145 wave_ror:1 row_mask:0xf bank_mask:0xf
    v_add_f32_dpp v150, v216, v149 wave_ror:1 row_mask:0xf bank_mask:0xf
    v_add_f32_dpp v154, v217, v153 wave_ror:1 row_mask:0xf bank_mask:0xf
    v_add_f32_dpp v158, v218, v157 wave_ror:1 row_mask:0xf bank_mask:0xf
    v_mfma_f32_32x32x16_bf16 v[128:143], a[156:159], a[200:203], v[128:143]
    v_add_f32_dpp v146, v216, v145 wave_shr:1 row_mask:0xf bank_mask:0xf
    v_add_f32_dpp v150, v217, v149 wave_shr:1 row_mask:0xf bank_mask:0xf
    v_add_f32_dpp v154, v218, v153 wave_shr:1 row_mask:0xf bank_mask:0xf
    v_add_f32_dpp v158, v219, v157 wave_shr:1 row_mask:0xf bank_mask:0xf
    v_add_f32_dpp v145, v110, v144 wave_ror:1 row_mask:0xf bank_mask:0xf
    v_add_f32_dpp v149, v146, v148 wave_ror:1 row_mask:0xf bank_mask:0xf
    v_mfma_f32_32x32x16_bf16 v[128:143], a[180:183], a[208:211], v[128:143]
    v_add_f32_dpp v153, v150, v152 wave_ror:1 row_mask:0xf bank_mask:0xf
    v_add_f32_dpp v157, v154, v156 wave_ror:1 row_mask:0xf bank_mask:0xf
    v_add_f32_dpp v145, v146, v144 wave_shr:1 row_mask:0xf bank_mask:0xf
    v_add_f32_dpp v149, v150, v148 wave_shr:1 row_mask:0xf bank_mask:0xf
    v_add_f32_dpp v153, v154, v152 wave_shr:1 row_mask:0xf bank_mask:0xf
    v_add_f32_dpp v157, v158, v156 wave_shr:1 row_mask:0xf bank_mask:0xf
    v_mfma_f32_32x32x16_bf16 v[128:143], a[188:191], a[216:219], v[128:143]
    v_cvt_pk_bf16_f32 v144, v145, v149
    v_cvt_pk_bf16_f32 v152, v153, v157
    ds_write_b16 v11, v144 offset:40960
    ds_write_b16_d16_hi v11, v144 offset:41472
    v_mfma_f32_32x32x16_bf16 v[128:143], a[196:199], a[224:227], v[128:143]
    ds_write_b16 v11, v152 offset:41984
    ds_write_b16_d16_hi v11, v152 offset:42496
    v_mfma_f32_32x32x16_bf16 v[128:143], a[236:239], a[120:123], v[128:143]
    v_mfma_f32_32x32x16_bf16 v[128:143], a[244:247], a[128:131], v[128:143]
    v_mfma_f32_32x32x16_bf16 v[128:143], a[252:255], a[136:139], v[128:143]
    v_mfma_f32_32x32x16_bf16 v[128:143], a[60:63], a[144:147], v[128:143]
    v_mfma_f32_32x32x16_bf16 v[128:143], a[124:127], a[232:235], v[128:143]
    v_mfma_f32_32x32x16_bf16 v[128:143], a[132:135], a[240:243], v[128:143]
    s_cmp_eq_u32 s32, 0
    s_cselect_b32 s17, s16, 0x7ff00000
    buffer_load_dword v27, v26, s[28:31], s17 offen sc1
    v_mfma_f32_32x32x16_bf16 v[128:143], a[140:143], a[248:251], v[128:143]
    v_mfma_f32_32x32x16_bf16 v[128:143], a[148:151], a[56:59], v[128:143]
    v_mfma_f32_32x32x16_bf16 v[128:143], a[68:71], a[32:35], v[128:143]
    v_mfma_f32_32x32x16_bf16 v[128:143], a[76:79], a[40:43], v[128:143]
    v_mfma_f32_32x32x16_bf16 v[128:143], a[84:87], a[48:51], v[128:143]
    v_mfma_f32_32x32x16_bf16 v[128:143], a[92:95], a[112:115], v[128:143]
    v_mfma_f32_32x32x16_bf16 v[128:143], a[36:39], a[64:67], v[128:143]
    v_mfma_f32_32x32x16_bf16 v[128:143], a[44:47], a[72:75], v[128:143]
    v_mfma_f32_32x32x16_bf16 v[128:143], a[52:55], a[80:83], v[128:143]
    v_mfma_f32_32x32x16_bf16 v[128:143], a[116:119], a[88:91], v[128:143]
    s_waitcnt lgkmcnt(12)
    v_mfma_f32_32x32x16_bf16 v[128:143], a[100:103], a[0:3], v[128:143]
    s_waitcnt lgkmcnt(8)
    v_mfma_f32_32x32x16_bf16 v[128:143], a[108:111], a[8:11], v[128:143]
    ds_read_b64_tr_b16 a[168:169], v7 offset:4000
    ds_read_b64_tr_b16 a[170:171], v7 offset:3968
    ds_read_b64_tr_b16 a[172:173], v8 offset:3584
    ds_read_b64_tr_b16 a[174:175], v8 offset:3616
    s_waitcnt lgkmcnt(8)
    v_mfma_f32_32x32x16_bf16 v[128:143], a[164:167], a[16:19], v[128:143]
    s_waitcnt lgkmcnt(0)
    v_mfma_f32_32x32x16_bf16 v[128:143], a[172:175], a[24:27], v[128:143]
    v_mfma_f32_32x32x16_bf16 v[128:143], a[4:7], a[96:99], v[128:143]
    v_mfma_f32_32x32x16_bf16 v[128:143], a[12:15], a[104:107], v[128:143]
    v_mfma_f32_32x32x16_bf16 v[128:143], a[20:23], a[160:163], v[128:143]
    v_mfma_f32_32x32x16_bf16 v[128:143], a[28:31], a[168:171], v[128:143]
    s_nop 11
    v_add_f32_dpp v220, v159, v130 wave_ror:1 row_mask:0xf bank_mask:0xf
    v_add_f32_dpp v221, v131, v134 wave_ror:1 row_mask:0xf bank_mask:0xf
    v_add_f32_dpp v222, v135, v138 wave_ror:1 row_mask:0xf bank_mask:0xf
    v_add_f32_dpp v223, v139, v142 wave_ror:1 row_mask:0xf bank_mask:0xf
    v_add_f32_dpp v220, v131, v130 wave_shr:1 row_mask:0xf bank_mask:0xf
    v_add_f32_dpp v221, v135, v134 wave_shr:1 row_mask:0xf bank_mask:0xf
    v_add_f32_dpp v222, v139, v138 wave_shr:1 row_mask:0xf bank_mask:0xf
    v_add_f32_dpp v223, v143, v142 wave_shr:1 row_mask:0xf bank_mask:0xf
    v_add_f32_dpp v130, v219, v129 wave_ror:1 row_mask:0xf bank_mask:0xf
    v_add_f32_dpp v134, v220, v133 wave_ror:1 row_mask:0xf bank_mask:0xf
    v_add_f32_dpp v138, v221, v137 wave_ror:1 row_mask:0xf bank_mask:0xf
    v_add_f32_dpp v142, v222, v141 wave_ror:1 row_mask:0xf bank_mask:0xf
    v_add_f32_dpp v130, v220, v129 wave_shr:1 row_mask:0xf bank_mask:0xf
    v_add_f32_dpp v134, v221, v133 wave_shr:1 row_mask:0xf bank_mask:0xf
    v_add_f32_dpp v138, v222, v137 wave_shr:1 row_mask:0xf bank_mask:0xf
    v_add_f32_dpp v142, v223, v141 wave_shr:1 row_mask:0xf bank_mask:0xf
    v_add_f32_dpp v129, v158, v128 wave_ror:1 row_mask:0xf bank_mask:0xf
    v_add_f32_dpp v133, v130, v132 wave_ror:1 row_mask:0xf bank_mask:0xf
    v_add_f32_dpp v137, v134, v136 wave_ror:1 row_mask:0xf bank_mask:0xf
    v_add_f32_dpp v141, v138, v140 wave_ror:1 row_mask:0xf bank_mask:0xf
    v_add_f32_dpp v129, v130, v128 wave_shr:1 row_mask:0xf bank_mask:0xf
    v_add_f32_dpp v133, v134, v132 wave_shr:1 row_mask:0xf bank_mask:0xf
    v_add_f32_dpp v137, v138, v136 wave_shr:1 row_mask:0xf bank_mask:0xf
    v_add_f32_dpp v141, v142, v140 wave_shr:1 row_mask:0xf bank_mask:0xf
    v_cvt_pk_bf16_f32 v128, v129, v133
    v_cvt_pk_bf16_f32 v136, v137, v141
    ds_write_b16 v11, v128 offset:43008
    ds_write_b16_d16_hi v11, v128 offset:43520
    ds_write_b16 v11, v136 offset:44032
    ds_write_b16_d16_hi v11, v136 offset:44544
    s_cmp_lg_u32 s32, 0
    s_cbranch_scc1 gated_mix__ssm_conv_s4__swiglu_ffn__prompt_kernel_hok
    s_mov_b32 s59, 400000
    s_waitcnt vmcnt(0)
    v_cmp_eq_u32 vcc, 1, v27
    s_nop 1
    s_cmp_eq_u64 vcc, -1
    s_cbranch_scc1 gated_mix__ssm_conv_s4__swiglu_ffn__prompt_kernel_hget
gated_mix__ssm_conv_s4__swiglu_ffn__prompt_kernel_hpoll:
    buffer_load_dword v27, v26, s[28:31], s16 offen sc1
    s_waitcnt vmcnt(0)
    v_cmp_eq_u32 vcc, 1, v27
    s_nop 1
    s_cmp_eq_u64 vcc, -1
    s_cbranch_scc1 gated_mix__ssm_conv_s4__swiglu_ffn__prompt_kernel_hget
    s_sleep 4
    s_sub_u32 s59, s59, 1
    s_cmp_lg_u32 s59, 0
    s_cbranch_scc1 gated_mix__ssm_conv_s4__swiglu_ffn__prompt_kernel_hpoll
gated_mix__ssm_conv_s4__swiglu_ffn__prompt_kernel_hget:
gated_mix__ssm_conv_s4__swiglu_ffn__prompt_kernel_hok:
    s_waitcnt lgkmcnt(0)
    s_barrier
    buffer_load_dwordx4 a[0:3], v12, s[28:31], s37 offen offset:0 sc1
    buffer_load_dwordx4 a[4:7], v12, s[28:31], s37 offen offset:256 sc1
    buffer_load_dwordx4 a[8:11], v13, s[28:31], s37 offen offset:0 sc1
    buffer_load_dwordx4 a[12:15], v13, s[28:31], s37 offen offset:256 sc1
    s_add_u32 s37, s37, 2048
    v_add_u32 v9, s40, v6
    ds_read_b128 v[192:195], v9 offset:24576
    ds_read_b128 v[196:199], v9 offset:25600
    ds_read_b128 v[200:203], v9 offset:26624
    ds_read_b128 v[204:207], v9 offset:27648
    buffer_load_dwordx4 a[16:19], v12, s[28:31], s37 offen offset:0 sc1
    buffer_load_dwordx4 a[20:23], v12, s[28:31], s37 offen offset:256 sc1
    buffer_load_dwordx4 a[24:27], v13, s[28:31], s37 offen offset:0 sc1
    buffer_load_dwordx4 a[28:31], v13, s[28:31], s37 offen offset:256 sc1
    s_add_u32 s37, s37, 2048
    s_lshl_b32 s58, s33, 14
    s_lshl_b32 s59, s32, 12
    s_add_u32 s58, s58, s59
    s_add_u32 s58, s58, 16777216
    buffer_load_dwordx4 a[32:35], v12, s[28:31], s37 offen offset:0 sc1
    buffer_load_dwordx4 a[36:39], v12, s[28:31], s37 offen offset:256 sc1
    buffer_load_dwordx4 a[40:43], v13, s[28:31], s37 offen offset:0 sc1
    buffer_load_dwordx4 a[44:47], v13, s[28:31], s37 offen offset:256 sc1
    s_add_u32 s37, s37, 2048
    s_waitcnt lgkmcnt(0)
    ds_read_b64_tr_b16 a[192:193], v17 offset:0
    ds_read_b64_tr_b16 a[194:195], v17 offset:512
    ds_read_b64_tr_b16 a[196:197], v18 offset:0
    ds_read_b64_tr_b16 a[198:199], v18 offset:512
    ds_read_b64_tr_b16 a[200:201], v19 offset:0
    ds_read_b64_tr_b16 a[202:203], v19 offset:512
    ds_read_b64_tr_b16 a[204:205], v20 offset:0
    ds_read_b64_tr_b16 a[206:207], v20 offset:512
    buffer_load_dwordx4 a[48:51], v12, s[28:31], s37 offen offset:0 sc1
    buffer_load_dwordx4 a[52:55], v12, s[28:31], s37 offen offset:256 sc1
    buffer_load_dwordx4 a[56:59], v13, s[28:31], s37 offen offset:0 sc1
    buffer_load_dwordx4 a[60:63], v13, s[28:31], s37 offen offset:256 sc1
    s_add_u32 s37, s37, 2048
    buffer_store_dwordx4 v[192:195], v6, s[28:31], s58 offen offset:0 sc1
    buffer_store_dwordx4 v[196:199], v6, s[28:31], s58 offen offset:1024 sc1
    buffer_store_dwordx4 v[200:203], v6, s[28:31], s58 offen offset:2048 sc1
    buffer_store_dwordx4 v[204:207], v6, s[28:31], s58 offen offset:3072 sc1
    s_waitcnt vmcnt(16)
    s_waitcnt lgkmcnt(0)
    s_barrier
    v_mfma_f32_16x16x32_bf16 v[96:99], a[192:195], a[8:11], 0
    v_mfma_f32_16x16x32_bf16 v[100:103], a[196:199], a[8:11], 0
    v_mfma_f32_16x16x32_bf16 v[104:107], a[200:203], a[8:11], 0
    v_mfma_f32_16x16x32_bf16 v[108:111], a[204:207], a[8:11], 0
    v_mfma_f32_16x16x32_bf16 v[128:131], a[192:195], a[12:15], 0
    ds_read_b64_tr_b16 a[224:225], v17 offset:4096
    v_mfma_f32_16x16x32_bf16 v[132:135], a[196:199], a[12:15], 0
    ds_read_b64_tr_b16 a[226:227], v17 offset:4608
    v_mfma_f32_16x16x32_bf16 v[136:139], a[200:203], a[12:15], 0
    ds_read_b64_tr_b16 a[228:229], v18 offset:4096
    v_mfma_f32_16x16x32_bf16 v[140:143], a[204:207], a[12:15], 0
    ds_read_b64_tr_b16 a[230:231], v18 offset:4608
    v_mfma_f32_16x16x32_bf16 v[32:35], a[192:195], a[0:3], 0
    ds_read_b64_tr_b16 a[232:233], v19 offset:4096
    v_mfma_f32_16x16x32_bf16 v[36:39], a[196:199], a[0:3], 0
    ds_read_b64_tr_b16 a[234:235], v19 offset:4608
    v_mfma_f32_16x16x32_bf16 v[40:43], a[200:203], a[0:3], 0
    ds_read_b64_tr_b16 a[236:237], v20 offset:4096
    v_mfma_f32_16x16x32_bf16 v[44:47], a[204:207], a[0:3], 0
    ds_read_b64_tr_b16 a[238:239], v20 offset:4608
    v_mfma_f32_16x16x32_bf16 v[64:67], a[192:195], a[4:7], 0
    v_mfma_f32_16x16x32_bf16 v[68:71], a[196:199], a[4:7], 0
    v_mfma_f32_16x16x32_bf16 v[72:75], a[200:203], a[4:7], 0
    v_mfma_f32_16x16x32_bf16 v[76:79], a[204:207], a[4:7], 0
    s_waitcnt vmcnt(12)
    s_waitcnt lgkmcnt(0)
    v_mfma_f32_16x16x32_bf16 v[96:99], a[224:227], a[24:27], v[96:99]
    s_add_u32 m0, s18, 28672
    v_mfma_f32_16x16x32_bf16 v[100:103], a[228:231], a[24:27], v[100:103]
    buffer_load_dwordx4 v2, s[44:47], s38 offen lds
    v_mfma_f32_16x16x32_bf16 v[104:107], a[232:235], a[24:27], v[104:107]
    s_add_u32 m0, s18, 29696
    v_mfma_f32_16x16x32_bf16 v[108:111], a[236:239], a[24:27], v[108:111]
    buffer_load_dwordx4 v3, s[44:47], s38 offen lds
    s_add_u32 s38, s38, 65536
    v_mfma_f32_16x16x32_bf16 v[128:131], a[224:227], a[28:31], v[128:131]
    ds_read_b64_tr_b16 a[192:193], v17 offset:8192
    v_mfma_f32_16x16x32_bf16 v[132:135], a[228:231], a[28:31], v[132:135]
    ds_read_b64_tr_b16 a[194:195], v17 offset:8704
    v_mfma_f32_16x16x32_bf16 v[136:139], a[232:235], a[28:31], v[136:139]
    buffer_load_dwordx4 a[64:67], v12, s[28:31], s37 offen offset:0 sc1
    ds_read_b64_tr_b16 a[196:197], v18 offset:8192
    v_mfma_f32_16x16x32_bf16 v[140:143], a[236:239], a[28:31], v[140:143]
    ds_read_b64_tr_b16 a[198:199], v18 offset:8704
    v_mfma_f32_16x16x32_bf16 v[32:35], a[224:227], a[16:19], v[32:35]
    buffer_load_dwordx4 a[68:71], v12, s[28:31], s37 offen offset:256 sc1
    ds_read_b64_tr_b16 a[200:201], v19 offset:8192
    v_mfma_f32_16x16x32_bf16 v[36:39], a[228:231], a[16:19], v[36:39]
    ds_read_b64_tr_b16 a[202:203], v19 offset:8704
    v_mfma_f32_16x16x32_bf16 v[40:43], a[232:235], a[16:19], v[40:43]
    ds_read_b64_tr_b16 a[204:205], v20 offset:8192
    v_mfma_f32_16x16x32_bf16 v[44:47], a[236:239], a[16:19], v[44:47]
    buffer_load_dwordx4 a[72:75], v13, s[28:31], s37 offen offset:0 sc1
    ds_read_b64_tr_b16 a[206:207], v20 offset:8704
    v_mfma_f32_16x16x32_bf16 v[64:67], a[224:227], a[20:23], v[64:67]
    v_mfma_f32_16x16x32_bf16 v[68:71], a[228:231], a[20:23], v[68:71]
    buffer_load_dwordx4 a[76:79], v13, s[28:31], s37 offen offset:256 sc1
    s_add_u32 s37, s37, 2048
    v_mfma_f32_16x16x32_bf16 v[72:75], a[232:235], a[20:23], v[72:75]
    v_mfma_f32_16x16x32_bf16 v[76:79], a[236:239], a[20:23], v[76:79]
    s_waitcnt vmcnt(14)
    s_waitcnt lgkmcnt(0)
    s_barrier
    v_mfma_f32_16x16x32_bf16 v[96:99], a[192:195], a[40:43], v[96:99]
    s_add_u32 m0, s18, 32768
    v_mfma_f32_16x16x32_bf16 v[100:103], a[196:199], a[40:43], v[100:103]
    buffer_load_dwordx4 v2, s[44:47], s38 offen lds
    v_mfma_f32_16x16x32_bf16 v[104:107], a[200:203], a[40:43], v[104:107]
    s_add_u32 m0, s18, 33792
    v_mfma_f32_16x16x32_bf16 v[108:111], a[204:207], a[40:43], v[108:111]
    buffer_load_dwordx4 v3, s[44:47], s38 offen lds
    s_add_u32 s38, s38, 65536
    v_mfma_f32_16x16x32_bf16 v[128:131], a[192:195], a[44:47], v[128:131]
    ds_read_b64_tr_b16 a[224:225], v17 offset:12288
    v_mfma_f32_16x16x32_bf16 v[132:135], a[196:199], a[44:47], v[132:135]
    ds_read_b64_tr_b16 a[226:227], v17 offset:12800
    v_mfma_f32_16x16x32_bf16 v[136:139], a[200:203], a[44:47], v[136:139]
    buffer_load_dwordx4 a[80:83], v12, s[28:31], s37 offen offset:0 sc1
    ds_read_b64_tr_b16 a[228:229], v18 offset:12288
    v_mfma_f32_16x16x32_bf16 v[140:143], a[204:207], a[44:47], v[140:143]
    ds_read_b64_tr_b16 a[230:231], v18 offset:12800
    v_mfma_f32_16x16x32_bf16 v[32:35], a[192:195], a[32:35], v[32:35]
    buffer_load_dwordx4 a[84:87], v12, s[28:31], s37 offen offset:256 sc1
    ds_read_b64_tr_b16 a[232:233], v19 offset:12288
    v_mfma_f32_16x16x32_bf16 v[36:39], a[196:199], a[32:35], v[36:39]
    ds_read_b64_tr_b16 a[234:235], v19 offset:12800
    v_mfma_f32_16x16x32_bf16 v[40:43], a[200:203], a[32:35], v[40:43]
    ds_read_b64_tr_b16 a[236:237], v20 offset:12288
    v_mfma_f32_16x16x32_bf16 v[44:47], a[204:207], a[32:35], v[44:47]
    buffer_load_dwordx4 a[88:91], v13, s[28:31], s37 offen offset:0 sc1
    ds_read_b64_tr_b16 a[238:239], v20 offset:12800
    v_mfma_f32_16x16x32_bf16 v[64:67], a[192:195], a[36:39], v[64:67]
    v_mfma_f32_16x16x32_bf16 v[68:71], a[196:199], a[36:39], v[68:71]
    buffer_load_dwordx4 a[92:95], v13, s[28:31], s37 offen offset:256 sc1
    s_add_u32 s37, s37, 2048
    v_mfma_f32_16x16x32_bf16 v[72:75], a[200:203], a[36:39], v[72:75]
    v_mfma_f32_16x16x32_bf16 v[76:79], a[204:207], a[36:39], v[76:79]
    s_waitcnt vmcnt(16)
    s_waitcnt lgkmcnt(0)
    v_mfma_f32_16x16x32_bf16 v[96:99], a[224:227], a[56:59], v[96:99]
    s_add_u32 m0, s18, 36864
    ds_read_b64_tr_b16 a[192:193], v17 offset:16384
    v_mfma_f32_16x16x32_bf16 v[100:103], a[228:231], a[56:59], v[100:103]
    buffer_load_dwordx4 v2, s[44:47], s38 offen lds
    ds_read_b64_tr_b16 a[194:195], v17 offset:16896
    v_mfma_f32_16x16x32_bf16 v[104:107], a[232:235], a[56:59], v[104:107]
    s_add_u32 m0, s18, 37888
    ds_read_b64_tr_b16 a[196:197], v18 offset:16384
    v_mfma_f32_16x16x32_bf16 v[108:111], a[236:239], a[56:59], v[108:111]
    buffer_load_dwordx4 v3, s[44:47], s38 offen lds
    s_add_u32 s38, s38, 65536
    ds_read_b64_tr_b16 a[198:199], v18 offset:16896
    v_mfma_f32_16x16x32_bf16 v[128:131], a[224:227], a[60:63], v[128:131]
    ds_read_b64_tr_b16 a[200:201], v19 offset:16384
    v_mfma_f32_16x16x32_bf16 v[132:135], a[228:231], a[60:63], v[132:135]
    ds_read_b64_tr_b16 a[202:203], v19 offset:16896
    v_mfma_f32_16x16x32_bf16 v[136:139], a[232:235], a[60:63], v[136:139]
    buffer_load_dwordx4 a[96:99], v12, s[28:31], s37 offen offset:0 sc1
    ds_read_b64_tr_b16 a[204:205], v20 offset:16384
    v_mfma_f32_16x16x32_bf16 v[140:143], a[236:239], a[60:63], v[140:143]
    ds_read_b64_tr_b16 a[206:207], v20 offset:16896
    v_mfma_f32_16x16x32_bf16 v[32:35], a[224:227], a[48:51], v[32:35]
    buffer_load_dwordx4 a[100:103], v12, s[28:31], s37 offen offset:256 sc1
    ds_read_b64_tr_b16 a[208:209], v14 offset:0
    v_mfma_f32_16x16x32_bf16 v[36:39], a[228:231], a[48:51], v[36:39]
    ds_read_b64_tr_b16 a[210:211], v14 offset:512
    v_mfma_f32_16x16x32_bf16 v[40:43], a[232:235], a[48:51], v[40:43]
    ds_read_b64_tr_b16 a[212:213], v15 offset:0
    v_mfma_f32_16x16x32_bf16 v[44:47], a[236:239], a[48:51], v[44:47]
    buffer_load_dwordx4 a[104:107], v13, s[28:31], s37 offen offset:0 sc1
    ds_read_b64_tr_b16 a[214:215], v15 offset:512
    v_mfma_f32_16x16x32_bf16 v[64:67], a[224:227], a[52:55], v[64:67]
    ds_read_b64_tr_b16 a[216:217], v16 offset:0
    v_mfma_f32_16x16x32_bf16 v[68:71], a[228:231], a[52:55], v[68:71]
    buffer_load_dwordx4 a[108:111], v13, s[28:31], s37 offen offset:256 sc1
    s_add_u32 s37, s37, 2048
    ds_read_b64_tr_b16 a[218:219], v16 offset:512
    v_mfma_f32_16x16x32_bf16 v[72:75], a[232:235], a[52:55], v[72:75]
    ds_read_b64_tr_b16 a[220:221], v29 offset:0
    v_mfma_f32_16x16x32_bf16 v[76:79], a[236:239], a[52:55], v[76:79]
    ds_read_b64_tr_b16 a[222:223], v29 offset:512
    s_waitcnt vmcnt(12)
    s_waitcnt lgkmcnt(0)
    s_barrier
    s_cmp_lg_u32 s32, 0
    s_cbranch_scc1 gated_mix__ssm_conv_s4__swiglu_ffn__prompt_kernel_siga
    s_lshr_b32 s98, s33, 4
    s_mul_i32 s98, s98, 4352
    s_and_b32 s99, s33, 15
    s_lshl_b32 s99, s99, 2
    s_add_u32 s98, s98, s99
    s_add_u32 s98, s98, 22054912
    v_mov_b32 v1, 1
    v_mov_b32 v9, 0
    s_mov_b64 exec, 1
    buffer_store_dword v1, v9, s[28:31], s98 offen sc1
    s_mov_b64 exec, -1
gated_mix__ssm_conv_s4__swiglu_ffn__prompt_kernel_siga:
    v_mfma_f32_16x16x32_bf16 v[96:99], a[192:195], a[72:75], v[96:99]
    s_add_u32 m0, s18, 24576
    v_mfma_f32_16x16x32_bf16 v[100:103], a[196:199], a[72:75], v[100:103]
    buffer_load_dwordx4 v2, s[44:47], s38 offen lds
    v_mfma_f32_16x16x32_bf16 v[104:107], a[200:203], a[72:75], v[104:107]
    v_mfma_f32_16x16x32_bf16 v[108:111], a[204:207], a[72:75], v[108:111]
    v_mfma_f32_16x16x32_bf16 v[128:131], a[192:195], a[76:79], v[128:131]
    v_mfma_f32_16x16x32_bf16 v[132:135], a[196:199], a[76:79], v[132:135]
    s_add_u32 m0, s18, 25600
    v_mfma_f32_16x16x32_bf16 v[136:139], a[200:203], a[76:79], v[136:139]
    buffer_load_dwordx4 v3, s[44:47], s38 offen lds
    s_add_u32 s38, s38, 65536
    v_mfma_f32_16x16x32_bf16 v[140:143], a[204:207], a[76:79], v[140:143]
    v_mfma_f32_16x16x32_bf16 v[32:35], a[192:195], a[64:67], v[32:35]
    v_mfma_f32_16x16x32_bf16 v[36:39], a[196:199], a[64:67], v[36:39]
    v_mfma_f32_16x16x32_bf16 v[40:43], a[200:203], a[64:67], v[40:43]
    v_mfma_f32_16x16x32_bf16 v[44:47], a[204:207], a[64:67], v[44:47]
    buffer_load_dwordx4 a[112:115], v12, s[28:31], s37 offen offset:0 sc1
    v_mfma_f32_16x16x32_bf16 v[64:67], a[192:195], a[68:71], v[64:67]
    ds_read_b64_tr_b16 a[224:225], v17 offset:20480
    v_mfma_f32_16x16x32_bf16 v[68:71], a[196:199], a[68:71], v[68:71]
    ds_read_b64_tr_b16 a[226:227], v17 offset:20992
    v_mfma_f32_16x16x32_bf16 v[72:75], a[200:203], a[68:71], v[72:75]
    ds_read_b64_tr_b16 a[228:229], v18 offset:20480
    v_mfma_f32_16x16x32_bf16 v[76:79], a[204:207], a[68:71], v[76:79]
    ds_read_b64_tr_b16 a[230:231], v18 offset:20992
    v_mfma_f32_16x16x32_bf16 v[112:115], a[208:211], a[8:11], 0
    buffer_load_dwordx4 a[116:119], v12, s[28:31], s37 offen offset:256 sc1
    ds_read_b64_tr_b16 a[232:233], v19 offset:20480
    v_mfma_f32_16x16x32_bf16 v[116:119], a[212:215], a[8:11], 0
    ds_read_b64_tr_b16 a[234:235], v19 offset:20992
    v_mfma_f32_16x16x32_bf16 v[120:123], a[216:219], a[8:11], 0
    ds_read_b64_tr_b16 a[236:237], v20 offset:20480
    v_mfma_f32_16x16x32_bf16 v[124:127], a[220:223], a[8:11], 0
    ds_read_b64_tr_b16 a[238:239], v20 offset:20992
    v_mfma_f32_16x16x32_bf16 v[144:147], a[208:211], a[12:15], 0
    ds_read_b64_tr_b16 a[240:241], v14 offset:4096
    v_mfma_f32_16x16x32_bf16 v[148:151], a[212:215], a[12:15], 0
    buffer_load_dwordx4 a[120:123], v13, s[28:31], s37 offen offset:0 sc1
    ds_read_b64_tr_b16 a[242:243], v14 offset:4608
    v_mfma_f32_16x16x32_bf16 v[152:155], a[216:219], a[12:15], 0
    ds_read_b64_tr_b16 a[244:245], v15 offset:4096
    v_mfma_f32_16x16x32_bf16 v[156:159], a[220:223], a[12:15], 0
    ds_read_b64_tr_b16 a[246:247], v15 offset:4608
    v_mfma_f32_16x16x32_bf16 v[48:51], a[208:211], a[0:3], 0
    ds_read_b64_tr_b16 a[248:249], v16 offset:4096
    v_mfma_f32_16x16x32_bf16 v[52:55], a[212:215], a[0:3], 0
    ds_read_b64_tr_b16 a[250:251], v16 offset:4608
    v_mfma_f32_16x16x32_bf16 v[56:59], a[216:219], a[0:3], 0
    buffer_load_dwordx4 a[124:127], v13, s[28:31], s37 offen offset:256 sc1
    s_add_u32 s37, s37, 2048
    ds_read_b64_tr_b16 a[252:253], v29 offset:4096
    v_mfma_f32_16x16x32_bf16 v[60:63], a[220:223], a[0:3], 0
    ds_read_b64_tr_b16 a[254:255], v29 offset:4608
    v_mfma_f32_16x16x32_bf16 v[80:83], a[208:211], a[4:7], 0
    v_mfma_f32_16x16x32_bf16 v[84:87], a[212:215], a[4:7], 0
    v_mfma_f32_16x16x32_bf16 v[88:91], a[216:219], a[4:7], 0
    v_mfma_f32_16x16x32_bf16 v[92:95], a[220:223], a[4:7], 0
    s_waitcnt vmcnt(12)
    s_waitcnt lgkmcnt(0)
    v_mfma_f32_16x16x32_bf16 v[96:99], a[224:227], a[88:91], v[96:99]
    s_add_u32 m0, s18, 0
    v_mfma_f32_16x16x32_bf16 v[100:103], a[228:231], a[88:91], v[100:103]
    buffer_load_dwordx4 v2, s[44:47], s38 offen lds
    v_mfma_f32_16x16x32_bf16 v[104:107], a[232:235], a[88:91], v[104:107]
    v_mfma_f32_16x16x32_bf16 v[108:111], a[236:239], a[88:91], v[108:111]
    s_add_u32 m0, s18, 1024
    v_mfma_f32_16x16x32_bf16 v[128:131], a[224:227], a[92:95], v[128:131]
    buffer_load_dwordx4 v3, s[44:47], s38 offen lds
    s_add_u32 s38, s38, 65536
    v_mfma_f32_16x16x32_bf16 v[132:135], a[228:231], a[92:95], v[132:135]
    v_mfma_f32_16x16x32_bf16 v[136:139], a[232:235], a[92:95], v[136:139]
    v_mfma_f32_16x16x32_bf16 v[140:143], a[236:239], a[92:95], v[140:143]
    s_add_u32 m0, s19, 28672
    v_mfma_f32_16x16x32_bf16 v[32:35], a[224:227], a[80:83], v[32:35]
    buffer_load_dwordx4 v2, s[44:47], s39 offen lds
    v_mfma_f32_16x16x32_bf16 v[36:39], a[228:231], a[80:83], v[36:39]
    v_mfma_f32_16x16x32_bf16 v[40:43], a[232:235], a[80:83], v[40:43]
    v_mfma_f32_16x16x32_bf16 v[44:47], a[236:239], a[80:83], v[44:47]
    s_add_u32 m0, s19, 29696
    v_mfma_f32_16x16x32_bf16 v[64:67], a[224:227], a[84:87], v[64:67]
    buffer_load_dwordx4 v3, s[44:47], s39 offen lds
    s_add_u32 s39, s39, 65536
    ds_read_b64_tr_b16 a[192:193], v17 offset:28672
    v_mfma_f32_16x16x32_bf16 v[68:71], a[228:231], a[84:87], v[68:71]
    ds_read_b64_tr_b16 a[194:195], v17 offset:29184
    v_mfma_f32_16x16x32_bf16 v[72:75], a[232:235], a[84:87], v[72:75]
    ds_read_b64_tr_b16 a[196:197], v18 offset:28672
    v_mfma_f32_16x16x32_bf16 v[76:79], a[236:239], a[84:87], v[76:79]
    ds_read_b64_tr_b16 a[198:199], v18 offset:29184
    v_mfma_f32_16x16x32_bf16 v[112:115], a[240:243], a[24:27], v[112:115]
    buffer_load_dwordx4 a[128:131], v12, s[28:31], s37 offen offset:0 sc1
    ds_read_b64_tr_b16 a[200:201], v19 offset:28672
    v_mfma_f32_16x16x32_bf16 v[116:119], a[244:247], a[24:27], v[116:119]
    ds_read_b64_tr_b16 a[202:203], v19 offset:29184
    v_mfma_f32_16x16x32_bf16 v[120:123], a[248:251], a[24:27], v[120:123]
    ds_read_b64_tr_b16 a[204:205], v20 offset:28672
    v_mfma_f32_16x16x32_bf16 v[124:127], a[252:255], a[24:27], v[124:127]
    ds_read_b64_tr_b16 a[206:207], v20 offset:29184
    v_mfma_f32_16x16x32_bf16 v[144:147], a[240:243], a[28:31], v[144:147]
    buffer_load_dwordx4 a[132:135], v12, s[28:31], s37 offen offset:256 sc1
    ds_read_b64_tr_b16 a[208:209], v14 offset:8192
    v_mfma_f32_16x16x32_bf16 v[148:151], a[244:247], a[28:31], v[148:151]
    ds_read_b64_tr_b16 a[210:211], v14 offset:8704
    v_mfma_f32_16x16x32_bf16 v[152:155], a[248:251], a[28:31], v[152:155]
    ds_read_b64_tr_b16 a[212:213], v15 offset:8192
    v_mfma_f32_16x16x32_bf16 v[156:159], a[252:255], a[28:31], v[156:159]
    ds_read_b64_tr_b16 a[214:215], v15 offset:8704
    v_mfma_f32_16x16x32_bf16 v[48:51], a[240:243], a[16:19], v[48:51]
    buffer_load_dwordx4 a[136:139], v13, s[28:31], s37 offen offset:0 sc1
    ds_read_b64_tr_b16 a[216:217], v16 offset:8192
    v_mfma_f32_16x16x32_bf16 v[52:55], a[244:247], a[16:19], v[52:55]
    ds_read_b64_tr_b16 a[218:219], v16 offset:8704
    v_mfma_f32_16x16x32_bf16 v[56:59], a[248:251], a[16:19], v[56:59]
    ds_read_b64_tr_b16 a[220:221], v29 offset:8192
    v_mfma_f32_16x16x32_bf16 v[60:63], a[252:255], a[16:19], v[60:63]
    ds_read_b64_tr_b16 a[222:223], v29 offset:8704
    v_mfma_f32_16x16x32_bf16 v[80:83], a[240:243], a[20:23], v[80:83]
    buffer_load_dwordx4 a[140:143], v13, s[28:31], s37 offen offset:256 sc1
    s_add_u32 s37, s37, 2048
    v_mfma_f32_16x16x32_bf16 v[84:87], a[244:247], a[20:23], v[84:87]
    v_mfma_f32_16x16x32_bf16 v[88:91], a[248:251], a[20:23], v[88:91]
    v_mfma_f32_16x16x32_bf16 v[92:95], a[252:255], a[20:23], v[92:95]
    s_waitcnt vmcnt(14)
    s_waitcnt lgkmcnt(0)
    s_barrier
    v_mfma_f32_16x16x32_bf16 v[96:99], a[192:195], a[104:107], v[96:99]
    s_add_u32 m0, s18, 4096
    v_mfma_f32_16x16x32_bf16 v[100:103], a[196:199], a[104:107], v[100:103]
    buffer_load_dwordx4 v2, s[44:47], s38 offen lds
    v_mfma_f32_16x16x32_bf16 v[104:107], a[200:203], a[104:107], v[104:107]
    v_mfma_f32_16x16x32_bf16 v[108:111], a[204:207], a[104:107], v[108:111]
    s_add_u32 m0, s18, 5120
    v_mfma_f32_16x16x32_bf16 v[128:131], a[192:195], a[108:111], v[128:131]
    buffer_load_dwordx4 v3, s[44:47], s38 offen lds
    s_add_u32 s38, s38, 65536
    v_mfma_f32_16x16x32_bf16 v[132:135], a[196:199], a[108:111], v[132:135]
    v_mfma_f32_16x16x32_bf16 v[136:139], a[200:203], a[108:111], v[136:139]
    v_mfma_f32_16x16x32_bf16 v[140:143], a[204:207], a[108:111], v[140:143]
    s_add_u32 m0, s19, 32768
    v_mfma_f32_16x16x32_bf16 v[32:35], a[192:195], a[96:99], v[32:35]
    buffer_load_dwordx4 v2, s[44:47], s39 offen lds
    v_mfma_f32_16x16x32_bf16 v[36:39], a[196:199], a[96:99], v[36:39]
    v_mfma_f32_16x16x32_bf16 v[40:43], a[200:203], a[96:99], v[40:43]
    v_mfma_f32_16x16x32_bf16 v[44:47], a[204:207], a[96:99], v[44:47]
    s_add_u32 m0, s19, 33792
    v_mfma_f32_16x16x32_bf16 v[64:67], a[192:195], a[100:103], v[64:67]
    buffer_load_dwordx4 v3, s[44:47], s39 offen lds
    s_add_u32 s39, s39, 65536
    ds_read_b64_tr_b16 a[224:225], v17 offset:32768
    v_mfma_f32_16x16x32_bf16 v[68:71], a[196:199], a[100:103], v[68:71]
    ds_read_b64_tr_b16 a[226:227], v17 offset:33280
    v_mfma_f32_16x16x32_bf16 v[72:75], a[200:203], a[100:103], v[72:75]
    ds_read_b64_tr_b16 a[228:229], v18 offset:32768
    v_mfma_f32_16x16x32_bf16 v[76:79], a[204:207], a[100:103], v[76:79]
    ds_read_b64_tr_b16 a[230:231], v18 offset:33280
    v_mfma_f32_16x16x32_bf16 v[112:115], a[208:211], a[40:43], v[112:115]
    buffer_load_dwordx4 a[144:147], v12, s[28:31], s37 offen offset:0 sc1
    ds_read_b64_tr_b16 a[232:233], v19 offset:32768
    v_mfma_f32_16x16x32_bf16 v[116:119], a[212:215], a[40:43], v[116:119]
    ds_read_b64_tr_b16 a[234:235], v19 offset:33280
    v_mfma_f32_16x16x32_bf16 v[120:123], a[216:219], a[40:43], v[120:123]
    ds_read_b64_tr_b16 a[236:237], v20 offset:32768
    v_mfma_f32_16x16x32_bf16 v[124:127], a[220:223], a[40:43], v[124:127]
    ds_read_b64_tr_b16 a[238:239], v20 offset:33280
    v_mfma_f32_16x16x32_bf16 v[144:147], a[208:211], a[44:47], v[144:147]
    buffer_load_dwordx4 a[148:151], v12, s[28:31], s37 offen offset:256 sc1
    ds_read_b64_tr_b16 a[240:241], v14 offset:12288
    v_mfma_f32_16x16x32_bf16 v[148:151], a[212:215], a[44:47], v[148:151]
    ds_read_b64_tr_b16 a[242:243], v14 offset:12800
    v_mfma_f32_16x16x32_bf16 v[152:155], a[216:219], a[44:47], v[152:155]
    ds_read_b64_tr_b16 a[244:245], v15 offset:12288
    v_mfma_f32_16x16x32_bf16 v[156:159], a[220:223], a[44:47], v[156:159]
    ds_read_b64_tr_b16 a[246:247], v15 offset:12800
    v_mfma_f32_16x16x32_bf16 v[48:51], a[208:211], a[32:35], v[48:51]
    buffer_load_dwordx4 a[152:155], v13, s[28:31], s37 offen offset:0 sc1
    ds_read_b64_tr_b16 a[248:249], v16 offset:12288
    v_mfma_f32_16x16x32_bf16 v[52:55], a[212:215], a[32:35], v[52:55]
    ds_read_b64_tr_b16 a[250:251], v16 offset:12800
    v_mfma_f32_16x16x32_bf16 v[56:59], a[216:219], a[32:35], v[56:59]
    ds_read_b64_tr_b16 a[252:253], v29 offset:12288
    v_mfma_f32_16x16x32_bf16 v[60:63], a[220:223], a[32:35], v[60:63]
    ds_read_b64_tr_b16 a[254:255], v29 offset:12800
    v_mfma_f32_16x16x32_bf16 v[80:83], a[208:211], a[36:39], v[80:83]
    buffer_load_dwordx4 a[156:159], v13, s[28:31], s37 offen offset:256 sc1
    s_add_u32 s37, s37, 2048
    v_mfma_f32_16x16x32_bf16 v[84:87], a[212:215], a[36:39], v[84:87]
    v_mfma_f32_16x16x32_bf16 v[88:91], a[216:219], a[36:39], v[88:91]
    v_mfma_f32_16x16x32_bf16 v[92:95], a[220:223], a[36:39], v[92:95]
    s_waitcnt vmcnt(16)
    s_waitcnt lgkmcnt(0)
    v_mfma_f32_16x16x32_bf16 v[96:99], a[224:227], a[120:123], v[96:99]
    s_add_u32 m0, s18, 8192
    v_mfma_f32_16x16x32_bf16 v[100:103], a[228:231], a[120:123], v[100:103]
    buffer_load_dwordx4 v2, s[44:47], s38 offen lds
    v_mfma_f32_16x16x32_bf16 v[104:107], a[232:235], a[120:123], v[104:107]
    v_mfma_f32_16x16x32_bf16 v[108:111], a[236:239], a[120:123], v[108:111]
    s_add_u32 m0, s18, 9216
    v_mfma_f32_16x16x32_bf16 v[128:131], a[224:227], a[124:127], v[128:131]
    buffer_load_dwordx4 v3, s[44:47], s38 offen lds
    s_add_u32 s38, s38, 65536
    v_mfma_f32_16x16x32_bf16 v[132:135], a[228:231], a[124:127], v[132:135]
    v_mfma_f32_16x16x32_bf16 v[136:139], a[232:235], a[124:127], v[136:139]
    v_mfma_f32_16x16x32_bf16 v[140:143], a[236:239], a[124:127], v[140:143]
    s_add_u32 m0, s19, 36864
    v_mfma_f32_16x16x32_bf16 v[32:35], a[224:227], a[112:115], v[32:35]
    buffer_load_dwordx4 v2, s[44:47], s39 offen lds
    v_mfma_f32_16x16x32_bf16 v[36:39], a[228:231], a[112:115], v[36:39]
    v_mfma_f32_16x16x32_bf16 v[40:43], a[232:235], a[112:115], v[40:43]
    v_mfma_f32_16x16x32_bf16 v[44:47], a[236:239], a[112:115], v[44:47]
    s_add_u32 m0, s19, 37888
    v_mfma_f32_16x16x32_bf16 v[64:67], a[224:227], a[116:119], v[64:67]
    buffer_load_dwordx4 v3, s[44:47], s39 offen lds
    s_add_u32 s39, s39, 65536
    ds_read_b64_tr_b16 a[192:193], v17 offset:36864
    v_mfma_f32_16x16x32_bf16 v[68:71], a[228:231], a[116:119], v[68:71]
    ds_read_b64_tr_b16 a[194:195], v17 offset:37376
    v_mfma_f32_16x16x32_bf16 v[72:75], a[232:235], a[116:119], v[72:75]
    ds_read_b64_tr_b16 a[196:197], v18 offset:36864
    v_mfma_f32_16x16x32_bf16 v[76:79], a[236:239], a[116:119], v[76:79]
    ds_read_b64_tr_b16 a[198:199], v18 offset:37376
    v_mfma_f32_16x16x32_bf16 v[112:115], a[240:243], a[56:59], v[112:115]
    buffer_load_dwordx4 a[160:163], v12, s[28:31], s37 offen offset:0 sc1
    ds_read_b64_tr_b16 a[200:201], v19 offset:36864
    v_mfma_f32_16x16x32_bf16 v[116:119], a[244:247], a[56:59], v[116:119]
    ds_read_b64_tr_b16 a[202:203], v19 offset:37376
    v_mfma_f32_16x16x32_bf16 v[120:123], a[248:251], a[56:59], v[120:123]
    ds_read_b64_tr_b16 a[204:205], v20 offset:36864
    v_mfma_f32_16x16x32_bf16 v[124:127], a[252:255], a[56:59], v[124:127]
    ds_read_b64_tr_b16 a[206:207], v20 offset:37376
    v_mfma_f32_16x16x32_bf16 v[144:147], a[240:243], a[60:63], v[144:147]
    buffer_load_dwordx4 a[164:167], v12, s[28:31], s37 offen offset:256 sc1
    ds_read_b64_tr_b16 a[208:209], v14 offset:16384
    v_mfma_f32_16x16x32_bf16 v[148:151], a[244:247], a[60:63], v[148:151]
    ds_read_b64_tr_b16 a[210:211], v14 offset:16896
    v_mfma_f32_16x16x32_bf16 v[152:155], a[248:251], a[60:63], v[152:155]
    ds_read_b64_tr_b16 a[212:213], v15 offset:16384
    v_mfma_f32_16x16x32_bf16 v[156:159], a[252:255], a[60:63], v[156:159]
    ds_read_b64_tr_b16 a[214:215], v15 offset:16896
    v_mfma_f32_16x16x32_bf16 v[48:51], a[240:243], a[48:51], v[48:51]
    buffer_load_dwordx4 a[168:171], v13, s[28:31], s37 offen offset:0 sc1
    ds_read_b64_tr_b16 a[216:217], v16 offset:16384
    v_mfma_f32_16x16x32_bf16 v[52:55], a[244:247], a[48:51], v[52:55]
    ds_read_b64_tr_b16 a[218:219], v16 offset:16896
    v_mfma_f32_16x16x32_bf16 v[56:59], a[248:251], a[48:51], v[56:59]
    ds_read_b64_tr_b16 a[220:221], v29 offset:16384
    v_mfma_f32_16x16x32_bf16 v[60:63], a[252:255], a[48:51], v[60:63]
    ds_read_b64_tr_b16 a[222:223], v29 offset:16896
    v_mfma_f32_16x16x32_bf16 v[80:83], a[240:243], a[52:55], v[80:83]
    buffer_load_dwordx4 a[172:175], v13, s[28:31], s37 offen offset:256 sc1
    s_add_u32 s37, s37, 2048
    v_mfma_f32_16x16x32_bf16 v[84:87], a[244:247], a[52:55], v[84:87]
    v_mfma_f32_16x16x32_bf16 v[88:91], a[248:251], a[52:55], v[88:91]
    v_mfma_f32_16x16x32_bf16 v[92:95], a[252:255], a[52:55], v[92:95]
    s_waitcnt vmcnt(16)
    s_waitcnt lgkmcnt(0)
    s_barrier
    v_mfma_f32_16x16x32_bf16 v[96:99], a[192:195], a[136:139], v[96:99]
    s_add_u32 m0, s18, 12288
    v_mfma_f32_16x16x32_bf16 v[100:103], a[196:199], a[136:139], v[100:103]
    buffer_load_dwordx4 v2, s[44:47], s38 offen lds
    v_mfma_f32_16x16x32_bf16 v[104:107], a[200:203], a[136:139], v[104:107]
    v_mfma_f32_16x16x32_bf16 v[108:111], a[204:207], a[136:139], v[108:111]
    s_add_u32 m0, s18, 13312
    v_mfma_f32_16x16x32_bf16 v[128:131], a[192:195], a[140:143], v[128:131]
    buffer_load_dwordx4 v3, s[44:47], s38 offen lds
    s_add_u32 s38, s38, 65536
    v_mfma_f32_16x16x32_bf16 v[132:135], a[196:199], a[140:143], v[132:135]
    v_mfma_f32_16x16x32_bf16 v[136:139], a[200:203], a[140:143], v[136:139]
    v_mfma_f32_16x16x32_bf16 v[140:143], a[204:207], a[140:143], v[140:143]
    s_add_u32 m0, s19, 24576
    v_mfma_f32_16x16x32_bf16 v[32:35], a[192:195], a[128:131], v[32:35]
    buffer_load_dwordx4 v2, s[44:47], s39 offen lds
    v_mfma_f32_16x16x32_bf16 v[36:39], a[196:199], a[128:131], v[36:39]
    v_mfma_f32_16x16x32_bf16 v[40:43], a[200:203], a[128:131], v[40:43]
    v_mfma_f32_16x16x32_bf16 v[44:47], a[204:207], a[128:131], v[44:47]
    s_add_u32 m0, s19, 25600
    v_mfma_f32_16x16x32_bf16 v[64:67], a[192:195], a[132:135], v[64:67]
    buffer_load_dwordx4 v3, s[44:47], s39 offen lds
    s_add_u32 s39, s39, 65536
    ds_read_b64_tr_b16 a[224:225], v17 offset:24576
    v_mfma_f32_16x16x32_bf16 v[68:71], a[196:199], a[132:135], v[68:71]
    ds_read_b64_tr_b16 a[226:227], v17 offset:25088
    v_mfma_f32_16x16x32_bf16 v[72:75], a[200:203], a[132:135], v[72:75]
    ds_read_b64_tr_b16 a[228:229], v18 offset:24576
    v_mfma_f32_16x16x32_bf16 v[76:79], a[204:207], a[132:135], v[76:79]
    ds_read_b64_tr_b16 a[230:231], v18 offset:25088
    v_mfma_f32_16x16x32_bf16 v[112:115], a[208:211], a[72:75], v[112:115]
    buffer_load_dwordx4 a[176:179], v12, s[28:31], s37 offen offset:0 sc1
    ds_read_b64_tr_b16 a[232:233], v19 offset:24576
    v_mfma_f32_16x16x32_bf16 v[116:119], a[212:215], a[72:75], v[116:119]
    ds_read_b64_tr_b16 a[234:235], v19 offset:25088
    v_mfma_f32_16x16x32_bf16 v[120:123], a[216:219], a[72:75], v[120:123]
    ds_read_b64_tr_b16 a[236:237], v20 offset:24576
    v_mfma_f32_16x16x32_bf16 v[124:127], a[220:223], a[72:75], v[124:127]
    ds_read_b64_tr_b16 a[238:239], v20 offset:25088
    v_mfma_f32_16x16x32_bf16 v[144:147], a[208:211], a[76:79], v[144:147]
    buffer_load_dwordx4 a[180:183], v12, s[28:31], s37 offen offset:256 sc1
    ds_read_b64_tr_b16 a[240:241], v14 offset:20480
    v_mfma_f32_16x16x32_bf16 v[148:151], a[212:215], a[76:79], v[148:151]
    ds_read_b64_tr_b16 a[242:243], v14 offset:20992
    v_mfma_f32_16x16x32_bf16 v[152:155], a[216:219], a[76:79], v[152:155]
    ds_read_b64_tr_b16 a[244:245], v15 offset:20480
    v_mfma_f32_16x16x32_bf16 v[156:159], a[220:223], a[76:79], v[156:159]
    ds_read_b64_tr_b16 a[246:247], v15 offset:20992
    v_mfma_f32_16x16x32_bf16 v[48:51], a[208:211], a[64:67], v[48:51]
    buffer_load_dwordx4 a[184:187], v13, s[28:31], s37 offen offset:0 sc1
    ds_read_b64_tr_b16 a[248:249], v16 offset:20480
    v_mfma_f32_16x16x32_bf16 v[52:55], a[212:215], a[64:67], v[52:55]
    ds_read_b64_tr_b16 a[250:251], v16 offset:20992
    v_mfma_f32_16x16x32_bf16 v[56:59], a[216:219], a[64:67], v[56:59]
    ds_read_b64_tr_b16 a[252:253], v29 offset:20480
    v_mfma_f32_16x16x32_bf16 v[60:63], a[220:223], a[64:67], v[60:63]
    ds_read_b64_tr_b16 a[254:255], v29 offset:20992
    v_mfma_f32_16x16x32_bf16 v[80:83], a[208:211], a[68:71], v[80:83]
    buffer_load_dwordx4 a[188:191], v13, s[28:31], s37 offen offset:256 sc1
    s_add_u32 s37, s37, 2048
    v_mfma_f32_16x16x32_bf16 v[84:87], a[212:215], a[68:71], v[84:87]
    v_mfma_f32_16x16x32_bf16 v[88:91], a[216:219], a[68:71], v[88:91]
    v_mfma_f32_16x16x32_bf16 v[92:95], a[220:223], a[68:71], v[92:95]
    s_waitcnt vmcnt(16)
    s_waitcnt lgkmcnt(0)
    v_mfma_f32_16x16x32_bf16 v[96:99], a[224:227], a[152:155], v[96:99]
    s_add_u32 m0, s18, 16384
    v_mfma_f32_16x16x32_bf16 v[100:103], a[228:231], a[152:155], v[100:103]
    buffer_load_dwordx4 v2, s[44:47], s38 offen lds
    v_mfma_f32_16x16x32_bf16 v[104:107], a[232:235], a[152:155], v[104:107]
    v_mfma_f32_16x16x32_bf16 v[108:111], a[236:239], a[152:155], v[108:111]
    s_add_u32 m0, s18, 17408
    v_mfma_f32_16x16x32_bf16 v[128:131], a[224:227], a[156:159], v[128:131]
    buffer_load_dwordx4 v3, s[44:47], s38 offen lds
    s_add_u32 s38, s38, 65536
    v_mfma_f32_16x16x32_bf16 v[132:135], a[228:231], a[156:159], v[132:135]
    v_mfma_f32_16x16x32_bf16 v[136:139], a[232:235], a[156:159], v[136:139]
    v_mfma_f32_16x16x32_bf16 v[140:143], a[236:239], a[156:159], v[140:143]
    s_add_u32 m0, s19, 0
    v_mfma_f32_16x16x32_bf16 v[32:35], a[224:227], a[144:147], v[32:35]
    buffer_load_dwordx4 v2, s[44:47], s39 offen lds
    v_mfma_f32_16x16x32_bf16 v[36:39], a[228:231], a[144:147], v[36:39]
    v_mfma_f32_16x16x32_bf16 v[40:43], a[232:235], a[144:147], v[40:43]
    v_mfma_f32_16x16x32_bf16 v[44:47], a[236:239], a[144:147], v[44:47]
    s_add_u32 m0, s19, 1024
    v_mfma_f32_16x16x32_bf16 v[64:67], a[224:227], a[148:151], v[64:67]
    buffer_load_dwordx4 v3, s[44:47], s39 offen lds
    s_add_u32 s39, s39, 65536
    ds_read_b64_tr_b16 a[192:193], v17 offset:0
    v_mfma_f32_16x16x32_bf16 v[68:71], a[228:231], a[148:151], v[68:71]
    ds_read_b64_tr_b16 a[194:195], v17 offset:512
    v_mfma_f32_16x16x32_bf16 v[72:75], a[232:235], a[148:151], v[72:75]
    ds_read_b64_tr_b16 a[196:197], v18 offset:0
    v_mfma_f32_16x16x32_bf16 v[76:79], a[236:239], a[148:151], v[76:79]
    ds_read_b64_tr_b16 a[198:199], v18 offset:512
    v_mfma_f32_16x16x32_bf16 v[112:115], a[240:243], a[88:91], v[112:115]
    buffer_load_dwordx4 a[0:3], v12, s[28:31], s37 offen offset:0 sc1
    ds_read_b64_tr_b16 a[200:201], v19 offset:0
    v_mfma_f32_16x16x32_bf16 v[116:119], a[244:247], a[88:91], v[116:119]
    ds_read_b64_tr_b16 a[202:203], v19 offset:512
    v_mfma_f32_16x16x32_bf16 v[120:123], a[248:251], a[88:91], v[120:123]
    ds_read_b64_tr_b16 a[204:205], v20 offset:0
    v_mfma_f32_16x16x32_bf16 v[124:127], a[252:255], a[88:91], v[124:127]
    ds_read_b64_tr_b16 a[206:207], v20 offset:512
    v_mfma_f32_16x16x32_bf16 v[144:147], a[240:243], a[92:95], v[144:147]
    buffer_load_dwordx4 a[4:7], v12, s[28:31], s37 offen offset:256 sc1
    ds_read_b64_tr_b16 a[208:209], v14 offset:28672
    v_mfma_f32_16x16x32_bf16 v[148:151], a[244:247], a[92:95], v[148:151]
    ds_read_b64_tr_b16 a[210:211], v14 offset:29184
    v_mfma_f32_16x16x32_bf16 v[152:155], a[248:251], a[92:95], v[152:155]
    ds_read_b64_tr_b16 a[212:213], v15 offset:28672
    v_mfma_f32_16x16x32_bf16 v[156:159], a[252:255], a[92:95], v[156:159]
    ds_read_b64_tr_b16 a[214:215], v15 offset:29184
    v_mfma_f32_16x16x32_bf16 v[48:51], a[240:243], a[80:83], v[48:51]
    buffer_load_dwordx4 a[8:11], v13, s[28:31], s37 offen offset:0 sc1
    ds_read_b64_tr_b16 a[216:217], v16 offset:28672
    v_mfma_f32_16x16x32_bf16 v[52:55], a[244:247], a[80:83], v[52:55]
    ds_read_b64_tr_b16 a[218:219], v16 offset:29184
    v_mfma_f32_16x16x32_bf16 v[56:59], a[248:251], a[80:83], v[56:59]
    ds_read_b64_tr_b16 a[220:221], v29 offset:28672
    v_mfma_f32_16x16x32_bf16 v[60:63], a[252:255], a[80:83], v[60:63]
    ds_read_b64_tr_b16 a[222:223], v29 offset:29184
    v_mfma_f32_16x16x32_bf16 v[80:83], a[240:243], a[84:87], v[80:83]
    buffer_load_dwordx4 a[12:15], v13, s[28:31], s37 offen offset:256 sc1
    s_add_u32 s37, s37, 2048
    v_mfma_f32_16x16x32_bf16 v[84:87], a[244:247], a[84:87], v[84:87]
    v_mfma_f32_16x16x32_bf16 v[88:91], a[248:251], a[84:87], v[88:91]
    v_mfma_f32_16x16x32_bf16 v[92:95], a[252:255], a[84:87], v[92:95]
    s_waitcnt vmcnt(16)
    s_waitcnt lgkmcnt(0)
    s_barrier
    v_mfma_f32_16x16x32_bf16 v[96:99], a[192:195], a[168:171], v[96:99]
    s_add_u32 m0, s18, 20480
    v_mfma_f32_16x16x32_bf16 v[100:103], a[196:199], a[168:171], v[100:103]
    buffer_load_dwordx4 v2, s[44:47], s38 offen lds
    v_mfma_f32_16x16x32_bf16 v[104:107], a[200:203], a[168:171], v[104:107]
    v_mfma_f32_16x16x32_bf16 v[108:111], a[204:207], a[168:171], v[108:111]
    s_add_u32 m0, s18, 21504
    v_mfma_f32_16x16x32_bf16 v[128:131], a[192:195], a[172:175], v[128:131]
    buffer_load_dwordx4 v3, s[44:47], s38 offen lds
    s_add_u32 s38, s38, 65536
    v_mfma_f32_16x16x32_bf16 v[132:135], a[196:199], a[172:175], v[132:135]
    v_mfma_f32_16x16x32_bf16 v[136:139], a[200:203], a[172:175], v[136:139]
    v_mfma_f32_16x16x32_bf16 v[140:143], a[204:207], a[172:175], v[140:143]
    s_add_u32 m0, s19, 4096
    v_mfma_f32_16x16x32_bf16 v[32:35], a[192:195], a[160:163], v[32:35]
    buffer_load_dwordx4 v2, s[44:47], s39 offen lds
    v_mfma_f32_16x16x32_bf16 v[36:39], a[196:199], a[160:163], v[36:39]
    v_mfma_f32_16x16x32_bf16 v[40:43], a[200:203], a[160:163], v[40:43]
    v_mfma_f32_16x16x32_bf16 v[44:47], a[204:207], a[160:163], v[44:47]
    s_add_u32 m0, s19, 5120
    v_mfma_f32_16x16x32_bf16 v[64:67], a[192:195], a[164:167], v[64:67]
    buffer_load_dwordx4 v3, s[44:47], s39 offen lds
    s_add_u32 s39, s39, 65536
    ds_read_b64_tr_b16 a[224:225], v17 offset:4096
    v_mfma_f32_16x16x32_bf16 v[68:71], a[196:199], a[164:167], v[68:71]
    ds_read_b64_tr_b16 a[226:227], v17 offset:4608
    v_mfma_f32_16x16x32_bf16 v[72:75], a[200:203], a[164:167], v[72:75]
    ds_read_b64_tr_b16 a[228:229], v18 offset:4096
    v_mfma_f32_16x16x32_bf16 v[76:79], a[204:207], a[164:167], v[76:79]
    ds_read_b64_tr_b16 a[230:231], v18 offset:4608
    v_mfma_f32_16x16x32_bf16 v[112:115], a[208:211], a[104:107], v[112:115]
    buffer_load_dwordx4 a[16:19], v12, s[28:31], s37 offen offset:0 sc1
    ds_read_b64_tr_b16 a[232:233], v19 offset:4096
    v_mfma_f32_16x16x32_bf16 v[116:119], a[212:215], a[104:107], v[116:119]
    ds_read_b64_tr_b16 a[234:235], v19 offset:4608
    v_mfma_f32_16x16x32_bf16 v[120:123], a[216:219], a[104:107], v[120:123]
    ds_read_b64_tr_b16 a[236:237], v20 offset:4096
    v_mfma_f32_16x16x32_bf16 v[124:127], a[220:223], a[104:107], v[124:127]
    ds_read_b64_tr_b16 a[238:239], v20 offset:4608
    v_mfma_f32_16x16x32_bf16 v[144:147], a[208:211], a[108:111], v[144:147]
    buffer_load_dwordx4 a[20:23], v12, s[28:31], s37 offen offset:256 sc1
    ds_read_b64_tr_b16 a[240:241], v14 offset:32768
    v_mfma_f32_16x16x32_bf16 v[148:151], a[212:215], a[108:111], v[148:151]
    ds_read_b64_tr_b16 a[242:243], v14 offset:33280
    v_mfma_f32_16x16x32_bf16 v[152:155], a[216:219], a[108:111], v[152:155]
    ds_read_b64_tr_b16 a[244:245], v15 offset:32768
    v_mfma_f32_16x16x32_bf16 v[156:159], a[220:223], a[108:111], v[156:159]
    ds_read_b64_tr_b16 a[246:247], v15 offset:33280
    v_mfma_f32_16x16x32_bf16 v[48:51], a[208:211], a[96:99], v[48:51]
    buffer_load_dwordx4 a[24:27], v13, s[28:31], s37 offen offset:0 sc1
    ds_read_b64_tr_b16 a[248:249], v16 offset:32768
    v_mfma_f32_16x16x32_bf16 v[52:55], a[212:215], a[96:99], v[52:55]
    ds_read_b64_tr_b16 a[250:251], v16 offset:33280
    v_mfma_f32_16x16x32_bf16 v[56:59], a[216:219], a[96:99], v[56:59]
    ds_read_b64_tr_b16 a[252:253], v29 offset:32768
    v_mfma_f32_16x16x32_bf16 v[60:63], a[220:223], a[96:99], v[60:63]
    ds_read_b64_tr_b16 a[254:255], v29 offset:33280
    v_mfma_f32_16x16x32_bf16 v[80:83], a[208:211], a[100:103], v[80:83]
    buffer_load_dwordx4 a[28:31], v13, s[28:31], s37 offen offset:256 sc1
    s_add_u32 s37, s37, 2048
    v_mfma_f32_16x16x32_bf16 v[84:87], a[212:215], a[100:103], v[84:87]
    v_mfma_f32_16x16x32_bf16 v[88:91], a[216:219], a[100:103], v[88:91]
    v_mfma_f32_16x16x32_bf16 v[92:95], a[220:223], a[100:103], v[92:95]
    s_waitcnt vmcnt(16)
    s_waitcnt lgkmcnt(0)
    v_mfma_f32_16x16x32_bf16 v[96:99], a[224:227], a[184:187], v[96:99]
    s_add_u32 m0, s18, 28672
    v_mfma_f32_16x16x32_bf16 v[100:103], a[228:231], a[184:187], v[100:103]
    buffer_load_dwordx4 v2, s[44:47], s38 offen lds
    v_mfma_f32_16x16x32_bf16 v[104:107], a[232:235], a[184:187], v[104:107]
    v_mfma_f32_16x16x32_bf16 v[108:111], a[236:239], a[184:187], v[108:111]
    s_add_u32 m0, s18, 29696
    v_mfma_f32_16x16x32_bf16 v[128:131], a[224:227], a[188:191], v[128:131]
    buffer_load_dwordx4 v3, s[44:47], s38 offen lds
    s_add_u32 s38, s38, 65536
    v_mfma_f32_16x16x32_bf16 v[132:135], a[228:231], a[188:191], v[132:135]
    v_mfma_f32_16x16x32_bf16 v[136:139], a[232:235], a[188:191], v[136:139]
    v_mfma_f32_16x16x32_bf16 v[140:143], a[236:239], a[188:191], v[140:143]
    s_add_u32 m0, s19, 8192
    v_mfma_f32_16x16x32_bf16 v[32:35], a[224:227], a[176:179], v[32:35]
    buffer_load_dwordx4 v2, s[44:47], s39 offen lds
    v_mfma_f32_16x16x32_bf16 v[36:39], a[228:231], a[176:179], v[36:39]
    v_mfma_f32_16x16x32_bf16 v[40:43], a[232:235], a[176:179], v[40:43]
    v_mfma_f32_16x16x32_bf16 v[44:47], a[236:239], a[176:179], v[44:47]
    s_add_u32 m0, s19, 9216
    v_mfma_f32_16x16x32_bf16 v[64:67], a[224:227], a[180:183], v[64:67]
    buffer_load_dwordx4 v3, s[44:47], s39 offen lds
    s_add_u32 s39, s39, 65536
    ds_read_b64_tr_b16 a[192:193], v17 offset:8192
    v_mfma_f32_16x16x32_bf16 v[68:71], a[228:231], a[180:183], v[68:71]
    ds_read_b64_tr_b16 a[194:195], v17 offset:8704
    v_mfma_f32_16x16x32_bf16 v[72:75], a[232:235], a[180:183], v[72:75]
    ds_read_b64_tr_b16 a[196:197], v18 offset:8192
    v_mfma_f32_16x16x32_bf16 v[76:79], a[236:239], a[180:183], v[76:79]
    ds_read_b64_tr_b16 a[198:199], v18 offset:8704
    v_mfma_f32_16x16x32_bf16 v[112:115], a[240:243], a[120:123], v[112:115]
    buffer_load_dwordx4 a[32:35], v12, s[28:31], s37 offen offset:0 sc1
    ds_read_b64_tr_b16 a[200:201], v19 offset:8192
    v_mfma_f32_16x16x32_bf16 v[116:119], a[244:247], a[120:123], v[116:119]
    ds_read_b64_tr_b16 a[202:203], v19 offset:8704
    v_mfma_f32_16x16x32_bf16 v[120:123], a[248:251], a[120:123], v[120:123]
    ds_read_b64_tr_b16 a[204:205], v20 offset:8192
    v_mfma_f32_16x16x32_bf16 v[124:127], a[252:255], a[120:123], v[124:127]
    ds_read_b64_tr_b16 a[206:207], v20 offset:8704
    v_mfma_f32_16x16x32_bf16 v[144:147], a[240:243], a[124:127], v[144:147]
    buffer_load_dwordx4 a[36:39], v12, s[28:31], s37 offen offset:256 sc1
    ds_read_b64_tr_b16 a[208:209], v14 offset:36864
    v_mfma_f32_16x16x32_bf16 v[148:151], a[244:247], a[124:127], v[148:151]
    ds_read_b64_tr_b16 a[210:211], v14 offset:37376
    v_mfma_f32_16x16x32_bf16 v[152:155], a[248:251], a[124:127], v[152:155]
    ds_read_b64_tr_b16 a[212:213], v15 offset:36864
    v_mfma_f32_16x16x32_bf16 v[156:159], a[252:255], a[124:127], v[156:159]
    ds_read_b64_tr_b16 a[214:215], v15 offset:37376
    v_mfma_f32_16x16x32_bf16 v[48:51], a[240:243], a[112:115], v[48:51]
    buffer_load_dwordx4 a[40:43], v13, s[28:31], s37 offen offset:0 sc1
    ds_read_b64_tr_b16 a[216:217], v16 offset:36864
    v_mfma_f32_16x16x32_bf16 v[52:55], a[244:247], a[112:115], v[52:55]
    ds_read_b64_tr_b16 a[218:219], v16 offset:37376
    v_mfma_f32_16x16x32_bf16 v[56:59], a[248:251], a[112:115], v[56:59]
    ds_read_b64_tr_b16 a[220:221], v29 offset:36864
    v_mfma_f32_16x16x32_bf16 v[60:63], a[252:255], a[112:115], v[60:63]
    ds_read_b64_tr_b16 a[222:223], v29 offset:37376
    v_mfma_f32_16x16x32_bf16 v[80:83], a[240:243], a[116:119], v[80:83]
    buffer_load_dwordx4 a[44:47], v13, s[28:31], s37 offen offset:256 sc1
    s_add_u32 s37, s37, 2048
    v_mfma_f32_16x16x32_bf16 v[84:87], a[244:247], a[116:119], v[84:87]
    v_mfma_f32_16x16x32_bf16 v[88:91], a[248:251], a[116:119], v[88:91]
    v_mfma_f32_16x16x32_bf16 v[92:95], a[252:255], a[116:119], v[92:95]
    s_waitcnt vmcnt(16)
    s_waitcnt lgkmcnt(0)
    s_barrier
    v_mfma_f32_16x16x32_bf16 v[96:99], a[192:195], a[8:11], v[96:99]
    s_add_u32 m0, s18, 32768
    v_mfma_f32_16x16x32_bf16 v[100:103], a[196:199], a[8:11], v[100:103]
    buffer_load_dwordx4 v2, s[44:47], s38 offen lds
    v_mfma_f32_16x16x32_bf16 v[104:107], a[200:203], a[8:11], v[104:107]
    v_mfma_f32_16x16x32_bf16 v[108:111], a[204:207], a[8:11], v[108:111]
    s_add_u32 m0, s18, 33792
    v_mfma_f32_16x16x32_bf16 v[128:131], a[192:195], a[12:15], v[128:131]
    buffer_load_dwordx4 v3, s[44:47], s38 offen lds
    s_add_u32 s38, s38, 65536
    v_mfma_f32_16x16x32_bf16 v[132:135], a[196:199], a[12:15], v[132:135]
    v_mfma_f32_16x16x32_bf16 v[136:139], a[200:203], a[12:15], v[136:139]
    v_mfma_f32_16x16x32_bf16 v[140:143], a[204:207], a[12:15], v[140:143]
    s_add_u32 m0, s19, 12288
    v_mfma_f32_16x16x32_bf16 v[32:35], a[192:195], a[0:3], v[32:35]
    buffer_load_dwordx4 v2, s[44:47], s39 offen lds
    v_mfma_f32_16x16x32_bf16 v[36:39], a[196:199], a[0:3], v[36:39]
    v_mfma_f32_16x16x32_bf16 v[40:43], a[200:203], a[0:3], v[40:43]
    v_mfma_f32_16x16x32_bf16 v[44:47], a[204:207], a[0:3], v[44:47]
    s_add_u32 m0, s19, 13312
    v_mfma_f32_16x16x32_bf16 v[64:67], a[192:195], a[4:7], v[64:67]
    buffer_load_dwordx4 v3, s[44:47], s39 offen lds
    s_add_u32 s39, s39, 65536
    ds_read_b64_tr_b16 a[224:225], v17 offset:12288
    v_mfma_f32_16x16x32_bf16 v[68:71], a[196:199], a[4:7], v[68:71]
    ds_read_b64_tr_b16 a[226:227], v17 offset:12800
    v_mfma_f32_16x16x32_bf16 v[72:75], a[200:203], a[4:7], v[72:75]
    ds_read_b64_tr_b16 a[228:229], v18 offset:12288
    v_mfma_f32_16x16x32_bf16 v[76:79], a[204:207], a[4:7], v[76:79]
    ds_read_b64_tr_b16 a[230:231], v18 offset:12800
    v_mfma_f32_16x16x32_bf16 v[112:115], a[208:211], a[136:139], v[112:115]
    buffer_load_dwordx4 a[48:51], v12, s[28:31], s37 offen offset:0 sc1
    ds_read_b64_tr_b16 a[232:233], v19 offset:12288
    v_mfma_f32_16x16x32_bf16 v[116:119], a[212:215], a[136:139], v[116:119]
    ds_read_b64_tr_b16 a[234:235], v19 offset:12800
    v_mfma_f32_16x16x32_bf16 v[120:123], a[216:219], a[136:139], v[120:123]
    ds_read_b64_tr_b16 a[236:237], v20 offset:12288
    v_mfma_f32_16x16x32_bf16 v[124:127], a[220:223], a[136:139], v[124:127]
    ds_read_b64_tr_b16 a[238:239], v20 offset:12800
    v_mfma_f32_16x16x32_bf16 v[144:147], a[208:211], a[140:143], v[144:147]
    buffer_load_dwordx4 a[52:55], v12, s[28:31], s37 offen offset:256 sc1
    ds_read_b64_tr_b16 a[240:241], v14 offset:24576
    v_mfma_f32_16x16x32_bf16 v[148:151], a[212:215], a[140:143], v[148:151]
    ds_read_b64_tr_b16 a[242:243], v14 offset:25088
    v_mfma_f32_16x16x32_bf16 v[152:155], a[216:219], a[140:143], v[152:155]
    ds_read_b64_tr_b16 a[244:245], v15 offset:24576
    v_mfma_f32_16x16x32_bf16 v[156:159], a[220:223], a[140:143], v[156:159]
    ds_read_b64_tr_b16 a[246:247], v15 offset:25088
    v_mfma_f32_16x16x32_bf16 v[48:51], a[208:211], a[128:131], v[48:51]
    buffer_load_dwordx4 a[56:59], v13, s[28:31], s37 offen offset:0 sc1
    ds_read_b64_tr_b16 a[248:249], v16 offset:24576
    v_mfma_f32_16x16x32_bf16 v[52:55], a[212:215], a[128:131], v[52:55]
    ds_read_b64_tr_b16 a[250:251], v16 offset:25088
    v_mfma_f32_16x16x32_bf16 v[56:59], a[216:219], a[128:131], v[56:59]
    ds_read_b64_tr_b16 a[252:253], v29 offset:24576
    v_mfma_f32_16x16x32_bf16 v[60:63], a[220:223], a[128:131], v[60:63]
    ds_read_b64_tr_b16 a[254:255], v29 offset:25088
    v_mfma_f32_16x16x32_bf16 v[80:83], a[208:211], a[132:135], v[80:83]
    buffer_load_dwordx4 a[60:63], v13, s[28:31], s37 offen offset:256 sc1
    s_add_u32 s37, s37, 2048
    v_mfma_f32_16x16x32_bf16 v[84:87], a[212:215], a[132:135], v[84:87]
    v_mfma_f32_16x16x32_bf16 v[88:91], a[216:219], a[132:135], v[88:91]
    v_mfma_f32_16x16x32_bf16 v[92:95], a[220:223], a[132:135], v[92:95]
    s_waitcnt vmcnt(16)
    s_waitcnt lgkmcnt(0)
    v_mfma_f32_16x16x32_bf16 v[96:99], a[224:227], a[24:27], v[96:99]
    s_add_u32 m0, s18, 36864
    v_mfma_f32_16x16x32_bf16 v[100:103], a[228:231], a[24:27], v[100:103]
    buffer_load_dwordx4 v2, s[44:47], s38 offen lds
    v_mfma_f32_16x16x32_bf16 v[104:107], a[232:235], a[24:27], v[104:107]
    v_mfma_f32_16x16x32_bf16 v[108:111], a[236:239], a[24:27], v[108:111]
    s_add_u32 m0, s18, 37888
    v_mfma_f32_16x16x32_bf16 v[128:131], a[224:227], a[28:31], v[128:131]
    buffer_load_dwordx4 v3, s[44:47], s38 offen lds
    s_add_u32 s38, s38, 65536
    v_mfma_f32_16x16x32_bf16 v[132:135], a[228:231], a[28:31], v[132:135]
    v_mfma_f32_16x16x32_bf16 v[136:139], a[232:235], a[28:31], v[136:139]
    v_mfma_f32_16x16x32_bf16 v[140:143], a[236:239], a[28:31], v[140:143]
    s_add_u32 m0, s19, 16384
    v_mfma_f32_16x16x32_bf16 v[32:35], a[224:227], a[16:19], v[32:35]
    buffer_load_dwordx4 v2, s[44:47], s39 offen lds
    v_mfma_f32_16x16x32_bf16 v[36:39], a[228:231], a[16:19], v[36:39]
    v_mfma_f32_16x16x32_bf16 v[40:43], a[232:235], a[16:19], v[40:43]
    v_mfma_f32_16x16x32_bf16 v[44:47], a[236:239], a[16:19], v[44:47]
    s_add_u32 m0, s19, 17408
    v_mfma_f32_16x16x32_bf16 v[64:67], a[224:227], a[20:23], v[64:67]
    buffer_load_dwordx4 v3, s[44:47], s39 offen lds
    s_add_u32 s39, s39, 65536
    ds_read_b64_tr_b16 a[192:193], v17 offset:16384
    v_mfma_f32_16x16x32_bf16 v[68:71], a[228:231], a[20:23], v[68:71]
    ds_read_b64_tr_b16 a[194:195], v17 offset:16896
    v_mfma_f32_16x16x32_bf16 v[72:75], a[232:235], a[20:23], v[72:75]
    ds_read_b64_tr_b16 a[196:197], v18 offset:16384
    v_mfma_f32_16x16x32_bf16 v[76:79], a[236:239], a[20:23], v[76:79]
    ds_read_b64_tr_b16 a[198:199], v18 offset:16896
    v_mfma_f32_16x16x32_bf16 v[112:115], a[240:243], a[152:155], v[112:115]
    buffer_load_dwordx4 a[64:67], v12, s[28:31], s37 offen offset:0 sc1
    ds_read_b64_tr_b16 a[200:201], v19 offset:16384
    v_mfma_f32_16x16x32_bf16 v[116:119], a[244:247], a[152:155], v[116:119]
    ds_read_b64_tr_b16 a[202:203], v19 offset:16896
    v_mfma_f32_16x16x32_bf16 v[120:123], a[248:251], a[152:155], v[120:123]
    ds_read_b64_tr_b16 a[204:205], v20 offset:16384
    v_mfma_f32_16x16x32_bf16 v[124:127], a[252:255], a[152:155], v[124:127]
    ds_read_b64_tr_b16 a[206:207], v20 offset:16896
    v_mfma_f32_16x16x32_bf16 v[144:147], a[240:243], a[156:159], v[144:147]
    buffer_load_dwordx4 a[68:71], v12, s[28:31], s37 offen offset:256 sc1
    ds_read_b64_tr_b16 a[208:209], v14 offset:0
    v_mfma_f32_16x16x32_bf16 v[148:151], a[244:247], a[156:159], v[148:151]
    ds_read_b64_tr_b16 a[210:211], v14 offset:512
    v_mfma_f32_16x16x32_bf16 v[152:155], a[248:251], a[156:159], v[152:155]
    ds_read_b64_tr_b16 a[212:213], v15 offset:0
    v_mfma_f32_16x16x32_bf16 v[156:159], a[252:255], a[156:159], v[156:159]
    ds_read_b64_tr_b16 a[214:215], v15 offset:512
    v_mfma_f32_16x16x32_bf16 v[48:51], a[240:243], a[144:147], v[48:51]
    buffer_load_dwordx4 a[72:75], v13, s[28:31], s37 offen offset:0 sc1
    ds_read_b64_tr_b16 a[216:217], v16 offset:0
    v_mfma_f32_16x16x32_bf16 v[52:55], a[244:247], a[144:147], v[52:55]
    ds_read_b64_tr_b16 a[218:219], v16 offset:512
    v_mfma_f32_16x16x32_bf16 v[56:59], a[248:251], a[144:147], v[56:59]
    ds_read_b64_tr_b16 a[220:221], v29 offset:0
    v_mfma_f32_16x16x32_bf16 v[60:63], a[252:255], a[144:147], v[60:63]
    ds_read_b64_tr_b16 a[222:223], v29 offset:512
    v_mfma_f32_16x16x32_bf16 v[80:83], a[240:243], a[148:151], v[80:83]
    buffer_load_dwordx4 a[76:79], v13, s[28:31], s37 offen offset:256 sc1
    s_add_u32 s37, s37, 2048
    v_mfma_f32_16x16x32_bf16 v[84:87], a[244:247], a[148:151], v[84:87]
    v_mfma_f32_16x16x32_bf16 v[88:91], a[248:251], a[148:151], v[88:91]
    v_mfma_f32_16x16x32_bf16 v[92:95], a[252:255], a[148:151], v[92:95]
    s_waitcnt vmcnt(16)
    s_waitcnt lgkmcnt(0)
    s_barrier
    v_mfma_f32_16x16x32_bf16 v[96:99], a[192:195], a[40:43], v[96:99]
    s_add_u32 m0, s18, 24576
    v_mfma_f32_16x16x32_bf16 v[100:103], a[196:199], a[40:43], v[100:103]
    buffer_load_dwordx4 v2, s[44:47], s38 offen lds
    v_mfma_f32_16x16x32_bf16 v[104:107], a[200:203], a[40:43], v[104:107]
    v_mfma_f32_16x16x32_bf16 v[108:111], a[204:207], a[40:43], v[108:111]
    s_add_u32 m0, s18, 25600
    v_mfma_f32_16x16x32_bf16 v[128:131], a[192:195], a[44:47], v[128:131]
    buffer_load_dwordx4 v3, s[44:47], s38 offen lds
    s_add_u32 s38, s38, 65536
    v_mfma_f32_16x16x32_bf16 v[132:135], a[196:199], a[44:47], v[132:135]
    v_mfma_f32_16x16x32_bf16 v[136:139], a[200:203], a[44:47], v[136:139]
    v_mfma_f32_16x16x32_bf16 v[140:143], a[204:207], a[44:47], v[140:143]
    s_add_u32 m0, s19, 20480
    v_mfma_f32_16x16x32_bf16 v[32:35], a[192:195], a[32:35], v[32:35]
    buffer_load_dwordx4 v2, s[44:47], s39 offen lds
    v_mfma_f32_16x16x32_bf16 v[36:39], a[196:199], a[32:35], v[36:39]
    v_mfma_f32_16x16x32_bf16 v[40:43], a[200:203], a[32:35], v[40:43]
    v_mfma_f32_16x16x32_bf16 v[44:47], a[204:207], a[32:35], v[44:47]
    s_add_u32 m0, s19, 21504
    v_mfma_f32_16x16x32_bf16 v[64:67], a[192:195], a[36:39], v[64:67]
    buffer_load_dwordx4 v3, s[44:47], s39 offen lds
    s_add_u32 s39, s39, 65536
    ds_read_b64_tr_b16 a[224:225], v17 offset:20480
    v_mfma_f32_16x16x32_bf16 v[68:71], a[196:199], a[36:39], v[68:71]
    ds_read_b64_tr_b16 a[226:227], v17 offset:20992
    v_mfma_f32_16x16x32_bf16 v[72:75], a[200:203], a[36:39], v[72:75]
    ds_read_b64_tr_b16 a[228:229], v18 offset:20480
    v_mfma_f32_16x16x32_bf16 v[76:79], a[204:207], a[36:39], v[76:79]
    ds_read_b64_tr_b16 a[230:231], v18 offset:20992
    v_mfma_f32_16x16x32_bf16 v[112:115], a[208:211], a[168:171], v[112:115]
    buffer_load_dwordx4 a[80:83], v12, s[28:31], s37 offen offset:0 sc1
    ds_read_b64_tr_b16 a[232:233], v19 offset:20480
    v_mfma_f32_16x16x32_bf16 v[116:119], a[212:215], a[168:171], v[116:119]
    ds_read_b64_tr_b16 a[234:235], v19 offset:20992
    v_mfma_f32_16x16x32_bf16 v[120:123], a[216:219], a[168:171], v[120:123]
    ds_read_b64_tr_b16 a[236:237], v20 offset:20480
    v_mfma_f32_16x16x32_bf16 v[124:127], a[220:223], a[168:171], v[124:127]
    ds_read_b64_tr_b16 a[238:239], v20 offset:20992
    v_mfma_f32_16x16x32_bf16 v[144:147], a[208:211], a[172:175], v[144:147]
    buffer_load_dwordx4 a[84:87], v12, s[28:31], s37 offen offset:256 sc1
    ds_read_b64_tr_b16 a[240:241], v14 offset:4096
    v_mfma_f32_16x16x32_bf16 v[148:151], a[212:215], a[172:175], v[148:151]
    ds_read_b64_tr_b16 a[242:243], v14 offset:4608
    v_mfma_f32_16x16x32_bf16 v[152:155], a[216:219], a[172:175], v[152:155]
    ds_read_b64_tr_b16 a[244:245], v15 offset:4096
    v_mfma_f32_16x16x32_bf16 v[156:159], a[220:223], a[172:175], v[156:159]
    ds_read_b64_tr_b16 a[246:247], v15 offset:4608
    v_mfma_f32_16x16x32_bf16 v[48:51], a[208:211], a[160:163], v[48:51]
    buffer_load_dwordx4 a[88:91], v13, s[28:31], s37 offen offset:0 sc1
    ds_read_b64_tr_b16 a[248:249], v16 offset:4096
    v_mfma_f32_16x16x32_bf16 v[52:55], a[212:215], a[160:163], v[52:55]
    ds_read_b64_tr_b16 a[250:251], v16 offset:4608
    v_mfma_f32_16x16x32_bf16 v[56:59], a[216:219], a[160:163], v[56:59]
    ds_read_b64_tr_b16 a[252:253], v29 offset:4096
    v_mfma_f32_16x16x32_bf16 v[60:63], a[220:223], a[160:163], v[60:63]
    ds_read_b64_tr_b16 a[254:255], v29 offset:4608
    v_mfma_f32_16x16x32_bf16 v[80:83], a[208:211], a[164:167], v[80:83]
    buffer_load_dwordx4 a[92:95], v13, s[28:31], s37 offen offset:256 sc1
    s_add_u32 s37, s37, 2048
    v_mfma_f32_16x16x32_bf16 v[84:87], a[212:215], a[164:167], v[84:87]
    v_mfma_f32_16x16x32_bf16 v[88:91], a[216:219], a[164:167], v[88:91]
    v_mfma_f32_16x16x32_bf16 v[92:95], a[220:223], a[164:167], v[92:95]
    s_waitcnt vmcnt(16)
    s_waitcnt lgkmcnt(0)
    v_mfma_f32_16x16x32_bf16 v[96:99], a[224:227], a[56:59], v[96:99]
    s_add_u32 m0, s18, 0
    v_mfma_f32_16x16x32_bf16 v[100:103], a[228:231], a[56:59], v[100:103]
    buffer_load_dwordx4 v2, s[44:47], s38 offen lds
    v_mfma_f32_16x16x32_bf16 v[104:107], a[232:235], a[56:59], v[104:107]
    v_mfma_f32_16x16x32_bf16 v[108:111], a[236:239], a[56:59], v[108:111]
    s_add_u32 m0, s18, 1024
    v_mfma_f32_16x16x32_bf16 v[128:131], a[224:227], a[60:63], v[128:131]
    buffer_load_dwordx4 v3, s[44:47], s38 offen lds
    s_add_u32 s38, s38, 65536
    v_mfma_f32_16x16x32_bf16 v[132:135], a[228:231], a[60:63], v[132:135]
    v_mfma_f32_16x16x32_bf16 v[136:139], a[232:235], a[60:63], v[136:139]
    v_mfma_f32_16x16x32_bf16 v[140:143], a[236:239], a[60:63], v[140:143]
    s_add_u32 m0, s19, 28672
    v_mfma_f32_16x16x32_bf16 v[32:35], a[224:227], a[48:51], v[32:35]
    buffer_load_dwordx4 v2, s[44:47], s39 offen lds
    v_mfma_f32_16x16x32_bf16 v[36:39], a[228:231], a[48:51], v[36:39]
    v_mfma_f32_16x16x32_bf16 v[40:43], a[232:235], a[48:51], v[40:43]
    v_mfma_f32_16x16x32_bf16 v[44:47], a[236:239], a[48:51], v[44:47]
    s_add_u32 m0, s19, 29696
    v_mfma_f32_16x16x32_bf16 v[64:67], a[224:227], a[52:55], v[64:67]
    buffer_load_dwordx4 v3, s[44:47], s39 offen lds
    s_add_u32 s39, s39, 65536
    ds_read_b64_tr_b16 a[192:193], v17 offset:28672
    v_mfma_f32_16x16x32_bf16 v[68:71], a[228:231], a[52:55], v[68:71]
    ds_read_b64_tr_b16 a[194:195], v17 offset:29184
    v_mfma_f32_16x16x32_bf16 v[72:75], a[232:235], a[52:55], v[72:75]
    ds_read_b64_tr_b16 a[196:197], v18 offset:28672
    v_mfma_f32_16x16x32_bf16 v[76:79], a[236:239], a[52:55], v[76:79]
    ds_read_b64_tr_b16 a[198:199], v18 offset:29184
    v_mfma_f32_16x16x32_bf16 v[112:115], a[240:243], a[184:187], v[112:115]
    buffer_load_dwordx4 a[96:99], v12, s[28:31], s37 offen offset:0 sc1
    ds_read_b64_tr_b16 a[200:201], v19 offset:28672
    v_mfma_f32_16x16x32_bf16 v[116:119], a[244:247], a[184:187], v[116:119]
    ds_read_b64_tr_b16 a[202:203], v19 offset:29184
    v_mfma_f32_16x16x32_bf16 v[120:123], a[248:251], a[184:187], v[120:123]
    ds_read_b64_tr_b16 a[204:205], v20 offset:28672
    v_mfma_f32_16x16x32_bf16 v[124:127], a[252:255], a[184:187], v[124:127]
    ds_read_b64_tr_b16 a[206:207], v20 offset:29184
    v_mfma_f32_16x16x32_bf16 v[144:147], a[240:243], a[188:191], v[144:147]
    buffer_load_dwordx4 a[100:103], v12, s[28:31], s37 offen offset:256 sc1
    ds_read_b64_tr_b16 a[208:209], v14 offset:8192
    v_mfma_f32_16x16x32_bf16 v[148:151], a[244:247], a[188:191], v[148:151]
    ds_read_b64_tr_b16 a[210:211], v14 offset:8704
    v_mfma_f32_16x16x32_bf16 v[152:155], a[248:251], a[188:191], v[152:155]
    ds_read_b64_tr_b16 a[212:213], v15 offset:8192
    v_mfma_f32_16x16x32_bf16 v[156:159], a[252:255], a[188:191], v[156:159]
    ds_read_b64_tr_b16 a[214:215], v15 offset:8704
    v_mfma_f32_16x16x32_bf16 v[48:51], a[240:243], a[176:179], v[48:51]
    buffer_load_dwordx4 a[104:107], v13, s[28:31], s37 offen offset:0 sc1
    ds_read_b64_tr_b16 a[216:217], v16 offset:8192
    v_mfma_f32_16x16x32_bf16 v[52:55], a[244:247], a[176:179], v[52:55]
    ds_read_b64_tr_b16 a[218:219], v16 offset:8704
    v_mfma_f32_16x16x32_bf16 v[56:59], a[248:251], a[176:179], v[56:59]
    ds_read_b64_tr_b16 a[220:221], v29 offset:8192
    v_mfma_f32_16x16x32_bf16 v[60:63], a[252:255], a[176:179], v[60:63]
    ds_read_b64_tr_b16 a[222:223], v29 offset:8704
    v_mfma_f32_16x16x32_bf16 v[80:83], a[240:243], a[180:183], v[80:83]
    buffer_load_dwordx4 a[108:111], v13, s[28:31], s37 offen offset:256 sc1
    s_add_u32 s37, s37, 2048
    v_mfma_f32_16x16x32_bf16 v[84:87], a[244:247], a[180:183], v[84:87]
    v_mfma_f32_16x16x32_bf16 v[88:91], a[248:251], a[180:183], v[88:91]
    v_mfma_f32_16x16x32_bf16 v[92:95], a[252:255], a[180:183], v[92:95]
    s_waitcnt vmcnt(16)
    s_waitcnt lgkmcnt(0)
    s_barrier
    v_mfma_f32_16x16x32_bf16 v[96:99], a[192:195], a[72:75], v[96:99]
    s_add_u32 m0, s18, 4096
    v_mfma_f32_16x16x32_bf16 v[100:103], a[196:199], a[72:75], v[100:103]
    buffer_load_dwordx4 v2, s[44:47], s38 offen lds
    v_mfma_f32_16x16x32_bf16 v[104:107], a[200:203], a[72:75], v[104:107]
    v_mfma_f32_16x16x32_bf16 v[108:111], a[204:207], a[72:75], v[108:111]
    s_add_u32 m0, s18, 5120
    v_mfma_f32_16x16x32_bf16 v[128:131], a[192:195], a[76:79], v[128:131]
    buffer_load_dwordx4 v3, s[44:47], s38 offen lds
    s_add_u32 s38, s38, 65536
    v_mfma_f32_16x16x32_bf16 v[132:135], a[196:199], a[76:79], v[132:135]
    v_mfma_f32_16x16x32_bf16 v[136:139], a[200:203], a[76:79], v[136:139]
    v_mfma_f32_16x16x32_bf16 v[140:143], a[204:207], a[76:79], v[140:143]
    s_add_u32 m0, s19, 32768
    v_mfma_f32_16x16x32_bf16 v[32:35], a[192:195], a[64:67], v[32:35]
    buffer_load_dwordx4 v2, s[44:47], s39 offen lds
    v_mfma_f32_16x16x32_bf16 v[36:39], a[196:199], a[64:67], v[36:39]
    v_mfma_f32_16x16x32_bf16 v[40:43], a[200:203], a[64:67], v[40:43]
    v_mfma_f32_16x16x32_bf16 v[44:47], a[204:207], a[64:67], v[44:47]
    s_add_u32 m0, s19, 33792
    v_mfma_f32_16x16x32_bf16 v[64:67], a[192:195], a[68:71], v[64:67]
    buffer_load_dwordx4 v3, s[44:47], s39 offen lds
    s_add_u32 s39, s39, 65536
    ds_read_b64_tr_b16 a[224:225], v17 offset:32768
    v_mfma_f32_16x16x32_bf16 v[68:71], a[196:199], a[68:71], v[68:71]
    ds_read_b64_tr_b16 a[226:227], v17 offset:33280
    v_mfma_f32_16x16x32_bf16 v[72:75], a[200:203], a[68:71], v[72:75]
    ds_read_b64_tr_b16 a[228:229], v18 offset:32768
    v_mfma_f32_16x16x32_bf16 v[76:79], a[204:207], a[68:71], v[76:79]
    ds_read_b64_tr_b16 a[230:231], v18 offset:33280
    v_mfma_f32_16x16x32_bf16 v[112:115], a[208:211], a[8:11], v[112:115]
    buffer_load_dwordx4 a[112:115], v12, s[28:31], s37 offen offset:0 sc1
    ds_read_b64_tr_b16 a[232:233], v19 offset:32768
    v_mfma_f32_16x16x32_bf16 v[116:119], a[212:215], a[8:11], v[116:119]
    ds_read_b64_tr_b16 a[234:235], v19 offset:33280
    v_mfma_f32_16x16x32_bf16 v[120:123], a[216:219], a[8:11], v[120:123]
    ds_read_b64_tr_b16 a[236:237], v20 offset:32768
    v_mfma_f32_16x16x32_bf16 v[124:127], a[220:223], a[8:11], v[124:127]
    ds_read_b64_tr_b16 a[238:239], v20 offset:33280
    v_mfma_f32_16x16x32_bf16 v[144:147], a[208:211], a[12:15], v[144:147]
    buffer_load_dwordx4 a[116:119], v12, s[28:31], s37 offen offset:256 sc1
    ds_read_b64_tr_b16 a[240:241], v14 offset:12288
    v_mfma_f32_16x16x32_bf16 v[148:151], a[212:215], a[12:15], v[148:151]
    ds_read_b64_tr_b16 a[242:243], v14 offset:12800
    v_mfma_f32_16x16x32_bf16 v[152:155], a[216:219], a[12:15], v[152:155]
    ds_read_b64_tr_b16 a[244:245], v15 offset:12288
    v_mfma_f32_16x16x32_bf16 v[156:159], a[220:223], a[12:15], v[156:159]
    ds_read_b64_tr_b16 a[246:247], v15 offset:12800
    v_mfma_f32_16x16x32_bf16 v[48:51], a[208:211], a[0:3], v[48:51]
    buffer_load_dwordx4 a[120:123], v13, s[28:31], s37 offen offset:0 sc1
    ds_read_b64_tr_b16 a[248:249], v16 offset:12288
    v_mfma_f32_16x16x32_bf16 v[52:55], a[212:215], a[0:3], v[52:55]
    ds_read_b64_tr_b16 a[250:251], v16 offset:12800
    v_mfma_f32_16x16x32_bf16 v[56:59], a[216:219], a[0:3], v[56:59]
    ds_read_b64_tr_b16 a[252:253], v29 offset:12288
    v_mfma_f32_16x16x32_bf16 v[60:63], a[220:223], a[0:3], v[60:63]
    ds_read_b64_tr_b16 a[254:255], v29 offset:12800
    v_mfma_f32_16x16x32_bf16 v[80:83], a[208:211], a[4:7], v[80:83]
    buffer_load_dwordx4 a[124:127], v13, s[28:31], s37 offen offset:256 sc1
    s_add_u32 s37, s37, 2048
    v_mfma_f32_16x16x32_bf16 v[84:87], a[212:215], a[4:7], v[84:87]
    v_mfma_f32_16x16x32_bf16 v[88:91], a[216:219], a[4:7], v[88:91]
    v_mfma_f32_16x16x32_bf16 v[92:95], a[220:223], a[4:7], v[92:95]
    s_waitcnt vmcnt(16)
    s_waitcnt lgkmcnt(0)
    v_mfma_f32_16x16x32_bf16 v[96:99], a[224:227], a[88:91], v[96:99]
    s_add_u32 m0, s18, 8192
    v_mfma_f32_16x16x32_bf16 v[100:103], a[228:231], a[88:91], v[100:103]
    buffer_load_dwordx4 v2, s[44:47], s38 offen lds
    v_mfma_f32_16x16x32_bf16 v[104:107], a[232:235], a[88:91], v[104:107]
    v_mfma_f32_16x16x32_bf16 v[108:111], a[236:239], a[88:91], v[108:111]
    s_add_u32 m0, s18, 9216
    v_mfma_f32_16x16x32_bf16 v[128:131], a[224:227], a[92:95], v[128:131]
    buffer_load_dwordx4 v3, s[44:47], s38 offen lds
    s_add_u32 s38, s38, 65536
    v_mfma_f32_16x16x32_bf16 v[132:135], a[228:231], a[92:95], v[132:135]
    v_mfma_f32_16x16x32_bf16 v[136:139], a[232:235], a[92:95], v[136:139]
    v_mfma_f32_16x16x32_bf16 v[140:143], a[236:239], a[92:95], v[140:143]
    s_add_u32 m0, s19, 36864
    v_mfma_f32_16x16x32_bf16 v[32:35], a[224:227], a[80:83], v[32:35]
    buffer_load_dwordx4 v2, s[44:47], s39 offen lds
    v_mfma_f32_16x16x32_bf16 v[36:39], a[228:231], a[80:83], v[36:39]
    v_mfma_f32_16x16x32_bf16 v[40:43], a[232:235], a[80:83], v[40:43]
    v_mfma_f32_16x16x32_bf16 v[44:47], a[236:239], a[80:83], v[44:47]
    s_add_u32 m0, s19, 37888
    v_mfma_f32_16x16x32_bf16 v[64:67], a[224:227], a[84:87], v[64:67]
    buffer_load_dwordx4 v3, s[44:47], s39 offen lds
    s_add_u32 s39, s39, 65536
    ds_read_b64_tr_b16 a[192:193], v17 offset:36864
    v_mfma_f32_16x16x32_bf16 v[68:71], a[228:231], a[84:87], v[68:71]
    ds_read_b64_tr_b16 a[194:195], v17 offset:37376
    v_mfma_f32_16x16x32_bf16 v[72:75], a[232:235], a[84:87], v[72:75]
    ds_read_b64_tr_b16 a[196:197], v18 offset:36864
    v_mfma_f32_16x16x32_bf16 v[76:79], a[236:239], a[84:87], v[76:79]
    ds_read_b64_tr_b16 a[198:199], v18 offset:37376
    v_mfma_f32_16x16x32_bf16 v[112:115], a[240:243], a[24:27], v[112:115]
    buffer_load_dwordx4 a[128:131], v12, s[28:31], s37 offen offset:0 sc1
    ds_read_b64_tr_b16 a[200:201], v19 offset:36864
    v_mfma_f32_16x16x32_bf16 v[116:119], a[244:247], a[24:27], v[116:119]
    ds_read_b64_tr_b16 a[202:203], v19 offset:37376
    v_mfma_f32_16x16x32_bf16 v[120:123], a[248:251], a[24:27], v[120:123]
    ds_read_b64_tr_b16 a[204:205], v20 offset:36864
    v_mfma_f32_16x16x32_bf16 v[124:127], a[252:255], a[24:27], v[124:127]
    ds_read_b64_tr_b16 a[206:207], v20 offset:37376
    v_mfma_f32_16x16x32_bf16 v[144:147], a[240:243], a[28:31], v[144:147]
    buffer_load_dwordx4 a[132:135], v12, s[28:31], s37 offen offset:256 sc1
    ds_read_b64_tr_b16 a[208:209], v14 offset:16384
    v_mfma_f32_16x16x32_bf16 v[148:151], a[244:247], a[28:31], v[148:151]
    ds_read_b64_tr_b16 a[210:211], v14 offset:16896
    v_mfma_f32_16x16x32_bf16 v[152:155], a[248:251], a[28:31], v[152:155]
    ds_read_b64_tr_b16 a[212:213], v15 offset:16384
    v_mfma_f32_16x16x32_bf16 v[156:159], a[252:255], a[28:31], v[156:159]
    ds_read_b64_tr_b16 a[214:215], v15 offset:16896
    v_mfma_f32_16x16x32_bf16 v[48:51], a[240:243], a[16:19], v[48:51]
    buffer_load_dwordx4 a[136:139], v13, s[28:31], s37 offen offset:0 sc1
    ds_read_b64_tr_b16 a[216:217], v16 offset:16384
    v_mfma_f32_16x16x32_bf16 v[52:55], a[244:247], a[16:19], v[52:55]
    ds_read_b64_tr_b16 a[218:219], v16 offset:16896
    v_mfma_f32_16x16x32_bf16 v[56:59], a[248:251], a[16:19], v[56:59]
    ds_read_b64_tr_b16 a[220:221], v29 offset:16384
    v_mfma_f32_16x16x32_bf16 v[60:63], a[252:255], a[16:19], v[60:63]
    ds_read_b64_tr_b16 a[222:223], v29 offset:16896
    v_mfma_f32_16x16x32_bf16 v[80:83], a[240:243], a[20:23], v[80:83]
    buffer_load_dwordx4 a[140:143], v13, s[28:31], s37 offen offset:256 sc1
    s_add_u32 s37, s37, 2048
    v_mfma_f32_16x16x32_bf16 v[84:87], a[244:247], a[20:23], v[84:87]
    v_mfma_f32_16x16x32_bf16 v[88:91], a[248:251], a[20:23], v[88:91]
    v_mfma_f32_16x16x32_bf16 v[92:95], a[252:255], a[20:23], v[92:95]
    s_waitcnt vmcnt(16)
    s_waitcnt lgkmcnt(0)
    s_barrier
    v_mfma_f32_16x16x32_bf16 v[96:99], a[192:195], a[104:107], v[96:99]
    s_add_u32 m0, s18, 12288
    v_mfma_f32_16x16x32_bf16 v[100:103], a[196:199], a[104:107], v[100:103]
    buffer_load_dwordx4 v2, s[44:47], s38 offen lds
    v_mfma_f32_16x16x32_bf16 v[104:107], a[200:203], a[104:107], v[104:107]
    s_mul_i32 s57, s97, 4352
    s_add_u32 s57, s57, 34816
    v_and_b32 v9, 15, v0
    v_mfma_f32_16x16x32_bf16 v[108:111], a[204:207], a[104:107], v[108:111]
    v_lshl_add_u32 v9, v9, 2, s57
    s_mul_i32 s57, s36, 4352
    s_xor_b32 s58, s35, 16
    s_lshl_b32 s58, s58, 2
    s_add_u32 s58, s58, s57
    s_add_u32 m0, s18, 13312
    v_mfma_f32_16x16x32_bf16 v[128:131], a[192:195], a[108:111], v[128:131]
    v_mov_b32 v1, s58
    v_cmp_gt_u32 vcc, 32, v0
    buffer_load_dwordx4 v3, s[44:47], s38 offen lds
    s_add_u32 s38, s38, 65536
    v_mfma_f32_16x16x32_bf16 v[132:135], a[196:199], a[108:111], v[132:135]
    v_cndmask_b32 v9, v1, v9, vcc
    s_mov_b32 s57, 22020096
    v_mfma_f32_16x16x32_bf16 v[136:139], a[200:203], a[108:111], v[136:139]
    v_lshrrev_b32 v21, 4, v0
    v_lshlrev_b32 v21, 14, v21
    v_mfma_f32_16x16x32_bf16 v[140:143], a[204:207], a[108:111], v[140:143]
    v_and_b32 v22, 15, v0
    v_lshl_add_u32 v21, v22, 3, v21
    s_add_u32 m0, s19, 24576
    v_mfma_f32_16x16x32_bf16 v[32:35], a[192:195], a[96:99], v[32:35]
    s_lshl_b32 s60, s96, 7
    s_lshl_b32 s61, s32, 5
    s_add_u32 s60, s60, s61
    buffer_load_dwordx4 v2, s[44:47], s39 offen lds
    v_mfma_f32_16x16x32_bf16 v[36:39], a[196:199], a[96:99], v[36:39]
    s_lshl_b32 s61, s97, 18
    s_lshl_b32 s62, s60, 3
    s_add_u32 s61, s61, s62
    s_add_u32 s61, s61, 16777216
    v_mfma_f32_16x16x32_bf16 v[40:43], a[200:203], a[96:99], v[40:43]
    v_mfma_f32_16x16x32_bf16 v[44:47], a[204:207], a[96:99], v[44:47]
    s_add_u32 m0, s19, 25600
    v_mfma_f32_16x16x32_bf16 v[64:67], a[192:195], a[100:103], v[64:67]
    buffer_load_dwordx4 v3, s[44:47], s39 offen lds
    s_add_u32 s39, s39, 65536
    ds_read_b64_tr_b16 a[224:225], v17 offset:24576
    v_mfma_f32_16x16x32_bf16 v[68:71], a[196:199], a[100:103], v[68:71]
    ds_read_b64_tr_b16 a[226:227], v17 offset:25088
    v_mfma_f32_16x16x32_bf16 v[72:75], a[200:203], a[100:103], v[72:75]
    ds_read_b64_tr_b16 a[228:229], v18 offset:24576
    v_mfma_f32_16x16x32_bf16 v[76:79], a[204:207], a[100:103], v[76:79]
    ds_read_b64_tr_b16 a[230:231], v18 offset:25088
    v_mfma_f32_16x16x32_bf16 v[112:115], a[208:211], a[40:43], v[112:115]
    buffer_load_dwordx4 a[144:147], v12, s[28:31], s37 offen offset:0 sc1
    ds_read_b64_tr_b16 a[232:233], v19 offset:24576
    v_mfma_f32_16x16x32_bf16 v[116:119], a[212:215], a[40:43], v[116:119]
    ds_read_b64_tr_b16 a[234:235], v19 offset:25088
    v_mfma_f32_16x16x32_bf16 v[120:123], a[216:219], a[40:43], v[120:123]
    ds_read_b64_tr_b16 a[236:237], v20 offset:24576
    v_mfma_f32_16x16x32_bf16 v[124:127], a[220:223], a[40:43], v[124:127]
    ds_read_b64_tr_b16 a[238:239], v20 offset:25088
    v_mfma_f32_16x16x32_bf16 v[144:147], a[208:211], a[44:47], v[144:147]
    buffer_load_dwordx4 a[148:151], v12, s[28:31], s37 offen offset:256 sc1
    ds_read_b64_tr_b16 a[240:241], v14 offset:20480
    v_mfma_f32_16x16x32_bf16 v[148:151], a[212:215], a[44:47], v[148:151]
    ds_read_b64_tr_b16 a[242:243], v14 offset:20992
    v_mfma_f32_16x16x32_bf16 v[152:155], a[216:219], a[44:47], v[152:155]
    ds_read_b64_tr_b16 a[244:245], v15 offset:20480
    v_mfma_f32_16x16x32_bf16 v[156:159], a[220:223], a[44:47], v[156:159]
    ds_read_b64_tr_b16 a[246:247], v15 offset:20992
    v_mfma_f32_16x16x32_bf16 v[48:51], a[208:211], a[32:35], v[48:51]
    buffer_load_dwordx4 a[152:155], v13, s[28:31], s37 offen offset:0 sc1
    ds_read_b64_tr_b16 a[248:249], v16 offset:20480
    v_mfma_f32_16x16x32_bf16 v[52:55], a[212:215], a[32:35], v[52:55]
    ds_read_b64_tr_b16 a[250:251], v16 offset:20992
    v_mfma_f32_16x16x32_bf16 v[56:59], a[216:219], a[32:35], v[56:59]
    ds_read_b64_tr_b16 a[252:253], v29 offset:20480
    v_mfma_f32_16x16x32_bf16 v[60:63], a[220:223], a[32:35], v[60:63]
    ds_read_b64_tr_b16 a[254:255], v29 offset:20992
    v_mfma_f32_16x16x32_bf16 v[80:83], a[208:211], a[36:39], v[80:83]
    buffer_load_dwordx4 a[156:159], v13, s[28:31], s37 offen offset:256 sc1
    s_add_u32 s37, s37, 2048
    v_mfma_f32_16x16x32_bf16 v[84:87], a[212:215], a[36:39], v[84:87]
    v_mfma_f32_16x16x32_bf16 v[88:91], a[216:219], a[36:39], v[88:91]
    v_mfma_f32_16x16x32_bf16 v[92:95], a[220:223], a[36:39], v[92:95]
    s_waitcnt vmcnt(16)
    s_waitcnt lgkmcnt(0)
    v_mfma_f32_16x16x32_bf16 v[96:99], a[224:227], a[120:123], v[96:99]
    s_add_u32 m0, s18, 16384
    v_mfma_f32_16x16x32_bf16 v[100:103], a[228:231], a[120:123], v[100:103]
    buffer_load_dwordx4 v2, s[44:47], s38 offen lds
    v_mfma_f32_16x16x32_bf16 v[104:107], a[232:235], a[120:123], v[104:107]
    v_lshlrev_b32 v23, 2, v22
    s_lshl_b32 s62, s60, 2
    s_add_u32 s62, s62, 20971520
    v_mfma_f32_16x16x32_bf16 v[108:111], a[236:239], a[120:123], v[108:111]
    s_and_b32 s58, s32, 1
    s_mul_i32 s58, s58, 40960
    s_lshr_b32 s59, s32, 1
    s_lshl_b32 s59, s59, 13
    s_add_u32 m0, s18, 17408
    v_mfma_f32_16x16x32_bf16 v[128:131], a[224:227], a[124:127], v[128:131]
    v_add_u32 v25, s59, v6
    s_sub_u32 s59, 40960, s58
    buffer_load_dwordx4 v3, s[44:47], s38 offen lds
    s_add_u32 s38, s38, 65536
    v_mfma_f32_16x16x32_bf16 v[132:135], a[228:231], a[124:127], v[132:135]
    v_add_u32 v24, s59, v25
    v_add_u32 v25, s58, v25
    v_mfma_f32_16x16x32_bf16 v[136:139], a[232:235], a[124:127], v[136:139]
    v_lshlrev_b32 v27, 11, v22
    v_bfe_u32 v28, v0, 4, 1
    v_mfma_f32_16x16x32_bf16 v[140:143], a[236:239], a[124:127], v[140:143]
    v_lshl_add_u32 v27, v28, 5, v27
    v_lshrrev_b32 v28, 5, v0
    s_add_u32 m0, s19, 0
    v_mfma_f32_16x16x32_bf16 v[32:35], a[224:227], a[112:115], v[32:35]
    v_lshl_add_u32 v27, v28, 4, v27
    buffer_load_dwordx4 v2, s[44:47], s39 offen lds
    v_mfma_f32_16x16x32_bf16 v[36:39], a[228:231], a[112:115], v[36:39]
    s_lshl_b32 s63, s60, 11
    s_lshl_b32 s58, s97, 7
    s_add_u32 s63, s63, s58
    s_add_u32 s56, s63, 0x8000
    v_mfma_f32_16x16x32_bf16 v[40:43], a[232:235], a[112:115], v[40:43]
    v_mfma_f32_16x16x32_bf16 v[44:47], a[236:239], a[112:115], v[44:47]
    s_add_u32 m0, s19, 1024
    v_mfma_f32_16x16x32_bf16 v[64:67], a[224:227], a[116:119], v[64:67]
    buffer_load_dwordx4 v3, s[44:47], s39 offen lds
    s_add_u32 s39, s39, 65536
    ds_read_b64_tr_b16 a[192:193], v17 offset:0
    v_mfma_f32_16x16x32_bf16 v[68:71], a[228:231], a[116:119], v[68:71]
    ds_read_b64_tr_b16 a[194:195], v17 offset:512
    v_mfma_f32_16x16x32_bf16 v[72:75], a[232:235], a[116:119], v[72:75]
    ds_read_b64_tr_b16 a[196:197], v18 offset:0
    v_mfma_f32_16x16x32_bf16 v[76:79], a[236:239], a[116:119], v[76:79]
    ds_read_b64_tr_b16 a[198:199], v18 offset:512
    v_mfma_f32_16x16x32_bf16 v[112:115], a[240:243], a[56:59], v[112:115]
    buffer_load_dwordx4 a[160:163], v12, s[28:31], s37 offen offset:0 sc1
    ds_read_b64_tr_b16 a[200:201], v19 offset:0
    v_mfma_f32_16x16x32_bf16 v[116:119], a[244:247], a[56:59], v[116:119]
    ds_read_b64_tr_b16 a[202:203], v19 offset:512
    v_mfma_f32_16x16x32_bf16 v[120:123], a[248:251], a[56:59], v[120:123]
    ds_read_b64_tr_b16 a[204:205], v20 offset:0
    v_mfma_f32_16x16x32_bf16 v[124:127], a[252:255], a[56:59], v[124:127]
    ds_read_b64_tr_b16 a[206:207], v20 offset:512
    v_mfma_f32_16x16x32_bf16 v[144:147], a[240:243], a[60:63], v[144:147]
    buffer_load_dwordx4 a[164:167], v12, s[28:31], s37 offen offset:256 sc1
    ds_read_b64_tr_b16 a[208:209], v14 offset:28672
    v_mfma_f32_16x16x32_bf16 v[148:151], a[244:247], a[60:63], v[148:151]
    ds_read_b64_tr_b16 a[210:211], v14 offset:29184
    v_mfma_f32_16x16x32_bf16 v[152:155], a[248:251], a[60:63], v[152:155]
    ds_read_b64_tr_b16 a[212:213], v15 offset:28672
    v_mfma_f32_16x16x32_bf16 v[156:159], a[252:255], a[60:63], v[156:159]
    ds_read_b64_tr_b16 a[214:215], v15 offset:29184
    v_mfma_f32_16x16x32_bf16 v[48:51], a[240:243], a[48:51], v[48:51]
    buffer_load_dwordx4 a[168:171], v13, s[28:31], s37 offen offset:0 sc1
    ds_read_b64_tr_b16 a[216:217], v16 offset:28672
    v_mfma_f32_16x16x32_bf16 v[52:55], a[244:247], a[48:51], v[52:55]
    ds_read_b64_tr_b16 a[218:219], v16 offset:29184
    v_mfma_f32_16x16x32_bf16 v[56:59], a[248:251], a[48:51], v[56:59]
    ds_read_b64_tr_b16 a[220:221], v29 offset:28672
    v_mfma_f32_16x16x32_bf16 v[60:63], a[252:255], a[48:51], v[60:63]
    ds_read_b64_tr_b16 a[222:223], v29 offset:29184
    v_mfma_f32_16x16x32_bf16 v[80:83], a[240:243], a[52:55], v[80:83]
    buffer_load_dwordx4 a[172:175], v13, s[28:31], s37 offen offset:256 sc1
    s_add_u32 s37, s37, 2048
    v_mfma_f32_16x16x32_bf16 v[84:87], a[244:247], a[52:55], v[84:87]
    v_mfma_f32_16x16x32_bf16 v[88:91], a[248:251], a[52:55], v[88:91]
    v_mfma_f32_16x16x32_bf16 v[92:95], a[252:255], a[52:55], v[92:95]
    s_waitcnt vmcnt(16)
    s_waitcnt lgkmcnt(0)
    s_barrier
    v_mfma_f32_16x16x32_bf16 v[96:99], a[192:195], a[136:139], v[96:99]
    s_add_u32 m0, s18, 20480
    v_mfma_f32_16x16x32_bf16 v[100:103], a[196:199], a[136:139], v[100:103]
    buffer_load_dwordx4 v2, s[44:47], s38 offen lds
    v_mfma_f32_16x16x32_bf16 v[104:107], a[200:203], a[136:139], v[104:107]
    v_mfma_f32_16x16x32_bf16 v[108:111], a[204:207], a[136:139], v[108:111]
    buffer_load_dword v1, v9, s[28:31], s57 offen sc1
    s_add_u32 m0, s18, 21504
    v_mfma_f32_16x16x32_bf16 v[128:131], a[192:195], a[140:143], v[128:131]
    buffer_load_dwordx4 v3, s[44:47], s38 offen lds
    s_add_u32 s38, s38, 65536
    v_mfma_f32_16x16x32_bf16 v[132:135], a[196:199], a[140:143], v[132:135]
    v_mfma_f32_16x16x32_bf16 v[136:139], a[200:203], a[140:143], v[136:139]
    v_mfma_f32_16x16x32_bf16 v[140:143], a[204:207], a[140:143], v[140:143]
    s_add_u32 m0, s19, 4096
    v_mfma_f32_16x16x32_bf16 v[32:35], a[192:195], a[128:131], v[32:35]
    buffer_load_dwordx4 v2, s[44:47], s39 offen lds
    v_mfma_f32_16x16x32_bf16 v[36:39], a[196:199], a[128:131], v[36:39]
    v_mfma_f32_16x16x32_bf16 v[40:43], a[200:203], a[128:131], v[40:43]
    v_mfma_f32_16x16x32_bf16 v[44:47], a[204:207], a[128:131], v[44:47]
    s_add_u32 m0, s19, 5120
    v_mfma_f32_16x16x32_bf16 v[64:67], a[192:195], a[132:135], v[64:67]
    buffer_load_dwordx4 v3, s[44:47], s39 offen lds
    s_add_u32 s39, s39, 65536
    ds_read_b64_tr_b16 a[224:225], v17 offset:4096
    v_mfma_f32_16x16x32_bf16 v[68:71], a[196:199], a[132:135], v[68:71]
    ds_read_b64_tr_b16 a[226:227], v17 offset:4608
    v_mfma_f32_16x16x32_bf16 v[72:75], a[200:203], a[132:135], v[72:75]
    ds_read_b64_tr_b16 a[228:229], v18 offset:4096
    v_mfma_f32_16x16x32_bf16 v[76:79], a[204:207], a[132:135], v[76:79]
    ds_read_b64_tr_b16 a[230:231], v18 offset:4608
    v_mfma_f32_16x16x32_bf16 v[112:115], a[208:211], a[72:75], v[112:115]
    buffer_load_dwordx4 a[176:179], v12, s[28:31], s37 offen offset:0 sc1
    ds_read_b64_tr_b16 a[232:233], v19 offset:4096
    v_mfma_f32_16x16x32_bf16 v[116:119], a[212:215], a[72:75], v[116:119]
    ds_read_b64_tr_b16 a[234:235], v19 offset:4608
    v_mfma_f32_16x16x32_bf16 v[120:123], a[216:219], a[72:75], v[120:123]
    ds_read_b64_tr_b16 a[236:237], v20 offset:4096
    v_mfma_f32_16x16x32_bf16 v[124:127], a[220:223], a[72:75], v[124:127]
    ds_read_b64_tr_b16 a[238:239], v20 offset:4608
    v_mfma_f32_16x16x32_bf16 v[144:147], a[208:211], a[76:79], v[144:147]
    buffer_load_dwordx4 a[180:183], v12, s[28:31], s37 offen offset:256 sc1
    ds_read_b64_tr_b16 a[240:241], v14 offset:32768
    v_mfma_f32_16x16x32_bf16 v[148:151], a[212:215], a[76:79], v[148:151]
    ds_read_b64_tr_b16 a[242:243], v14 offset:33280
    v_mfma_f32_16x16x32_bf16 v[152:155], a[216:219], a[76:79], v[152:155]
    ds_read_b64_tr_b16 a[244:245], v15 offset:32768
    v_mfma_f32_16x16x32_bf16 v[156:159], a[220:223], a[76:79], v[156:159]
    ds_read_b64_tr_b16 a[246:247], v15 offset:33280
    v_mfma_f32_16x16x32_bf16 v[48:51], a[208:211], a[64:67], v[48:51]
    buffer_load_dwordx4 a[184:187], v13, s[28:31], s37 offen offset:0 sc1
    ds_read_b64_tr_b16 a[248:249], v16 offset:32768
    v_mfma_f32_16x16x32_bf16 v[52:55], a[212:215], a[64:67], v[52:55]
    ds_read_b64_tr_b16 a[250:251], v16 offset:33280
    v_mfma_f32_16x16x32_bf16 v[56:59], a[216:219], a[64:67], v[56:59]
    ds_read_b64_tr_b16 a[252:253], v29 offset:32768
    v_mfma_f32_16x16x32_bf16 v[60:63], a[220:223], a[64:67], v[60:63]
    ds_read_b64_tr_b16 a[254:255], v29 offset:33280
    v_mfma_f32_16x16x32_bf16 v[80:83], a[208:211], a[68:71], v[80:83]
    buffer_load_dwordx4 a[188:191], v13, s[28:31], s37 offen offset:256 sc1
    s_add_u32 s37, s37, 2048
    v_mfma_f32_16x16x32_bf16 v[84:87], a[212:215], a[68:71], v[84:87]
    v_mfma_f32_16x16x32_bf16 v[88:91], a[216:219], a[68:71], v[88:91]
    v_mfma_f32_16x16x32_bf16 v[92:95], a[220:223], a[68:71], v[92:95]
    s_waitcnt vmcnt(17)
    s_waitcnt lgkmcnt(0)
    v_mfma_f32_16x16x32_bf16 v[96:99], a[224:227], a[152:155], v[96:99]
    s_add_u32 m0, s18, 28672
    v_mfma_f32_16x16x32_bf16 v[100:103], a[228:231], a[152:155], v[100:103]
    buffer_load_dwordx4 v2, s[44:47], s38 offen lds
    v_mfma_f32_16x16x32_bf16 v[104:107], a[232:235], a[152:155], v[104:107]
    v_mfma_f32_16x16x32_bf16 v[108:111], a[236:239], a[152:155], v[108:111]
    s_add_u32 m0, s18, 29696
    v_mfma_f32_16x16x32_bf16 v[128:131], a[224:227], a[156:159], v[128:131]
    buffer_load_dwordx4 v3, s[44:47], s38 offen lds
    s_add_u32 s38, s38, 65536
    v_mfma_f32_16x16x32_bf16 v[132:135], a[228:231], a[156:159], v[132:135]
    v_mfma_f32_16x16x32_bf16 v[136:139], a[232:235], a[156:159], v[136:139]
    v_mfma_f32_16x16x32_bf16 v[140:143], a[236:239], a[156:159], v[140:143]
    s_add_u32 m0, s19, 8192
    v_mfma_f32_16x16x32_bf16 v[32:35], a[224:227], a[144:147], v[32:35]
    buffer_load_dwordx4 v2, s[44:47], s39 offen lds
    v_mfma_f32_16x16x32_bf16 v[36:39], a[228:231], a[144:147], v[36:39]
    v_mfma_f32_16x16x32_bf16 v[40:43], a[232:235], a[144:147], v[40:43]
    v_mfma_f32_16x16x32_bf16 v[44:47], a[236:239], a[144:147], v[44:47]
    s_add_u32 m0, s19, 9216
    v_mfma_f32_16x16x32_bf16 v[64:67], a[224:227], a[148:151], v[64:67]
    buffer_load_dwordx4 v3, s[44:47], s39 offen lds
    s_add_u32 s39, s39, 65536
    ds_read_b64_tr_b16 a[192:193], v17 offset:8192
    v_mfma_f32_16x16x32_bf16 v[68:71], a[228:231], a[148:151], v[68:71]
    ds_read_b64_tr_b16 a[194:195], v17 offset:8704
    v_mfma_f32_16x16x32_bf16 v[72:75], a[232:235], a[148:151], v[72:75]
    ds_read_b64_tr_b16 a[196:197], v18 offset:8192
    v_mfma_f32_16x16x32_bf16 v[76:79], a[236:239], a[148:151], v[76:79]
    ds_read_b64_tr_b16 a[198:199], v18 offset:8704
    v_mfma_f32_16x16x32_bf16 v[112:115], a[240:243], a[88:91], v[112:115]
    buffer_load_dwordx4 a[0:3], v12, s[28:31], s37 offen offset:0 sc1
    ds_read_b64_tr_b16 a[200:201], v19 offset:8192
    v_mfma_f32_16x16x32_bf16 v[116:119], a[244:247], a[88:91], v[116:119]
    ds_read_b64_tr_b16 a[202:203], v19 offset:8704
    v_mfma_f32_16x16x32_bf16 v[120:123], a[248:251], a[88:91], v[120:123]
    ds_read_b64_tr_b16 a[204:205], v20 offset:8192
    v_mfma_f32_16x16x32_bf16 v[124:127], a[252:255], a[88:91], v[124:127]
    ds_read_b64_tr_b16 a[206:207], v20 offset:8704
    v_mfma_f32_16x16x32_bf16 v[144:147], a[240:243], a[92:95], v[144:147]
    buffer_load_dwordx4 a[4:7], v12, s[28:31], s37 offen offset:256 sc1
    ds_read_b64_tr_b16 a[208:209], v14 offset:36864
    v_mfma_f32_16x16x32_bf16 v[148:151], a[244:247], a[92:95], v[148:151]
    ds_read_b64_tr_b16 a[210:211], v14 offset:37376
    v_mfma_f32_16x16x32_bf16 v[152:155], a[248:251], a[92:95], v[152:155]
    ds_read_b64_tr_b16 a[212:213], v15 offset:36864
    v_mfma_f32_16x16x32_bf16 v[156:159], a[252:255], a[92:95], v[156:159]
    ds_read_b64_tr_b16 a[214:215], v15 offset:37376
    v_mfma_f32_16x16x32_bf16 v[48:51], a[240:243], a[80:83], v[48:51]
    buffer_load_dwordx4 a[8:11], v13, s[28:31], s37 offen offset:0 sc1
    ds_read_b64_tr_b16 a[216:217], v16 offset:36864
    v_mfma_f32_16x16x32_bf16 v[52:55], a[244:247], a[80:83], v[52:55]
    ds_read_b64_tr_b16 a[218:219], v16 offset:37376
    v_mfma_f32_16x16x32_bf16 v[56:59], a[248:251], a[80:83], v[56:59]
    ds_read_b64_tr_b16 a[220:221], v29 offset:36864
    v_mfma_f32_16x16x32_bf16 v[60:63], a[252:255], a[80:83], v[60:63]
    ds_read_b64_tr_b16 a[222:223], v29 offset:37376
    v_mfma_f32_16x16x32_bf16 v[80:83], a[240:243], a[84:87], v[80:83]
    buffer_load_dwordx4 a[12:15], v13, s[28:31], s37 offen offset:256 sc1
    s_add_u32 s37, s37, 2048
    v_mfma_f32_16x16x32_bf16 v[84:87], a[244:247], a[84:87], v[84:87]
    v_mfma_f32_16x16x32_bf16 v[88:91], a[248:251], a[84:87], v[88:91]
    v_mfma_f32_16x16x32_bf16 v[92:95], a[252:255], a[84:87], v[92:95]
    s_waitcnt vmcnt(17)
    s_waitcnt lgkmcnt(0)
    s_barrier
    v_mfma_f32_16x16x32_bf16 v[96:99], a[192:195], a[168:171], v[96:99]
    s_add_u32 m0, s18, 32768
    v_mfma_f32_16x16x32_bf16 v[100:103], a[196:199], a[168:171], v[100:103]
    buffer_load_dwordx4 v2, s[44:47], s38 offen lds
    v_mfma_f32_16x16x32_bf16 v[104:107], a[200:203], a[168:171], v[104:107]
    v_mfma_f32_16x16x32_bf16 v[108:111], a[204:207], a[168:171], v[108:111]
    s_add_u32 m0, s18, 33792
    v_mfma_f32_16x16x32_bf16 v[128:131], a[192:195], a[172:175], v[128:131]
    buffer_load_dwordx4 v3, s[44:47], s38 offen lds
    s_add_u32 s38, s38, 65536
    v_mfma_f32_16x16x32_bf16 v[132:135], a[196:199], a[172:175], v[132:135]
    v_mfma_f32_16x16x32_bf16 v[136:139], a[200:203], a[172:175], v[136:139]
    v_mfma_f32_16x16x32_bf16 v[140:143], a[204:207], a[172:175], v[140:143]
    s_add_u32 m0, s19, 12288
    v_mfma_f32_16x16x32_bf16 v[32:35], a[192:195], a[160:163], v[32:35]
    buffer_load_dwordx4 v2, s[44:47], s39 offen lds
    v_mfma_f32_16x16x32_bf16 v[36:39], a[196:199], a[160:163], v[36:39]
    v_mfma_f32_16x16x32_bf16 v[40:43], a[200:203], a[160:163], v[40:43]
    v_mfma_f32_16x16x32_bf16 v[44:47], a[204:207], a[160:163], v[44:47]
    s_add_u32 m0, s19, 13312
    v_mfma_f32_16x16x32_bf16 v[64:67], a[192:195], a[164:167], v[64:67]
    buffer_load_dwordx4 v3, s[44:47], s39 offen lds
    s_add_u32 s39, s39, 65536
    ds_read_b64_tr_b16 a[224:225], v17 offset:12288
    v_mfma_f32_16x16x32_bf16 v[68:71], a[196:199], a[164:167], v[68:71]
    ds_read_b64_tr_b16 a[226:227], v17 offset:12800
    v_mfma_f32_16x16x32_bf16 v[72:75], a[200:203], a[164:167], v[72:75]
    ds_read_b64_tr_b16 a[228:229], v18 offset:12288
    v_mfma_f32_16x16x32_bf16 v[76:79], a[204:207], a[164:167], v[76:79]
    ds_read_b64_tr_b16 a[230:231], v18 offset:12800
    v_mfma_f32_16x16x32_bf16 v[112:115], a[208:211], a[104:107], v[112:115]
    buffer_load_dwordx4 a[16:19], v12, s[28:31], s37 offen offset:0 sc1
    ds_read_b64_tr_b16 a[232:233], v19 offset:12288
    v_mfma_f32_16x16x32_bf16 v[116:119], a[212:215], a[104:107], v[116:119]
    ds_read_b64_tr_b16 a[234:235], v19 offset:12800
    v_mfma_f32_16x16x32_bf16 v[120:123], a[216:219], a[104:107], v[120:123]
    ds_read_b64_tr_b16 a[236:237], v20 offset:12288
    v_mfma_f32_16x16x32_bf16 v[124:127], a[220:223], a[104:107], v[124:127]
    ds_read_b64_tr_b16 a[238:239], v20 offset:12800
    v_mfma_f32_16x16x32_bf16 v[144:147], a[208:211], a[108:111], v[144:147]
    buffer_load_dwordx4 a[20:23], v12, s[28:31], s37 offen offset:256 sc1
    ds_read_b64_tr_b16 a[240:241], v14 offset:24576
    v_mfma_f32_16x16x32_bf16 v[148:151], a[212:215], a[108:111], v[148:151]
    ds_read_b64_tr_b16 a[242:243], v14 offset:25088
    v_mfma_f32_16x16x32_bf16 v[152:155], a[216:219], a[108:111], v[152:155]
    ds_read_b64_tr_b16 a[244:245], v15 offset:24576
    v_mfma_f32_16x16x32_bf16 v[156:159], a[220:223], a[108:111], v[156:159]
    ds_read_b64_tr_b16 a[246:247], v15 offset:25088
    v_mfma_f32_16x16x32_bf16 v[48:51], a[208:211], a[96:99], v[48:51]
    buffer_load_dwordx4 a[24:27], v13, s[28:31], s37 offen offset:0 sc1
    ds_read_b64_tr_b16 a[248:249], v16 offset:24576
    v_mfma_f32_16x16x32_bf16 v[52:55], a[212:215], a[96:99], v[52:55]
    ds_read_b64_tr_b16 a[250:251], v16 offset:25088
    v_mfma_f32_16x16x32_bf16 v[56:59], a[216:219], a[96:99], v[56:59]
    ds_read_b64_tr_b16 a[252:253], v29 offset:24576
    v_mfma_f32_16x16x32_bf16 v[60:63], a[220:223], a[96:99], v[60:63]
    ds_read_b64_tr_b16 a[254:255], v29 offset:25088
    v_mfma_f32_16x16x32_bf16 v[80:83], a[208:211], a[100:103], v[80:83]
    buffer_load_dwordx4 a[28:31], v13, s[28:31], s37 offen offset:256 sc1
    s_add_u32 s37, s37, 2048
    v_mfma_f32_16x16x32_bf16 v[84:87], a[212:215], a[100:103], v[84:87]
    v_mfma_f32_16x16x32_bf16 v[88:91], a[216:219], a[100:103], v[88:91]
    v_mfma_f32_16x16x32_bf16 v[92:95], a[220:223], a[100:103], v[92:95]
    s_waitcnt vmcnt(16)
    s_waitcnt lgkmcnt(0)
    v_mfma_f32_16x16x32_bf16 v[96:99], a[224:227], a[184:187], v[96:99]
    s_add_u32 m0, s19, 16384
    v_mfma_f32_16x16x32_bf16 v[100:103], a[228:231], a[184:187], v[100:103]
    buffer_load_dwordx4 v2, s[44:47], s39 offen lds
    v_mfma_f32_16x16x32_bf16 v[104:107], a[232:235], a[184:187], v[104:107]
    v_mfma_f32_16x16x32_bf16 v[108:111], a[236:239], a[184:187], v[108:111]
    v_mfma_f32_16x16x32_bf16 v[128:131], a[224:227], a[188:191], v[128:131]
    v_mfma_f32_16x16x32_bf16 v[132:135], a[228:231], a[188:191], v[132:135]
    s_add_u32 m0, s19, 17408
    v_mfma_f32_16x16x32_bf16 v[136:139], a[232:235], a[188:191], v[136:139]
    buffer_load_dwordx4 v3, s[44:47], s39 offen lds
    s_add_u32 s39, s39, 65536
    v_mfma_f32_16x16x32_bf16 v[140:143], a[236:239], a[188:191], v[140:143]
    v_mfma_f32_16x16x32_bf16 v[32:35], a[224:227], a[176:179], v[32:35]
    v_mfma_f32_16x16x32_bf16 v[36:39], a[228:231], a[176:179], v[36:39]
    v_mfma_f32_16x16x32_bf16 v[40:43], a[232:235], a[176:179], v[40:43]
    v_mfma_f32_16x16x32_bf16 v[44:47], a[236:239], a[176:179], v[44:47]
    buffer_load_dwordx4 a[32:35], v12, s[28:31], s37 offen offset:0 sc1
    v_mfma_f32_16x16x32_bf16 v[64:67], a[224:227], a[180:183], v[64:67]
    ds_read_b64_tr_b16 a[192:193], v17 offset:16384
    v_mfma_f32_16x16x32_bf16 v[68:71], a[228:231], a[180:183], v[68:71]
    ds_read_b64_tr_b16 a[194:195], v17 offset:16896
    v_mfma_f32_16x16x32_bf16 v[72:75], a[232:235], a[180:183], v[72:75]
    ds_read_b64_tr_b16 a[196:197], v18 offset:16384
    v_mfma_f32_16x16x32_bf16 v[76:79], a[236:239], a[180:183], v[76:79]
    ds_read_b64_tr_b16 a[198:199], v18 offset:16896
    v_mfma_f32_16x16x32_bf16 v[112:115], a[240:243], a[120:123], v[112:115]
    buffer_load_dwordx4 a[36:39], v12, s[28:31], s37 offen offset:256 sc1
    ds_read_b64_tr_b16 a[200:201], v19 offset:16384
    v_mfma_f32_16x16x32_bf16 v[116:119], a[244:247], a[120:123], v[116:119]
    ds_read_b64_tr_b16 a[202:203], v19 offset:16896
    v_mfma_f32_16x16x32_bf16 v[120:123], a[248:251], a[120:123], v[120:123]
    ds_read_b64_tr_b16 a[204:205], v20 offset:16384
    v_mfma_f32_16x16x32_bf16 v[124:127], a[252:255], a[120:123], v[124:127]
    ds_read_b64_tr_b16 a[206:207], v20 offset:16896
    v_mfma_f32_16x16x32_bf16 v[144:147], a[240:243], a[124:127], v[144:147]
    ds_read_b64_tr_b16 a[208:209], v14 offset:0
    v_mfma_f32_16x16x32_bf16 v[148:151], a[244:247], a[124:127], v[148:151]
    buffer_load_dwordx4 a[40:43], v13, s[28:31], s37 offen offset:0 sc1
    ds_read_b64_tr_b16 a[210:211], v14 offset:512
    v_mfma_f32_16x16x32_bf16 v[152:155], a[248:251], a[124:127], v[152:155]
    ds_read_b64_tr_b16 a[212:213], v15 offset:0
    v_mfma_f32_16x16x32_bf16 v[156:159], a[252:255], a[124:127], v[156:159]
    ds_read_b64_tr_b16 a[214:215], v15 offset:512
    v_mfma_f32_16x16x32_bf16 v[48:51], a[240:243], a[112:115], v[48:51]
    ds_read_b64_tr_b16 a[216:217], v16 offset:0
    v_mfma_f32_16x16x32_bf16 v[52:55], a[244:247], a[112:115], v[52:55]
    ds_read_b64_tr_b16 a[218:219], v16 offset:512
    v_mfma_f32_16x16x32_bf16 v[56:59], a[248:251], a[112:115], v[56:59]
    buffer_load_dwordx4 a[44:47], v13, s[28:31], s37 offen offset:256 sc1
    s_add_u32 s37, s37, 2048
    ds_read_b64_tr_b16 a[220:221], v29 offset:0
    v_mfma_f32_16x16x32_bf16 v[60:63], a[252:255], a[112:115], v[60:63]
    ds_read_b64_tr_b16 a[222:223], v29 offset:512
    v_mfma_f32_16x16x32_bf16 v[80:83], a[240:243], a[116:119], v[80:83]
    v_mfma_f32_16x16x32_bf16 v[84:87], a[244:247], a[116:119], v[84:87]
    v_mfma_f32_16x16x32_bf16 v[88:91], a[248:251], a[116:119], v[88:91]
    v_mfma_f32_16x16x32_bf16 v[92:95], a[252:255], a[116:119], v[92:95]
    s_waitcnt vmcnt(14)
    s_waitcnt lgkmcnt(0)
    s_barrier
    v_mfma_f32_16x16x32_bf16 v[96:99], a[192:195], a[8:11], v[96:99]
    s_add_u32 m0, s19, 20480
    v_mfma_f32_16x16x32_bf16 v[100:103], a[196:199], a[8:11], v[100:103]
    buffer_load_dwordx4 v2, s[44:47], s39 offen lds
    v_mfma_f32_16x16x32_bf16 v[104:107], a[200:203], a[8:11], v[104:107]
    v_mfma_f32_16x16x32_bf16 v[108:111], a[204:207], a[8:11], v[108:111]
    v_mfma_f32_16x16x32_bf16 v[128:131], a[192:195], a[12:15], v[128:131]
    v_mfma_f32_16x16x32_bf16 v[132:135], a[196:199], a[12:15], v[132:135]
    s_add_u32 m0, s19, 21504
    v_mfma_f32_16x16x32_bf16 v[136:139], a[200:203], a[12:15], v[136:139]
    buffer_load_dwordx4 v3, s[44:47], s39 offen lds
    s_add_u32 s39, s39, 65536
    v_mfma_f32_16x16x32_bf16 v[140:143], a[204:207], a[12:15], v[140:143]
    v_mfma_f32_16x16x32_bf16 v[32:35], a[192:195], a[0:3], v[32:35]
    v_mfma_f32_16x16x32_bf16 v[36:39], a[196:199], a[0:3], v[36:39]
    v_mfma_f32_16x16x32_bf16 v[40:43], a[200:203], a[0:3], v[40:43]
    v_mfma_f32_16x16x32_bf16 v[44:47], a[204:207], a[0:3], v[44:47]
    buffer_load_dwordx4 a[48:51], v12, s[28:31], s37 offen offset:0 sc1
    v_mfma_f32_16x16x32_bf16 v[64:67], a[192:195], a[4:7], v[64:67]
    ds_read_b64_tr_b16 a[224:225], v17 offset:20480
    v_mfma_f32_16x16x32_bf16 v[68:71], a[196:199], a[4:7], v[68:71]
    ds_read_b64_tr_b16 a[226:227], v17 offset:20992
    v_mfma_f32_16x16x32_bf16 v[72:75], a[200:203], a[4:7], v[72:75]
    ds_read_b64_tr_b16 a[228:229], v18 offset:20480
    v_mfma_f32_16x16x32_bf16 v[76:79], a[204:207], a[4:7], v[76:79]
    ds_read_b64_tr_b16 a[230:231], v18 offset:20992
    v_mfma_f32_16x16x32_bf16 v[112:115], a[208:211], a[136:139], v[112:115]
    buffer_load_dwordx4 a[52:55], v12, s[28:31], s37 offen offset:256 sc1
    ds_read_b64_tr_b16 a[232:233], v19 offset:20480
    v_mfma_f32_16x16x32_bf16 v[116:119], a[212:215], a[136:139], v[116:119]
    ds_read_b64_tr_b16 a[234:235], v19 offset:20992
    v_mfma_f32_16x16x32_bf16 v[120:123], a[216:219], a[136:139], v[120:123]
    ds_read_b64_tr_b16 a[236:237], v20 offset:20480
    v_mfma_f32_16x16x32_bf16 v[124:127], a[220:223], a[136:139], v[124:127]
    ds_read_b64_tr_b16 a[238:239], v20 offset:20992
    v_mfma_f32_16x16x32_bf16 v[144:147], a[208:211], a[140:143], v[144:147]
    ds_read_b64_tr_b16 a[240:241], v14 offset:4096
    v_mfma_f32_16x16x32_bf16 v[148:151], a[212:215], a[140:143], v[148:151]
    buffer_load_dwordx4 a[56:59], v13, s[28:31], s37 offen offset:0 sc1
    ds_read_b64_tr_b16 a[242:243], v14 offset:4608
    v_mfma_f32_16x16x32_bf16 v[152:155], a[216:219], a[140:143], v[152:155]
    ds_read_b64_tr_b16 a[244:245], v15 offset:4096
    v_mfma_f32_16x16x32_bf16 v[156:159], a[220:223], a[140:143], v[156:159]
    ds_read_b64_tr_b16 a[246:247], v15 offset:4608
    v_mfma_f32_16x16x32_bf16 v[48:51], a[208:211], a[128:131], v[48:51]
    ds_read_b64_tr_b16 a[248:249], v16 offset:4096
    v_mfma_f32_16x16x32_bf16 v[52:55], a[212:215], a[128:131], v[52:55]
    ds_read_b64_tr_b16 a[250:251], v16 offset:4608
    v_mfma_f32_16x16x32_bf16 v[56:59], a[216:219], a[128:131], v[56:59]
    buffer_load_dwordx4 a[60:63], v13, s[28:31], s37 offen offset:256 sc1
    s_add_u32 s37, s37, 2048
    ds_read_b64_tr_b16 a[252:253], v29 offset:4096
    v_mfma_f32_16x16x32_bf16 v[60:63], a[220:223], a[128:131], v[60:63]
    ds_read_b64_tr_b16 a[254:255], v29 offset:4608
    v_mfma_f32_16x16x32_bf16 v[80:83], a[208:211], a[132:135], v[80:83]
    v_mfma_f32_16x16x32_bf16 v[84:87], a[212:215], a[132:135], v[84:87]
    v_mfma_f32_16x16x32_bf16 v[88:91], a[216:219], a[132:135], v[88:91]
    v_mfma_f32_16x16x32_bf16 v[92:95], a[220:223], a[132:135], v[92:95]
    s_waitcnt vmcnt(12)
    s_waitcnt lgkmcnt(0)
    v_cmp_eq_u32 vcc, 1, v1
    s_nop 1
    s_cmp_eq_u64 vcc, -1
    s_cbranch_scc0 gated_mix__ssm_conv_s4__swiglu_ffn__prompt_kernel_apoll
gated_mix__ssm_conv_s4__swiglu_ffn__prompt_kernel_aok:
    v_mfma_f32_16x16x32_bf16 v[96:99], a[224:227], a[24:27], v[96:99]
    s_add_u32 m0, s19, 28672
    v_mfma_f32_16x16x32_bf16 v[100:103], a[228:231], a[24:27], v[100:103]
    buffer_load_dwordx4 v2, s[44:47], s39 offen lds
    v_mfma_f32_16x16x32_bf16 v[104:107], a[232:235], a[24:27], v[104:107]
    buffer_load_dwordx2 v[160:161], v21, s[28:31], s61 offen offset:0 sc1
    v_mfma_f32_16x16x32_bf16 v[108:111], a[236:239], a[24:27], v[108:111]
    v_mfma_f32_16x16x32_bf16 v[128:131], a[224:227], a[28:31], v[128:131]
    v_mfma_f32_16x16x32_bf16 v[132:135], a[228:231], a[28:31], v[132:135]
    buffer_load_dwordx2 v[168:169], v21, s[28:31], s61 offen offset:128 sc1
    s_add_u32 s61, s61, 65536
    v_mfma_f32_16x16x32_bf16 v[136:139], a[232:235], a[28:31], v[136:139]
    v_mfma_f32_16x16x32_bf16 v[140:143], a[236:239], a[28:31], v[140:143]
    v_mfma_f32_16x16x32_bf16 v[32:35], a[224:227], a[16:19], v[32:35]
    buffer_load_dwordx2 v[162:163], v21, s[28:31], s61 offen offset:0 sc1
    v_mfma_f32_16x16x32_bf16 v[36:39], a[228:231], a[16:19], v[36:39]
    v_mfma_f32_16x16x32_bf16 v[40:43], a[232:235], a[16:19], v[40:43]
    v_mfma_f32_16x16x32_bf16 v[44:47], a[236:239], a[16:19], v[44:47]
    buffer_load_dwordx2 v[170:171], v21, s[28:31], s61 offen offset:128 sc1
    s_add_u32 s61, s61, 65536
    v_mfma_f32_16x16x32_bf16 v[64:67], a[224:227], a[20:23], v[64:67]
    ds_read_b64_tr_b16 a[192:193], v17 offset:28672
    v_mfma_f32_16x16x32_bf16 v[68:71], a[228:231], a[20:23], v[68:71]
    ds_read_b64_tr_b16 a[194:195], v17 offset:29184
    v_mfma_f32_16x16x32_bf16 v[72:75], a[232:235], a[20:23], v[72:75]
    buffer_load_dwordx2 v[164:165], v21, s[28:31], s61 offen offset:0 sc1
    ds_read_b64_tr_b16 a[196:197], v18 offset:28672
    v_mfma_f32_16x16x32_bf16 v[76:79], a[236:239], a[20:23], v[76:79]
    s_add_u32 m0, s19, 29696
    ds_read_b64_tr_b16 a[198:199], v18 offset:29184
    v_mfma_f32_16x16x32_bf16 v[112:115], a[240:243], a[152:155], v[112:115]
    buffer_load_dwordx4 v3, s[44:47], s39 offen lds
    s_add_u32 s39, s39, 65536
    ds_read_b64_tr_b16 a[200:201], v19 offset:28672
    v_mfma_f32_16x16x32_bf16 v[116:119], a[244:247], a[152:155], v[116:119]
    buffer_load_dwordx2 v[172:173], v21, s[28:31], s61 offen offset:128 sc1
    s_add_u32 s61, s61, 65536
    ds_read_b64_tr_b16 a[202:203], v19 offset:29184
    v_mfma_f32_16x16x32_bf16 v[120:123], a[248:251], a[152:155], v[120:123]
    ds_read_b64_tr_b16 a[204:205], v20 offset:28672
    v_mfma_f32_16x16x32_bf16 v[124:127], a[252:255], a[152:155], v[124:127]
    ds_read_b64_tr_b16 a[206:207], v20 offset:29184
    v_mfma_f32_16x16x32_bf16 v[144:147], a[240:243], a[156:159], v[144:147]
    buffer_load_dwordx2 v[166:167], v21, s[28:31], s61 offen offset:0 sc1
    ds_read_b64_tr_b16 a[208:209], v14 offset:8192
    v_mfma_f32_16x16x32_bf16 v[148:151], a[244:247], a[156:159], v[148:151]
    ds_read_b64_tr_b16 a[210:211], v14 offset:8704
    v_mfma_f32_16x16x32_bf16 v[152:155], a[248:251], a[156:159], v[152:155]
    ds_read_b64_tr_b16 a[212:213], v15 offset:8192
    v_mfma_f32_16x16x32_bf16 v[156:159], a[252:255], a[156:159], v[156:159]
    buffer_load_dwordx2 v[174:175], v21, s[28:31], s61 offen offset:128 sc1
    ds_read_b64_tr_b16 a[214:215], v15 offset:8704
    v_mfma_f32_16x16x32_bf16 v[48:51], a[240:243], a[144:147], v[48:51]
    ds_read_b64_tr_b16 a[216:217], v16 offset:8192
    v_mfma_f32_16x16x32_bf16 v[52:55], a[244:247], a[144:147], v[52:55]
    ds_read_b64_tr_b16 a[218:219], v16 offset:8704
    v_mfma_f32_16x16x32_bf16 v[56:59], a[248:251], a[144:147], v[56:59]
    buffer_load_dword v176, v23, s[28:31], s62 offen sc1
    ds_read_b64_tr_b16 a[220:221], v29 offset:8192
    v_mfma_f32_16x16x32_bf16 v[60:63], a[252:255], a[144:147], v[60:63]
    ds_read_b64_tr_b16 a[222:223], v29 offset:8704
    v_mfma_f32_16x16x32_bf16 v[80:83], a[240:243], a[148:151], v[80:83]
    v_mfma_f32_16x16x32_bf16 v[84:87], a[244:247], a[148:151], v[84:87]
    buffer_load_dword v177, v23, s[28:31], s62 offen offset:64 sc1
    v_mfma_f32_16x16x32_bf16 v[88:91], a[248:251], a[148:151], v[88:91]
    v_mfma_f32_16x16x32_bf16 v[92:95], a[252:255], a[148:151], v[92:95]
    s_waitcnt vmcnt(18)
    s_waitcnt lgkmcnt(0)
    s_barrier
    v_mfma_f32_16x16x32_bf16 v[96:99], a[192:195], a[40:43], v[96:99]
    s_add_u32 m0, s19, 32768
    v_mfma_f32_16x16x32_bf16 v[100:103], a[196:199], a[40:43], v[100:103]
    buffer_load_dwordx4 v2, s[44:47], s39 offen lds
    v_mfma_f32_16x16x32_bf16 v[104:107], a[200:203], a[40:43], v[104:107]
    v_mfma_f32_16x16x32_bf16 v[108:111], a[204:207], a[40:43], v[108:111]
    v_mfma_f32_16x16x32_bf16 v[128:131], a[192:195], a[44:47], v[128:131]
    v_mfma_f32_16x16x32_bf16 v[132:135], a[196:199], a[44:47], v[132:135]
    v_mfma_f32_16x16x32_bf16 v[136:139], a[200:203], a[44:47], v[136:139]
    v_mfma_f32_16x16x32_bf16 v[140:143], a[204:207], a[44:47], v[140:143]
    v_mfma_f32_16x16x32_bf16 v[32:35], a[192:195], a[32:35], v[32:35]
    v_mfma_f32_16x16x32_bf16 v[36:39], a[196:199], a[32:35], v[36:39]
    v_mfma_f32_16x16x32_bf16 v[40:43], a[200:203], a[32:35], v[40:43]
    v_mfma_f32_16x16x32_bf16 v[44:47], a[204:207], a[32:35], v[44:47]
    v_mfma_f32_16x16x32_bf16 v[64:67], a[192:195], a[36:39], v[64:67]
    ds_read_b64_tr_b16 a[224:225], v17 offset:32768
    v_mfma_f32_16x16x32_bf16 v[68:71], a[196:199], a[36:39], v[68:71]
    ds_read_b64_tr_b16 a[226:227], v17 offset:33280
    v_mfma_f32_16x16x32_bf16 v[72:75], a[200:203], a[36:39], v[72:75]
    ds_read_b64_tr_b16 a[228:229], v18 offset:32768
    v_mfma_f32_16x16x32_bf16 v[76:79], a[204:207], a[36:39], v[76:79]
    s_add_u32 m0, s19, 33792
    ds_read_b64_tr_b16 a[230:231], v18 offset:33280
    v_mfma_f32_16x16x32_bf16 v[112:115], a[208:211], a[168:171], v[112:115]
    buffer_load_dwordx4 v3, s[44:47], s39 offen lds
    s_add_u32 s39, s39, 65536
    ds_read_b64_tr_b16 a[232:233], v19 offset:32768
    v_mfma_f32_16x16x32_bf16 v[116:119], a[212:215], a[168:171], v[116:119]
    ds_read_b64_tr_b16 a[234:235], v19 offset:33280
    v_mfma_f32_16x16x32_bf16 v[120:123], a[216:219], a[168:171], v[120:123]
    ds_read_b64_tr_b16 a[236:237], v20 offset:32768
    v_mfma_f32_16x16x32_bf16 v[124:127], a[220:223], a[168:171], v[124:127]
    ds_read_b64_tr_b16 a[238:239], v20 offset:33280
    v_mfma_f32_16x16x32_bf16 v[144:147], a[208:211], a[172:175], v[144:147]
    ds_read_b64_tr_b16 a[240:241], v14 offset:12288
    v_mfma_f32_16x16x32_bf16 v[148:151], a[212:215], a[172:175], v[148:151]
    ds_read_b64_tr_b16 a[242:243], v14 offset:12800
    v_mfma_f32_16x16x32_bf16 v[152:155], a[216:219], a[172:175], v[152:155]
    ds_read_b64_tr_b16 a[244:245], v15 offset:12288
    v_mfma_f32_16x16x32_bf16 v[156:159], a[220:223], a[172:175], v[156:159]
    ds_read_b64_tr_b16 a[246:247], v15 offset:12800
    v_mfma_f32_16x16x32_bf16 v[48:51], a[208:211], a[160:163], v[48:51]
    ds_read_b64_tr_b16 a[248:249], v16 offset:12288
    v_mfma_f32_16x16x32_bf16 v[52:55], a[212:215], a[160:163], v[52:55]
    ds_read_b64_tr_b16 a[250:251], v16 offset:12800
    v_mfma_f32_16x16x32_bf16 v[56:59], a[216:219], a[160:163], v[56:59]
    ds_read_b64_tr_b16 a[252:253], v29 offset:12288
    v_mfma_f32_16x16x32_bf16 v[60:63], a[220:223], a[160:163], v[60:63]
    ds_read_b64_tr_b16 a[254:255], v29 offset:12800
    v_mfma_f32_16x16x32_bf16 v[80:83], a[208:211], a[164:167], v[80:83]
    v_mfma_f32_16x16x32_bf16 v[84:87], a[212:215], a[164:167], v[84:87]
    v_mfma_f32_16x16x32_bf16 v[88:91], a[216:219], a[164:167], v[88:91]
    v_mfma_f32_16x16x32_bf16 v[92:95], a[220:223], a[164:167], v[92:95]
    s_waitcnt vmcnt(14)
    s_waitcnt lgkmcnt(0)
    v_mfma_f32_16x16x32_bf16 v[96:99], a[224:227], a[56:59], v[96:99]
    v_mfma_f32_16x16x32_bf16 v[100:103], a[228:231], a[56:59], v[100:103]
    v_mfma_f32_16x16x32_bf16 v[104:107], a[232:235], a[56:59], v[104:107]
    v_mfma_f32_16x16x32_bf16 v[108:111], a[236:239], a[56:59], v[108:111]
    v_mfma_f32_16x16x32_bf16 v[128:131], a[224:227], a[60:63], v[128:131]
    v_mfma_f32_16x16x32_bf16 v[132:135], a[228:231], a[60:63], v[132:135]
    v_mfma_f32_16x16x32_bf16 v[136:139], a[232:235], a[60:63], v[136:139]
    v_mfma_f32_16x16x32_bf16 v[140:143], a[236:239], a[60:63], v[140:143]
    v_mfma_f32_16x16x32_bf16 v[32:35], a[224:227], a[48:51], v[32:35]
    ds_write_b128 v25, v[96:99] offset:0
    v_mfma_f32_16x16x32_bf16 v[36:39], a[228:231], a[48:51], v[36:39]
    ds_write_b128 v25, v[100:103] offset:1024
    v_mfma_f32_16x16x32_bf16 v[40:43], a[232:235], a[48:51], v[40:43]
    ds_write_b128 v25, v[104:107] offset:2048
    v_mfma_f32_16x16x32_bf16 v[44:47], a[236:239], a[48:51], v[44:47]
    ds_write_b128 v25, v[108:111] offset:3072
    v_mfma_f32_16x16x32_bf16 v[64:67], a[224:227], a[52:55], v[64:67]
    ds_write_b128 v25, v[128:131] offset:4096
    v_mfma_f32_16x16x32_bf16 v[68:71], a[228:231], a[52:55], v[68:71]
    ds_write_b128 v25, v[132:135] offset:5120
    v_mfma_f32_16x16x32_bf16 v[72:75], a[232:235], a[52:55], v[72:75]
    ds_write_b128 v25, v[136:139] offset:6144
    v_mfma_f32_16x16x32_bf16 v[76:79], a[236:239], a[52:55], v[76:79]
    ds_write_b128 v25, v[140:143] offset:7168
    s_waitcnt lgkmcnt(0)
    s_barrier
    ds_read_b128 v[96:99], v24 offset:0
    ds_read_b128 v[100:103], v24 offset:1024
    ds_read_b128 v[104:107], v24 offset:2048
    ds_read_b128 v[108:111], v24 offset:3072
    ds_read_b128 v[128:131], v24 offset:4096
    ds_read_b128 v[132:135], v24 offset:5120
    ds_read_b128 v[136:139], v24 offset:6144
    ds_read_b128 v[140:143], v24 offset:7168
    v_mfma_f32_16x16x32_bf16 v[112:115], a[240:243], a[184:187], v[112:115]
    v_mfma_f32_16x16x32_bf16 v[116:119], a[244:247], a[184:187], v[116:119]
    v_mfma_f32_16x16x32_bf16 v[120:123], a[248:251], a[184:187], v[120:123]
    v_mfma_f32_16x16x32_bf16 v[124:127], a[252:255], a[184:187], v[124:127]
    s_waitcnt lgkmcnt(7)
    v_add_f32 v32, v32, v96
    v_add_f32 v33, v33, v97
    v_add_f32 v34, v34, v98
    v_add_f32 v35, v35, v99
    s_waitcnt lgkmcnt(6)
    v_add_f32 v36, v36, v100
    v_add_f32 v37, v37, v101
    v_add_f32 v38, v38, v102
    v_add_f32 v39, v39, v103
    v_cvt_pk_bf16_f32 v32, v32, v33
    v_cvt_pk_bf16_f32 v33, v34, v35
    v_cvt_pk_bf16_f32 v34, v36, v37
    v_cvt_pk_bf16_f32 v35, v38, v39
    buffer_store_dwordx4 v[32:35], v6, s[28:31], s20 offen offset:0 sc1
    v_mfma_f32_16x16x32_bf16 v[144:147], a[240:243], a[188:191], v[144:147]
    s_waitcnt lgkmcnt(5)
    v_add_f32 v40, v40, v104
    v_add_f32 v41, v41, v105
    v_add_f32 v42, v42, v106
    v_add_f32 v43, v43, v107
    s_waitcnt lgkmcnt(4)
    v_add_f32 v44, v44, v108
    v_add_f32 v45, v45, v109
    v_add_f32 v46, v46, v110
    v_add_f32 v47, v47, v111
    v_cvt_pk_bf16_f32 v40, v40, v41
    v_cvt_pk_bf16_f32 v41, v42, v43
    v_cvt_pk_bf16_f32 v42, v44, v45
    v_cvt_pk_bf16_f32 v43, v46, v47
    buffer_store_dwordx4 v[40:43], v6, s[28:31], s20 offen offset:1024 sc1
    v_mfma_f32_16x16x32_bf16 v[148:151], a[244:247], a[188:191], v[148:151]
    s_waitcnt lgkmcnt(3)
    v_add_f32 v64, v64, v128
    v_add_f32 v65, v65, v129
    v_add_f32 v66, v66, v130
    v_add_f32 v67, v67, v131
    s_waitcnt lgkmcnt(2)
    v_add_f32 v68, v68, v132
    v_add_f32 v69, v69, v133
    v_add_f32 v70, v70, v134
    v_add_f32 v71, v71, v135
    v_cvt_pk_bf16_f32 v64, v64, v65
    v_cvt_pk_bf16_f32 v65, v66, v67
    v_cvt_pk_bf16_f32 v66, v68, v69
    v_cvt_pk_bf16_f32 v67, v70, v71
    buffer_store_dwordx4 v[64:67], v6, s[28:31], s20 offen offset:2048 sc1
    v_mfma_f32_16x16x32_bf16 v[152:155], a[248:251], a[188:191], v[152:155]
    s_waitcnt lgkmcnt(1)
    v_add_f32 v72, v72, v136
    v_add_f32 v73, v73, v137
    v_add_f32 v74, v74, v138
    v_add_f32 v75, v75, v139
    s_waitcnt lgkmcnt(0)
    v_add_f32 v76, v76, v140
    v_add_f32 v77, v77, v141
    v_add_f32 v78, v78, v142
    v_add_f32 v79, v79, v143
    v_cvt_pk_bf16_f32 v72, v72, v73
    v_cvt_pk_bf16_f32 v73, v74, v75
    v_cvt_pk_bf16_f32 v74, v76, v77
    v_cvt_pk_bf16_f32 v75, v78, v79
    buffer_store_dwordx4 v[72:75], v6, s[28:31], s20 offen offset:3072 sc1
    v_mfma_f32_16x16x32_bf16 v[156:159], a[252:255], a[188:191], v[156:159]
    v_mfma_f32_16x16x32_bf16 v[48:51], a[240:243], a[176:179], v[48:51]
    ds_read_b64_tr_b16 a[208:209], v14 offset:16384
    v_mfma_f32_16x16x32_bf16 v[52:55], a[244:247], a[176:179], v[52:55]
    ds_read_b64_tr_b16 a[210:211], v14 offset:16896
    v_mfma_f32_16x16x32_bf16 v[56:59], a[248:251], a[176:179], v[56:59]
    ds_read_b64_tr_b16 a[212:213], v15 offset:16384
    v_mfma_f32_16x16x32_bf16 v[60:63], a[252:255], a[176:179], v[60:63]
    ds_read_b64_tr_b16 a[214:215], v15 offset:16896
    v_mfma_f32_16x16x32_bf16 v[80:83], a[240:243], a[180:183], v[80:83]
    ds_read_b64_tr_b16 a[216:217], v16 offset:16384
    v_mfma_f32_16x16x32_bf16 v[84:87], a[244:247], a[180:183], v[84:87]
    ds_read_b64_tr_b16 a[218:219], v16 offset:16896
    v_mfma_f32_16x16x32_bf16 v[88:91], a[248:251], a[180:183], v[88:91]
    ds_read_b64_tr_b16 a[220:221], v29 offset:16384
    v_mfma_f32_16x16x32_bf16 v[92:95], a[252:255], a[180:183], v[92:95]
    ds_read_b64_tr_b16 a[222:223], v29 offset:16896
    s_waitcnt vmcnt(11)
    s_waitcnt lgkmcnt(0)
    s_barrier
    s_waitcnt vmcnt(6)
    v_mfma_f32_16x16x32_bf16 v[112:115], a[208:211], a[8:11], v[112:115]
    v_sub_f32 v178, 1.0, v176
    v_sub_f32 v179, 1.0, v177
    v_mfma_f32_16x16x32_bf16 v[116:119], a[212:215], a[8:11], v[116:119]
    v_cvt_pk_bf16_f32 v178, v178, v179
    v_and_b32 v179, 0xffff0000, v178
    v_mfma_f32_16x16x32_bf16 v[120:123], a[216:219], a[8:11], v[120:123]
    v_lshlrev_b32 v178, 16, v178
    v_lshlrev_b32 v180, 16, v160
    v_mfma_f32_16x16x32_bf16 v[124:127], a[220:223], a[8:11], v[124:127]
    v_and_b32 v181, 0xffff0000, v160
    v_lshlrev_b32 v182, 16, v161
    v_mfma_f32_16x16x32_bf16 v[144:147], a[208:211], a[12:15], v[144:147]
    v_and_b32 v183, 0xffff0000, v161
    v_mul_f32 v180, v176, v180
    ds_read_b64_tr_b16 a[240:241], v14 offset:20480
    v_mfma_f32_16x16x32_bf16 v[148:151], a[212:215], a[12:15], v[148:151]
    v_mul_f32 v181, v176, v181
    v_mul_f32 v182, v176, v182
    ds_read_b64_tr_b16 a[242:243], v14 offset:20992
    v_mfma_f32_16x16x32_bf16 v[152:155], a[216:219], a[12:15], v[152:155]
    v_mul_f32 v183, v176, v183
    v_lshlrev_b32 v184, 16, v162
    ds_read_b64_tr_b16 a[244:245], v15 offset:20480
    v_mfma_f32_16x16x32_bf16 v[156:159], a[220:223], a[12:15], v[156:159]
    v_and_b32 v185, 0xffff0000, v162
    v_lshlrev_b32 v186, 16, v163
    ds_read_b64_tr_b16 a[246:247], v15 offset:20992
    v_mfma_f32_16x16x32_bf16 v[48:51], a[208:211], a[0:3], v[48:51]
    ds_read_b64_tr_b16 a[248:249], v16 offset:20480
    v_mfma_f32_16x16x32_bf16 v[52:55], a[212:215], a[0:3], v[52:55]
    ds_read_b64_tr_b16 a[250:251], v16 offset:20992
    v_mfma_f32_16x16x32_bf16 v[56:59], a[216:219], a[0:3], v[56:59]
    ds_read_b64_tr_b16 a[252:253], v29 offset:20480
    v_mfma_f32_16x16x32_bf16 v[60:63], a[220:223], a[0:3], v[60:63]
    ds_read_b64_tr_b16 a[254:255], v29 offset:20992
    v_mfma_f32_16x16x32_bf16 v[80:83], a[208:211], a[4:7], v[80:83]
    v_mfma_f32_16x16x32_bf16 v[84:87], a[212:215], a[4:7], v[84:87]
    v_mfma_f32_16x16x32_bf16 v[88:91], a[216:219], a[4:7], v[88:91]
    v_mfma_f32_16x16x32_bf16 v[92:95], a[220:223], a[4:7], v[92:95]
    s_waitcnt lgkmcnt(0)
    v_mfma_f32_16x16x32_bf16 v[112:115], a[240:243], a[24:27], v[112:115]
    v_and_b32 v187, 0xffff0000, v163
    v_mul_f32 v184, v176, v184
    v_mfma_f32_16x16x32_bf16 v[116:119], a[244:247], a[24:27], v[116:119]
    v_mul_f32 v185, v176, v185
    v_mul_f32 v186, v176, v186
    v_mfma_f32_16x16x32_bf16 v[120:123], a[248:251], a[24:27], v[120:123]
    v_mul_f32 v187, v176, v187
    v_lshlrev_b32 v188, 16, v164
    v_mfma_f32_16x16x32_bf16 v[124:127], a[252:255], a[24:27], v[124:127]
    v_and_b32 v189, 0xffff0000, v164
    v_lshlrev_b32 v190, 16, v165
    v_mfma_f32_16x16x32_bf16 v[144:147], a[240:243], a[28:31], v[144:147]
    v_and_b32 v191, 0xffff0000, v165
    v_mul_f32 v188, v176, v188
    ds_read_b64_tr_b16 a[208:209], v14 offset:28672
    v_mfma_f32_16x16x32_bf16 v[148:151], a[244:247], a[28:31], v[148:151]
    v_mul_f32 v189, v176, v189
    v_mul_f32 v190, v176, v190
    ds_read_b64_tr_b16 a[210:211], v14 offset:29184
    v_mfma_f32_16x16x32_bf16 v[152:155], a[248:251], a[28:31], v[152:155]
    v_mul_f32 v191, v176, v191
    v_lshlrev_b32 v192, 16, v166
    ds_read_b64_tr_b16 a[212:213], v15 offset:28672
    v_mfma_f32_16x16x32_bf16 v[156:159], a[252:255], a[28:31], v[156:159]
    v_and_b32 v193, 0xffff0000, v166
    v_lshlrev_b32 v194, 16, v167
    ds_read_b64_tr_b16 a[214:215], v15 offset:29184
    v_mfma_f32_16x16x32_bf16 v[48:51], a[240:243], a[16:19], v[48:51]
    ds_read_b64_tr_b16 a[216:217], v16 offset:28672
    v_mfma_f32_16x16x32_bf16 v[52:55], a[244:247], a[16:19], v[52:55]
    ds_read_b64_tr_b16 a[218:219], v16 offset:29184
    v_mfma_f32_16x16x32_bf16 v[56:59], a[248:251], a[16:19], v[56:59]
    ds_read_b64_tr_b16 a[220:221], v29 offset:28672
    v_mfma_f32_16x16x32_bf16 v[60:63], a[252:255], a[16:19], v[60:63]
    ds_read_b64_tr_b16 a[222:223], v29 offset:29184
    v_mfma_f32_16x16x32_bf16 v[80:83], a[240:243], a[20:23], v[80:83]
    v_mfma_f32_16x16x32_bf16 v[84:87], a[244:247], a[20:23], v[84:87]
    v_mfma_f32_16x16x32_bf16 v[88:91], a[248:251], a[20:23], v[88:91]
    v_mfma_f32_16x16x32_bf16 v[92:95], a[252:255], a[20:23], v[92:95]
    s_waitcnt vmcnt(4)
    s_waitcnt lgkmcnt(0)
    s_barrier
    v_mfma_f32_16x16x32_bf16 v[112:115], a[208:211], a[40:43], v[112:115]
    v_and_b32 v195, 0xffff0000, v167
    v_mul_f32 v192, v176, v192
    v_mfma_f32_16x16x32_bf16 v[116:119], a[212:215], a[40:43], v[116:119]
    v_mul_f32 v193, v176, v193
    v_mul_f32 v194, v176, v194
    v_mfma_f32_16x16x32_bf16 v[120:123], a[216:219], a[40:43], v[120:123]
    v_mul_f32 v195, v176, v195
    v_lshlrev_b32 v196, 16, v168
    v_mfma_f32_16x16x32_bf16 v[124:127], a[220:223], a[40:43], v[124:127]
    v_and_b32 v197, 0xffff0000, v168
    v_lshlrev_b32 v198, 16, v169
    v_mfma_f32_16x16x32_bf16 v[144:147], a[208:211], a[44:47], v[144:147]
    v_and_b32 v199, 0xffff0000, v169
    v_mul_f32 v196, v177, v196
    ds_read_b64_tr_b16 a[240:241], v14 offset:32768
    v_mfma_f32_16x16x32_bf16 v[148:151], a[212:215], a[44:47], v[148:151]
    v_mul_f32 v197, v177, v197
    v_mul_f32 v198, v177, v198
    ds_read_b64_tr_b16 a[242:243], v14 offset:33280
    v_mfma_f32_16x16x32_bf16 v[152:155], a[216:219], a[44:47], v[152:155]
    v_mul_f32 v199, v177, v199
    v_lshlrev_b32 v200, 16, v170
    ds_read_b64_tr_b16 a[244:245], v15 offset:32768
    v_mfma_f32_16x16x32_bf16 v[156:159], a[220:223], a[44:47], v[156:159]
    v_and_b32 v201, 0xffff0000, v170
    v_lshlrev_b32 v202, 16, v171
    ds_read_b64_tr_b16 a[246:247], v15 offset:33280
    v_mfma_f32_16x16x32_bf16 v[48:51], a[208:211], a[32:35], v[48:51]
    ds_read_b64_tr_b16 a[248:249], v16 offset:32768
    v_mfma_f32_16x16x32_bf16 v[52:55], a[212:215], a[32:35], v[52:55]
    buffer_load_dwordx4 v[212:215], v6, s[28:31], s22 offen offset:0 sc1
    ds_read_b64_tr_b16 a[250:251], v16 offset:33280
    v_mfma_f32_16x16x32_bf16 v[56:59], a[216:219], a[32:35], v[56:59]
    ds_read_b64_tr_b16 a[252:253], v29 offset:32768
    v_mfma_f32_16x16x32_bf16 v[60:63], a[220:223], a[32:35], v[60:63]
    buffer_load_dwordx4 v[216:219], v6, s[28:31], s22 offen offset:1024 sc1
    ds_read_b64_tr_b16 a[254:255], v29 offset:33280
    v_mfma_f32_16x16x32_bf16 v[80:83], a[208:211], a[36:39], v[80:83]
    v_mfma_f32_16x16x32_bf16 v[84:87], a[212:215], a[36:39], v[84:87]
    buffer_load_dwordx4 v[220:223], v6, s[28:31], s22 offen offset:2048 sc1
    v_mfma_f32_16x16x32_bf16 v[88:91], a[216:219], a[36:39], v[88:91]
    v_mfma_f32_16x16x32_bf16 v[92:95], a[220:223], a[36:39], v[92:95]
    buffer_load_dwordx4 v[224:227], v6, s[28:31], s22 offen offset:3072 sc1
    s_waitcnt lgkmcnt(0)
    v_mfma_f32_16x16x32_bf16 v[112:115], a[240:243], a[56:59], v[112:115]
    v_mfma_f32_16x16x32_bf16 v[116:119], a[244:247], a[56:59], v[116:119]
    v_mfma_f32_16x16x32_bf16 v[120:123], a[248:251], a[56:59], v[120:123]
    v_mfma_f32_16x16x32_bf16 v[124:127], a[252:255], a[56:59], v[124:127]
    v_mfma_f32_16x16x32_bf16 v[144:147], a[240:243], a[60:63], v[144:147]
    v_mfma_f32_16x16x32_bf16 v[148:151], a[244:247], a[60:63], v[148:151]
    v_mfma_f32_16x16x32_bf16 v[152:155], a[248:251], a[60:63], v[152:155]
    v_mfma_f32_16x16x32_bf16 v[156:159], a[252:255], a[60:63], v[156:159]
    v_mfma_f32_16x16x32_bf16 v[48:51], a[240:243], a[48:51], v[48:51]
    ds_write_b128 v25, v[112:115] offset:16384
    v_mfma_f32_16x16x32_bf16 v[52:55], a[244:247], a[48:51], v[52:55]
    ds_write_b128 v25, v[116:119] offset:17408
    v_mfma_f32_16x16x32_bf16 v[56:59], a[248:251], a[48:51], v[56:59]
    ds_write_b128 v25, v[120:123] offset:18432
    v_mfma_f32_16x16x32_bf16 v[60:63], a[252:255], a[48:51], v[60:63]
    ds_write_b128 v25, v[124:127] offset:19456
    v_mfma_f32_16x16x32_bf16 v[80:83], a[240:243], a[52:55], v[80:83]
    ds_write_b128 v25, v[144:147] offset:20480
    v_mfma_f32_16x16x32_bf16 v[84:87], a[244:247], a[52:55], v[84:87]
    ds_write_b128 v25, v[148:151] offset:21504
    v_mfma_f32_16x16x32_bf16 v[88:91], a[248:251], a[52:55], v[88:91]
    ds_write_b128 v25, v[152:155] offset:22528
    v_mfma_f32_16x16x32_bf16 v[92:95], a[252:255], a[52:55], v[92:95]
    ds_write_b128 v25, v[156:159] offset:23552
    v_and_b32 v203, 0xffff0000, v171
    v_mul_f32 v200, v177, v200
    v_mul_f32 v201, v177, v201
    v_mul_f32 v202, v177, v202
    v_mul_f32 v203, v177, v203
    v_lshlrev_b32 v204, 16, v172
    v_and_b32 v205, 0xffff0000, v172
    v_lshlrev_b32 v206, 16, v173
    s_waitcnt lgkmcnt(0)
    s_barrier
    ds_read_b128 v[112:115], v24 offset:16384
    ds_read_b128 v[116:119], v24 offset:17408
    ds_read_b128 v[120:123], v24 offset:18432
    ds_read_b128 v[124:127], v24 offset:19456
    ds_read_b128 v[144:147], v24 offset:20480
    ds_read_b128 v[148:151], v24 offset:21504
    ds_read_b128 v[152:155], v24 offset:22528
    ds_read_b128 v[156:159], v24 offset:23552
    v_and_b32 v207, 0xffff0000, v173
    v_mul_f32 v204, v177, v204
    v_mul_f32 v205, v177, v205
    v_mul_f32 v206, v177, v206
    v_mul_f32 v207, v177, v207
    v_lshlrev_b32 v208, 16, v174
    v_and_b32 v209, 0xffff0000, v174
    v_lshlrev_b32 v210, 16, v175
    v_and_b32 v211, 0xffff0000, v175
    v_mul_f32 v208, v177, v208
    v_mul_f32 v209, v177, v209
    v_mul_f32 v210, v177, v210
    v_mul_f32 v211, v177, v211
    s_waitcnt lgkmcnt(7)
    v_pk_add_f32 v[48:49], v[48:49], v[112:113]
    v_pk_add_f32 v[50:51], v[50:51], v[114:115]
    v_pk_fma_f32 v[48:49], v[178:179], v[48:49], v[180:181] op_sel:[0,0,0] op_sel_hi:[0,1,1]
    v_pk_fma_f32 v[50:51], v[178:179], v[50:51], v[182:183] op_sel:[0,0,0] op_sel_hi:[0,1,1]
    s_waitcnt lgkmcnt(6)
    v_pk_add_f32 v[52:53], v[52:53], v[116:117]
    v_pk_add_f32 v[54:55], v[54:55], v[118:119]
    v_pk_fma_f32 v[52:53], v[178:179], v[52:53], v[184:185] op_sel:[0,0,0] op_sel_hi:[0,1,1]
    v_pk_fma_f32 v[54:55], v[178:179], v[54:55], v[186:187] op_sel:[0,0,0] op_sel_hi:[0,1,1]
    s_waitcnt lgkmcnt(5)
    v_pk_add_f32 v[56:57], v[56:57], v[120:121]
    v_pk_add_f32 v[58:59], v[58:59], v[122:123]
    v_pk_fma_f32 v[56:57], v[178:179], v[56:57], v[188:189] op_sel:[0,0,0] op_sel_hi:[0,1,1]
    v_pk_fma_f32 v[58:59], v[178:179], v[58:59], v[190:191] op_sel:[0,0,0] op_sel_hi:[0,1,1]
    s_waitcnt lgkmcnt(4)
    v_pk_add_f32 v[60:61], v[60:61], v[124:125]
    v_pk_add_f32 v[62:63], v[62:63], v[126:127]
    v_pk_fma_f32 v[60:61], v[178:179], v[60:61], v[192:193] op_sel:[0,0,0] op_sel_hi:[0,1,1]
    v_pk_fma_f32 v[62:63], v[178:179], v[62:63], v[194:195] op_sel:[0,0,0] op_sel_hi:[0,1,1]
    s_waitcnt lgkmcnt(3)
    v_pk_add_f32 v[80:81], v[80:81], v[144:145]
    v_pk_add_f32 v[82:83], v[82:83], v[146:147]
    v_pk_fma_f32 v[80:81], v[178:179], v[80:81], v[196:197] op_sel:[1,0,0] op_sel_hi:[1,1,1]
    v_pk_fma_f32 v[82:83], v[178:179], v[82:83], v[198:199] op_sel:[1,0,0] op_sel_hi:[1,1,1]
    s_waitcnt lgkmcnt(2)
    v_pk_add_f32 v[84:85], v[84:85], v[148:149]
    v_pk_add_f32 v[86:87], v[86:87], v[150:151]
    v_pk_fma_f32 v[84:85], v[178:179], v[84:85], v[200:201] op_sel:[1,0,0] op_sel_hi:[1,1,1]
    v_pk_fma_f32 v[86:87], v[178:179], v[86:87], v[202:203] op_sel:[1,0,0] op_sel_hi:[1,1,1]
    s_waitcnt lgkmcnt(1)
    v_pk_add_f32 v[88:89], v[88:89], v[152:153]
    v_pk_add_f32 v[90:91], v[90:91], v[154:155]
    v_pk_fma_f32 v[88:89], v[178:179], v[88:89], v[204:205] op_sel:[1,0,0] op_sel_hi:[1,1,1]
    v_pk_fma_f32 v[90:91], v[178:179], v[90:91], v[206:207] op_sel:[1,0,0] op_sel_hi:[1,1,1]
    s_waitcnt lgkmcnt(0)
    v_pk_add_f32 v[92:93], v[92:93], v[156:157]
    v_pk_add_f32 v[94:95], v[94:95], v[158:159]
    v_pk_fma_f32 v[92:93], v[178:179], v[92:93], v[208:209] op_sel:[1,0,0] op_sel_hi:[1,1,1]
    v_pk_fma_f32 v[94:95], v[178:179], v[94:95], v[210:211] op_sel:[1,0,0] op_sel_hi:[1,1,1]
    s_waitcnt vmcnt(0)
    v_max3_u32 v1, v212, v213, v214
    v_max3_u32 v9, v215, v216, v217
    v_max3_u32 v1, v1, v218, v219
    v_max3_u32 v9, v9, v220, v221
    v_max3_u32 v1, v1, v222, v223
    v_max3_u32 v9, v9, v224, v225
    v_max3_u32 v1, v1, v226, v227
    v_max_u32 v1, v1, v9
    v_cmp_eq_u32 vcc, -1, v1
    s_nop 1
    s_cmp_eq_u64 vcc, 0
    s_cbranch_scc0 gated_mix__ssm_conv_s4__swiglu_ffn__prompt_kernel_xpoll
gated_mix__ssm_conv_s4__swiglu_ffn__prompt_kernel_xok:
    v_lshlrev_b32 v180, 16, v212
    v_and_b32 v181, 0xffff0000, v212
    v_lshlrev_b32 v182, 16, v213
    v_and_b32 v183, 0xffff0000, v213
    v_pk_fma_f32 v[48:49], v[178:179], v[180:181], v[48:49] op_sel:[0,0,0] op_sel_hi:[0,1,1]
    v_pk_fma_f32 v[50:51], v[178:179], v[182:183], v[50:51] op_sel:[0,0,0] op_sel_hi:[0,1,1]
    v_lshlrev_b32 v184, 16, v214
    v_and_b32 v185, 0xffff0000, v214
    v_lshlrev_b32 v186, 16, v215
    v_and_b32 v187, 0xffff0000, v215
    v_pk_fma_f32 v[52:53], v[178:179], v[184:185], v[52:53] op_sel:[0,0,0] op_sel_hi:[0,1,1]
    v_pk_fma_f32 v[54:55], v[178:179], v[186:187], v[54:55] op_sel:[0,0,0] op_sel_hi:[0,1,1]
    v_cvt_pk_bf16_f32 v48, v48, v49
    v_cvt_pk_bf16_f32 v49, v50, v51
    v_cvt_pk_bf16_f32 v50, v52, v53
    v_cvt_pk_bf16_f32 v51, v54, v55
    s_nop 0
    v_permlane16_swap_b32 v48, v50
    v_permlane16_swap_b32 v49, v51
    buffer_store_dwordx4 v[48:51], v27, s[4:7], s63 offen offset:0
    v_lshlrev_b32 v188, 16, v216
    v_and_b32 v189, 0xffff0000, v216
    v_lshlrev_b32 v190, 16, v217
    v_and_b32 v191, 0xffff0000, v217
    v_pk_fma_f32 v[56:57], v[178:179], v[188:189], v[56:57] op_sel:[0,0,0] op_sel_hi:[0,1,1]
    v_pk_fma_f32 v[58:59], v[178:179], v[190:191], v[58:59] op_sel:[0,0,0] op_sel_hi:[0,1,1]
    v_lshlrev_b32 v192, 16, v218
    v_and_b32 v193, 0xffff0000, v218
    v_lshlrev_b32 v194, 16, v219
    v_and_b32 v195, 0xffff0000, v219
    v_pk_fma_f32 v[60:61], v[178:179], v[192:193], v[60:61] op_sel:[0,0,0] op_sel_hi:[0,1,1]
    v_pk_fma_f32 v[62:63], v[178:179], v[194:195], v[62:63] op_sel:[0,0,0] op_sel_hi:[0,1,1]
    v_cvt_pk_bf16_f32 v56, v56, v57
    v_cvt_pk_bf16_f32 v57, v58, v59
    v_cvt_pk_bf16_f32 v58, v60, v61
    v_cvt_pk_bf16_f32 v59, v62, v63
    s_nop 0
    v_permlane16_swap_b32 v56, v58
    v_permlane16_swap_b32 v57, v59
    buffer_store_dwordx4 v[56:59], v27, s[4:7], s63 offen offset:64
    v_lshlrev_b32 v196, 16, v220
    v_and_b32 v197, 0xffff0000, v220
    v_lshlrev_b32 v198, 16, v221
    v_and_b32 v199, 0xffff0000, v221
    v_pk_fma_f32 v[80:81], v[178:179], v[196:197], v[80:81] op_sel:[1,0,0] op_sel_hi:[1,1,1]
    v_pk_fma_f32 v[82:83], v[178:179], v[198:199], v[82:83] op_sel:[1,0,0] op_sel_hi:[1,1,1]
    v_lshlrev_b32 v200, 16, v222
    v_and_b32 v201, 0xffff0000, v222
    v_lshlrev_b32 v202, 16, v223
    v_and_b32 v203, 0xffff0000, v223
    v_pk_fma_f32 v[84:85], v[178:179], v[200:201], v[84:85] op_sel:[1,0,0] op_sel_hi:[1,1,1]
    v_pk_fma_f32 v[86:87], v[178:179], v[202:203], v[86:87] op_sel:[1,0,0] op_sel_hi:[1,1,1]
    v_cvt_pk_bf16_f32 v80, v80, v81
    v_cvt_pk_bf16_f32 v81, v82, v83
    v_cvt_pk_bf16_f32 v82, v84, v85
    v_cvt_pk_bf16_f32 v83, v86, v87
    s_nop 0
    v_permlane16_swap_b32 v80, v82
    v_permlane16_swap_b32 v81, v83
    buffer_store_dwordx4 v[80:83], v27, s[4:7], s56 offen offset:0
    v_lshlrev_b32 v204, 16, v224
    v_and_b32 v205, 0xffff0000, v224
    v_lshlrev_b32 v206, 16, v225
    v_and_b32 v207, 0xffff0000, v225
    v_pk_fma_f32 v[88:89], v[178:179], v[204:205], v[88:89] op_sel:[1,0,0] op_sel_hi:[1,1,1]
    v_pk_fma_f32 v[90:91], v[178:179], v[206:207], v[90:91] op_sel:[1,0,0] op_sel_hi:[1,1,1]
    v_lshlrev_b32 v208, 16, v226
    v_and_b32 v209, 0xffff0000, v226
    v_lshlrev_b32 v210, 16, v227
    v_and_b32 v211, 0xffff0000, v227
    v_pk_fma_f32 v[92:93], v[178:179], v[208:209], v[92:93] op_sel:[1,0,0] op_sel_hi:[1,1,1]
    v_pk_fma_f32 v[94:95], v[178:179], v[210:211], v[94:95] op_sel:[1,0,0] op_sel_hi:[1,1,1]
    v_cvt_pk_bf16_f32 v88, v88, v89
    v_cvt_pk_bf16_f32 v89, v90, v91
    v_cvt_pk_bf16_f32 v90, v92, v93
    v_cvt_pk_bf16_f32 v91, v94, v95
    s_nop 0
    v_permlane16_swap_b32 v88, v90
    v_permlane16_swap_b32 v89, v91
    buffer_store_dwordx4 v[88:91], v27, s[4:7], s56 offen offset:64
gated_mix__ssm_conv_s4__swiglu_ffn__prompt_kernel_done:
    s_endpgm
gated_mix__ssm_conv_s4__swiglu_ffn__prompt_kernel_u1_o:
    buffer_store_dwordx2 a[112:113], v31, s[28:31], s16 offen offset:0 sc1
    buffer_store_dwordx2 a[114:115], v31, s[28:31], s17 offen offset:0 sc1
    buffer_store_dwordx2 a[116:117], v31, s[28:31], s16 offen offset:128 sc1
    buffer_store_dwordx2 a[118:119], v31, s[28:31], s17 offen offset:128 sc1
    buffer_store_dwordx2 a[120:121], v31, s[28:31], s16 offen offset:256 sc1
    buffer_store_dwordx2 a[122:123], v31, s[28:31], s17 offen offset:256 sc1
    buffer_store_dwordx2 a[124:125], v31, s[28:31], s16 offen offset:384 sc1
    buffer_store_dwordx2 a[126:127], v31, s[28:31], s17 offen offset:384 sc1
    buffer_store_dwordx2 a[128:129], v31, s[28:31], s14 offen offset:0 sc1
    buffer_store_dwordx2 a[130:131], v31, s[28:31], s15 offen offset:0 sc1
    buffer_store_dwordx2 a[132:133], v31, s[28:31], s14 offen offset:128 sc1
    buffer_store_dwordx2 a[134:135], v31, s[28:31], s15 offen offset:128 sc1
    buffer_store_dwordx2 a[136:137], v31, s[28:31], s14 offen offset:256 sc1
    buffer_store_dwordx2 a[138:139], v31, s[28:31], s15 offen offset:256 sc1
    buffer_store_dwordx2 a[140:141], v31, s[28:31], s14 offen offset:384 sc1
    buffer_store_dwordx2 a[142:143], v31, s[28:31], s15 offen offset:384 sc1
    s_branch gated_mix__ssm_conv_s4__swiglu_ffn__prompt_kernel_u1_b
gated_mix__ssm_conv_s4__swiglu_ffn__prompt_kernel_u1_f:
    buffer_store_byte v28, v29, s[8:11], s18 offen sc1
    s_branch gated_mix__ssm_conv_s4__swiglu_ffn__prompt_kernel_u1_g
gated_mix__ssm_conv_s4__swiglu_ffn__prompt_kernel_u2_o:
    buffer_store_dwordx2 a[144:145], v31, s[28:31], s16 offen offset:0 sc1
    buffer_store_dwordx2 a[146:147], v31, s[28:31], s17 offen offset:0 sc1
    buffer_store_dwordx2 a[148:149], v31, s[28:31], s16 offen offset:128 sc1
    buffer_store_dwordx2 a[150:151], v31, s[28:31], s17 offen offset:128 sc1
    buffer_store_dwordx2 a[152:153], v31, s[28:31], s16 offen offset:256 sc1
    buffer_store_dwordx2 a[154:155], v31, s[28:31], s17 offen offset:256 sc1
    buffer_store_dwordx2 a[156:157], v31, s[28:31], s16 offen offset:384 sc1
    buffer_store_dwordx2 a[158:159], v31, s[28:31], s17 offen offset:384 sc1
    buffer_store_dwordx2 a[160:161], v31, s[28:31], s14 offen offset:0 sc1
    buffer_store_dwordx2 a[162:163], v31, s[28:31], s15 offen offset:0 sc1
    buffer_store_dwordx2 a[164:165], v31, s[28:31], s14 offen offset:128 sc1
    buffer_store_dwordx2 a[166:167], v31, s[28:31], s15 offen offset:128 sc1
    buffer_store_dwordx2 a[168:169], v31, s[28:31], s14 offen offset:256 sc1
    buffer_store_dwordx2 a[170:171], v31, s[28:31], s15 offen offset:256 sc1
    buffer_store_dwordx2 a[172:173], v31, s[28:31], s14 offen offset:384 sc1
    buffer_store_dwordx2 a[174:175], v31, s[28:31], s15 offen offset:384 sc1
    s_branch gated_mix__ssm_conv_s4__swiglu_ffn__prompt_kernel_u2_b
gated_mix__ssm_conv_s4__swiglu_ffn__prompt_kernel_u2_f:
    buffer_store_byte v28, v29, s[8:11], s18 offen sc1
    s_branch gated_mix__ssm_conv_s4__swiglu_ffn__prompt_kernel_u2_g
gated_mix__ssm_conv_s4__swiglu_ffn__prompt_kernel_u3_o:
    buffer_store_dwordx2 a[112:113], v31, s[28:31], s16 offen offset:0 sc1
    buffer_store_dwordx2 a[114:115], v31, s[28:31], s17 offen offset:0 sc1
    buffer_store_dwordx2 a[116:117], v31, s[28:31], s16 offen offset:128 sc1
    buffer_store_dwordx2 a[118:119], v31, s[28:31], s17 offen offset:128 sc1
    buffer_store_dwordx2 a[120:121], v31, s[28:31], s16 offen offset:256 sc1
    buffer_store_dwordx2 a[122:123], v31, s[28:31], s17 offen offset:256 sc1
    buffer_store_dwordx2 a[124:125], v31, s[28:31], s16 offen offset:384 sc1
    buffer_store_dwordx2 a[126:127], v31, s[28:31], s17 offen offset:384 sc1
    buffer_store_dwordx2 a[128:129], v31, s[28:31], s14 offen offset:0 sc1
    buffer_store_dwordx2 a[130:131], v31, s[28:31], s15 offen offset:0 sc1
    buffer_store_dwordx2 a[132:133], v31, s[28:31], s14 offen offset:128 sc1
    buffer_store_dwordx2 a[134:135], v31, s[28:31], s15 offen offset:128 sc1
    buffer_store_dwordx2 a[136:137], v31, s[28:31], s14 offen offset:256 sc1
    buffer_store_dwordx2 a[138:139], v31, s[28:31], s15 offen offset:256 sc1
    buffer_store_dwordx2 a[140:141], v31, s[28:31], s14 offen offset:384 sc1
    buffer_store_dwordx2 a[142:143], v31, s[28:31], s15 offen offset:384 sc1
    s_branch gated_mix__ssm_conv_s4__swiglu_ffn__prompt_kernel_u3_b
gated_mix__ssm_conv_s4__swiglu_ffn__prompt_kernel_u3_f:
    buffer_store_byte v28, v29, s[8:11], s18 offen sc1
    s_branch gated_mix__ssm_conv_s4__swiglu_ffn__prompt_kernel_u3_g
gated_mix__ssm_conv_s4__swiglu_ffn__prompt_kernel_u4_o:
    buffer_store_dwordx2 a[144:145], v31, s[28:31], s16 offen offset:0 sc1
    buffer_store_dwordx2 a[146:147], v31, s[28:31], s17 offen offset:0 sc1
    buffer_store_dwordx2 a[148:149], v31, s[28:31], s16 offen offset:128 sc1
    buffer_store_dwordx2 a[150:151], v31, s[28:31], s17 offen offset:128 sc1
    buffer_store_dwordx2 a[152:153], v31, s[28:31], s16 offen offset:256 sc1
    buffer_store_dwordx2 a[154:155], v31, s[28:31], s17 offen offset:256 sc1
    buffer_store_dwordx2 a[156:157], v31, s[28:31], s16 offen offset:384 sc1
    buffer_store_dwordx2 a[158:159], v31, s[28:31], s17 offen offset:384 sc1
    buffer_store_dwordx2 a[160:161], v31, s[28:31], s14 offen offset:0 sc1
    buffer_store_dwordx2 a[162:163], v31, s[28:31], s15 offen offset:0 sc1
    buffer_store_dwordx2 a[164:165], v31, s[28:31], s14 offen offset:128 sc1
    buffer_store_dwordx2 a[166:167], v31, s[28:31], s15 offen offset:128 sc1
    buffer_store_dwordx2 a[168:169], v31, s[28:31], s14 offen offset:256 sc1
    buffer_store_dwordx2 a[170:171], v31, s[28:31], s15 offen offset:256 sc1
    buffer_store_dwordx2 a[172:173], v31, s[28:31], s14 offen offset:384 sc1
    buffer_store_dwordx2 a[174:175], v31, s[28:31], s15 offen offset:384 sc1
    s_branch gated_mix__ssm_conv_s4__swiglu_ffn__prompt_kernel_u4_b
gated_mix__ssm_conv_s4__swiglu_ffn__prompt_kernel_u4_f:
    buffer_store_byte v28, v29, s[8:11], s18 offen sc1
    s_branch gated_mix__ssm_conv_s4__swiglu_ffn__prompt_kernel_u4_g
gated_mix__ssm_conv_s4__swiglu_ffn__prompt_kernel_apoll:
    s_mov_b32 s58, 400000
gated_mix__ssm_conv_s4__swiglu_ffn__prompt_kernel_apoll2:
    s_sleep 4
    buffer_load_dword v1, v9, s[28:31], s57 offen sc1
    s_waitcnt vmcnt(0)
    v_cmp_eq_u32 vcc, 1, v1
    s_nop 1
    s_cmp_eq_u64 vcc, -1
    s_cbranch_scc1 gated_mix__ssm_conv_s4__swiglu_ffn__prompt_kernel_aok
    s_sub_u32 s58, s58, 1
    s_cmp_lg_u32 s58, 0
    s_cbranch_scc1 gated_mix__ssm_conv_s4__swiglu_ffn__prompt_kernel_apoll2
    s_branch gated_mix__ssm_conv_s4__swiglu_ffn__prompt_kernel_aok
gated_mix__ssm_conv_s4__swiglu_ffn__prompt_kernel_xpoll:
    s_mov_b32 s58, 400000
gated_mix__ssm_conv_s4__swiglu_ffn__prompt_kernel_xpoll2:
    s_sub_u32 s58, s58, 1
    s_cmp_eq_u32 s58, 0
    s_cbranch_scc1 gated_mix__ssm_conv_s4__swiglu_ffn__prompt_kernel_xok
    v_max3_u32 v1, v212, v213, v214
    v_max_u32 v1, v1, v215
    v_cmp_eq_u32 vcc, -1, v1
    s_nop 1
    s_cmp_eq_u64 vcc, 0
    s_cbranch_scc1 gated_mix__ssm_conv_s4__swiglu_ffn__prompt_kernel_xall
    s_sleep 2
    buffer_load_dwordx4 v[212:215], v6, s[28:31], s22 offen offset:0 sc1
    s_waitcnt vmcnt(0)
    s_branch gated_mix__ssm_conv_s4__swiglu_ffn__prompt_kernel_xpoll2
gated_mix__ssm_conv_s4__swiglu_ffn__prompt_kernel_xall:
    buffer_load_dwordx4 v[216:219], v6, s[28:31], s22 offen offset:1024 sc1
    buffer_load_dwordx4 v[220:223], v6, s[28:31], s22 offen offset:2048 sc1
    buffer_load_dwordx4 v[224:227], v6, s[28:31], s22 offen offset:3072 sc1
    s_waitcnt vmcnt(0)
    v_max3_u32 v1, v212, v213, v214
    v_max3_u32 v9, v215, v216, v217
    v_max3_u32 v1, v1, v218, v219
    v_max3_u32 v9, v9, v220, v221
    v_max3_u32 v1, v1, v222, v223
    v_max3_u32 v9, v9, v224, v225
    v_max3_u32 v1, v1, v226, v227
    v_max_u32 v1, v1, v9
    v_cmp_eq_u32 vcc, -1, v1
    s_nop 1
    s_cmp_eq_u64 vcc, 0
    s_cbranch_scc1 gated_mix__ssm_conv_s4__swiglu_ffn__prompt_kernel_xok
    s_branch gated_mix__ssm_conv_s4__swiglu_ffn__prompt_kernel_xpoll2
gated_mix__ssm_conv_s4__swiglu_ffn__prompt_kernel_ipoll:
    s_mov_b32 s58, 400000
gated_mix__ssm_conv_s4__swiglu_ffn__prompt_kernel_ipoll2:
    s_sleep 4
    buffer_load_dword v25, v30, s[8:11], 0 offen sc1
    s_waitcnt vmcnt(0)
    v_cmp_eq_u32 vcc, 0x01010101, v25
    s_nop 1
    s_cmp_eq_u64 vcc, -1
    s_cbranch_scc1 gated_mix__ssm_conv_s4__swiglu_ffn__prompt_kernel_iok
    s_sub_u32 s58, s58, 1
    s_cmp_lg_u32 s58, 0
    s_cbranch_scc1 gated_mix__ssm_conv_s4__swiglu_ffn__prompt_kernel_ipoll2
    s_branch gated_mix__ssm_conv_s4__swiglu_ffn__prompt_kernel_iok
gated_mix__ssm_conv_s4__swiglu_ffn__prompt_kernel_end:
.section .rodata,"a"
.p2align 6
.amdhsa_kernel gated_mix__ssm_conv_s4__swiglu_ffn__prompt_kernel
  .amdhsa_next_free_vgpr 512
  .amdhsa_next_free_sgpr 102
  .amdhsa_accum_offset 256
  .amdhsa_group_segment_fixed_size 0
  .amdhsa_kernarg_size 136
  .amdhsa_user_sgpr_count 2
  .amdhsa_user_sgpr_kernarg_segment_ptr 1
  .amdhsa_system_sgpr_workgroup_id_x 1
  .amdhsa_float_denorm_mode_32 3
  .amdhsa_float_denorm_mode_16_64 3
.end_amdhsa_kernel
```
